```python
import torch

def _softmax(x, axis=-1):
    return torch.softmax(x, dim=axis)
def _gelu(x):
    return torch.nn.functional.gelu(x, approximate="tanh")
def _silu(x):
    return torch.nn.functional.silu(x)
def _sigmoid(x):
    return torch.sigmoid(x)
def _layernorm(x, axis=-1, eps=1e-5):
    m = x.mean(dim=axis, keepdim=True)
    v = x.var(dim=axis, keepdim=True, unbiased=False)
    return (x - m) / torch.sqrt(v + eps)
def _scatter_add(tgt, idx, src, axis=0):
    return tgt.clone().index_add_(axis, idx, src)
def _segment_sum(src, seg, n):
    out = torch.zeros((n,) + src.shape[1:], dtype=src.dtype)
    return out.index_add_(0, seg, src)
def _pad(x, pw):
    flat = tuple(v for pair in reversed(pw) for v in pair)
    return torch.nn.functional.pad(x, flat)

kernel_name = 'concat_heads__mha_block_cached__gqa_block_cached__decode'

def setup_inputs():

    _w = (lambda a: (lambda t: t.to(torch.bfloat16) if t.is_floating_point() else t)(torch.as_tensor(a)))
    def _A_setup():
        B, Sq, D = 1, 1, 640
        H, Sk, Dh = 32, 8192, 128
        return {
            "x": _w((lambda *s: torch.randn(*s, dtype=torch.bfloat16) * 0.8)(B, Sq, D)),
            "k_cache": _w((lambda *s: torch.randn(*s, dtype=torch.bfloat16) * 1.6)(B, H, Sk, Dh)),
            "v_cache": _w((lambda *s: torch.randn(*s, dtype=torch.bfloat16) * 0.2)(B, H, Sk, Dh)),
            "wq": _w((lambda *s: torch.randn(*s, dtype=torch.bfloat16) * 1.6)(D, H * Dh) * (D ** -0.5)),
            "wo": _w((lambda *s: torch.randn(*s, dtype=torch.bfloat16) * 0.2)(H * Dh, D) * ((H * Dh) ** -0.5)),
        }
    _A_in = _A_setup()

    def _B_setup():
        B, Sq, D = 1, 1, 640
        Hq, Hkv, Sk, Dh = 32, 32, 8192, 128
        assert Hq % Hkv == 0, (Hq, Hkv)
        return {
            "x": _w((lambda *s: torch.randn(*s, dtype=torch.bfloat16) * 0.8)(B, Sq, D)),
            "k_cache": _w((lambda *s: torch.randn(*s, dtype=torch.bfloat16) * 1.6)(B, Hkv, Sk, Dh)),
            "v_cache": _w((lambda *s: torch.randn(*s, dtype=torch.bfloat16) * 0.2)(B, Hkv, Sk, Dh)),
            "wq": _w((lambda *s: torch.randn(*s, dtype=torch.bfloat16) * 1.6)(D, Hq * Dh) * (D ** -0.5)),
            "wo": _w((lambda *s: torch.randn(*s, dtype=torch.bfloat16) * 0.2)(Hq * Dh, D) * ((Hq * Dh) ** -0.5)),
        }
    _B_in = _B_setup()

    return {
        "A_x": _A_in["x"],
        "A_k_cache": _A_in["k_cache"],
        "A_v_cache": _A_in["v_cache"],
        "A_wq": _A_in["wq"],
        "A_wo": _A_in["wo"],
        "B_x": _B_in["x"],
        "B_k_cache": _B_in["k_cache"],
        "B_v_cache": _B_in["v_cache"],
        "B_wq": _B_in["wq"],
        "B_wo": _B_in["wo"],
    }

def reference(A_x, A_k_cache, A_v_cache, A_wq, A_wo, B_x, B_k_cache, B_v_cache, B_wq, B_wo):
    def _A_ref(x, k_cache, v_cache, wq, wo):
        B, Sq, D = x.shape
        H, Dh = 32, 128
        q = (lambda x, *d: x.permute(*d))((x @ wq).reshape(B, Sq, H, Dh), 0, 2, 1, 3)
        scores = torch.einsum("bhqd,bhkd->bhqk", q, k_cache) * (Dh ** -0.5)
        p = _softmax(scores, axis=-1)
        o = torch.einsum("bhqk,bhkd->bhqd", p, v_cache)
        return (lambda x, *d: x.permute(*d))(o, 0, 2, 1, 3).reshape(B, Sq, H * Dh) @ wo

    def _B_ref(x, k_cache, v_cache, wq, wo):
        B, Sq, D = x.shape
        Hq, Dh = 32, 128
        Hkv = k_cache.shape[1]
        rep = Hq // Hkv
        q = (lambda x, *d: x.permute(*d))((x @ wq).reshape(B, Sq, Hq, Dh), 0, 2, 1, 3)
        k = (lambda x, n, axis: torch.repeat_interleave(x, n, dim=axis))(k_cache, rep, axis=1)
        v = (lambda x, n, axis: torch.repeat_interleave(x, n, dim=axis))(v_cache, rep, axis=1)
        scores = torch.einsum("bhqd,bhkd->bhqk", q, k) * (Dh ** -0.5)
        p = _softmax(scores, axis=-1)
        o = torch.einsum("bhqk,bhkd->bhqd", p, v)
        return (lambda x, *d: x.permute(*d))(o, 0, 2, 1, 3).reshape(B, Sq, Hq * Dh) @ wo

    a = _A_ref(A_x, A_k_cache, A_v_cache, A_wq, A_wo)
    b = _B_ref(B_x, B_k_cache, B_v_cache, B_wq, B_wo)
    return torch.concatenate([a, b], axis=-1)
```

```asm
; @launch grid=(256,1,1) block=(512,1,1) lds=6656
.amdgcn_target "amdgcn-amd-amdhsa--gfx950"
.text
.globl concat_heads__mha_block_cached__gqa_block_cached__decode_kernel
.p2align 8
.type concat_heads__mha_block_cached__gqa_block_cached__decode_kernel,@function
concat_heads__mha_block_cached__gqa_block_cached__decode_kernel:
    s_cmp_ge_u32 s2, 256
    s_cbranch_scc1 L_end
    s_load_dwordx16 s[8:23], s[0:1], 0
    s_load_dwordx8 s[24:31], s[0:1], 64
    s_load_dwordx2 s[32:33], s[0:1], 96
    s_memrealtime s[84:85]
    v_lshrrev_b32 v1, 6, v0
    v_and_b32 v7, 63, v0
    v_readfirstlane_b32 s34, v1
    s_and_b32 s63, s2, 7
    s_lshr_b32 s3, s2, 3
    s_lshl_b32 s63, s63, 5
    s_add_u32 s63, s63, s3
    s_lshr_b32 s35, s63, 7
    s_and_b32 s61, s63, 127
    s_lshr_b32 s60, s61, 2
    s_cmp_ge_u32 s34, 4
    s_cbranch_scc1 L_help
    v_lshlrev_b32 v1, 4, v7
    s_lshr_b32 s83, s61, 1
    s_lshl_b32 s101, s83, 20
    s_mov_b32 s38, 0x100000
    s_mov_b32 s39, 0x20000
    s_and_b32 s100, s61, 1
    s_lshl_b32 s100, s100, 2
    s_add_u32 s100, s100, s34
    s_lshl_b32 s100, s100, 13
    s_add_u32 s3, s83, s35
    s_and_b32 s64, s3, 15
    s_lshl_b32 s64, s64, 16
    s_add_u32 s64, s64, s100
    v_add_u32 v2, 4096, v1
    s_waitcnt lgkmcnt(0)
    s_add_u32 s36, s10, s101
    s_addc_u32 s37, s11, 0
    buffer_load_dwordx4 v[48:51], v1, s[36:39], s64 offen offset:0 nt
    buffer_load_dwordx4 v[52:55], v1, s[36:39], s64 offen offset:1024 nt
    buffer_load_dwordx4 v[56:59], v1, s[36:39], s64 offen offset:2048 nt
    buffer_load_dwordx4 v[60:63], v1, s[36:39], s64 offen offset:3072 nt
    buffer_load_dwordx4 v[64:67], v2, s[36:39], s64 offen offset:0 nt
    s_add_u32 s40, s12, s101
    s_addc_u32 s41, s13, 0
    s_mov_b32 s42, 0x100000
    s_mov_b32 s43, 0x20000
    s_add_u32 s48, s20, s101
    s_addc_u32 s49, s21, 0
    s_mov_b32 s50, 0x100000
    s_mov_b32 s51, 0x20000
    s_add_u32 s52, s22, s101
    s_addc_u32 s53, s23, 0
    s_mov_b32 s54, 0x100000
    s_mov_b32 s55, 0x20000
    s_add_u32 s65, s3, 2
    s_and_b32 s65, s65, 15
    s_lshl_b32 s65, s65, 16
    s_add_u32 s65, s65, s100
    s_add_u32 s66, s3, 4
    s_and_b32 s66, s66, 15
    s_lshl_b32 s66, s66, 16
    s_add_u32 s66, s66, s100
    s_add_u32 s67, s3, 6
    s_and_b32 s67, s67, 15
    s_lshl_b32 s67, s67, 16
    s_add_u32 s67, s67, s100
    s_add_u32 s68, s3, 8
    s_and_b32 s68, s68, 15
    s_lshl_b32 s68, s68, 16
    s_add_u32 s68, s68, s100
    s_add_u32 s69, s3, 10
    s_and_b32 s69, s69, 15
    s_lshl_b32 s69, s69, 16
    s_add_u32 s69, s69, s100
    s_add_u32 s70, s83, 12
    s_and_b32 s70, s70, 15
    s_lshl_b32 s70, s70, 16
    s_add_u32 s70, s70, s100
    s_add_u32 s71, s83, 13
    s_and_b32 s71, s71, 15
    s_lshl_b32 s71, s71, 16
    s_add_u32 s71, s71, s100
    s_add_u32 s72, s83, 14
    s_and_b32 s72, s72, 15
    s_lshl_b32 s72, s72, 16
    s_add_u32 s72, s72, s100
    s_add_u32 s73, s83, 15
    s_and_b32 s73, s73, 15
    s_lshl_b32 s73, s73, 16
    s_add_u32 s73, s73, s100
    s_mov_b32 s56, s32
    s_mov_b32 s57, s33
    s_mov_b32 s58, 3670016
    s_mov_b32 s59, 0x20000
    s_load_dword s62, s[32:33], 0
    s_mov_b32 s80, 0x3fb8aa3b
    s_mov_b32 s81, 0x3db504f3
    s_mov_b32 s44, s28
    s_mov_b32 s45, s29
    s_mov_b32 s46, 2560
    s_mov_b32 s47, 0x20000
    v_lshrrev_b32 v27, 4, v7
    v_and_b32 v28, 15, v7
    v_lshrrev_b32 v5, 1, v27
    v_and_b32 v29, 1, v27
    v_lshl_add_u32 v5, v29, 2, v5
    v_bfe_u32 v29, v28, 0, 1
    v_lshl_add_u32 v5, v29, 1, v5
    v_bfe_u32 v29, v28, 1, 1
    v_lshl_add_u32 v5, v29, 3, v5
    v_bfe_u32 v29, v28, 2, 1
    v_lshl_add_u32 v5, v29, 4, v5
    v_bfe_u32 v29, v28, 3, 1
    v_lshl_add_u32 v5, v29, 5, v5
    v_lshlrev_b32 v5, 2, v5
    s_mul_i32 s63, s34, 320
    v_add_u32 v5, s63, v5
    s_lshl_b32 s63, s34, 9
    v_lshl_add_u32 v4, v7, 3, s63
    s_lshl_b32 s63, s34, 3
    v_mov_b32 v20, s63
    s_lshl_b32 s63, s34, 2
    v_mov_b32 v21, s63
    s_lshl_b32 s63, s35, 8
    v_lshl_add_u32 v3, v28, 4, s63
    s_mul_i32 s20, s35, 540672
    s_lshl_b32 s63, s61, 5
    s_add_u32 s20, s20, s63
    s_add_u32 s20, s20, 0x200000
    s_add_u32 s21, s20, 135168
    s_add_u32 s22, s20, 270336
    s_add_u32 s23, s20, 405504
    v_lshrrev_b32 v0, 1, v7
    v_mul_u32_u24 v0, 4224, v0
    v_and_b32 v29, 1, v7
    v_lshl_add_u32 v0, v29, 4, v0
    s_bfe_u32 s63, s61, 0x10003
    s_bfe_u32 s3, s61, 0x10004
    s_mul_i32 s3, s3, 5
    s_cmp_eq_u32 s63, 0
    s_cselect_b32 s9, 0x30003, 3
    v_add_u32 v29, s63, v27
    v_cmp_eq_u32 s[10:11], 1, v27
    s_nop 1
    v_cndmask_b32 v29, v29, 4, s[10:11]
    v_add_u32 v29, s3, v29
    s_and_b32 s63, s61, 7
    s_lshl_b32 s63, s63, 1
    v_and_b32 v30, 1, v7
    v_add_u32 v30, s63, v30
    v_lshl_add_u32 v31, v30, 3, v29
    v_lshl_add_u32 v6, v30, 1, v29
    v_add_u32 v6, 120, v6
    v_cmp_gt_u32 s[10:11], 8, v29
    s_nop 1
    v_cndmask_b32 v6, v6, v31, s[10:11]
    s_lshr_b32 s63, s61, 5
    s_mul_i32 s63, s63, 160
    s_mul_i32 s3, s35, 640
    s_add_u32 s63, s63, s3
    v_add_u32 v6, s63, v6
    v_lshlrev_b32 v6, 1, v6
    v_lshlrev_b32 v27, 4, v28
    s_mov_b32 s4, 0xcccccccc
    s_mov_b32 s5, 0xcccccccc
    s_mov_b32 s6, 0xaaaaaaaa
    s_mov_b32 s7, 0xaaaaaaaa
    v_mov_b32 v12, 0
    v_mov_b32 v13, 0
    v_mov_b32 v14, 0
    v_mov_b32 v15, 0
    v_mov_b32 v16, 0
    v_mov_b32 v17, 0
    v_mov_b32 v18, 0
    v_mov_b32 v19, 0
    v_mov_b32 v31, 0
    s_mov_b64 s[18:19], 0
    s_waitcnt vmcnt(4)
    buffer_load_dwordx4 v[68:71], v2, s[36:39], s64 offen offset:1024 nt
    s_waitcnt vmcnt(4)
    buffer_load_dwordx4 v[72:75], v2, s[36:39], s64 offen offset:2048 nt
    s_waitcnt vmcnt(4)
    buffer_load_dwordx4 v[76:79], v2, s[36:39], s64 offen offset:3072 nt
    s_waitcnt vmcnt(4)
    buffer_load_dwordx4 v[80:83], v1, s[36:39], s65 offen offset:0 nt
    s_waitcnt vmcnt(4)
    buffer_load_dwordx4 v[84:87], v1, s[36:39], s65 offen offset:1024 nt
    s_waitcnt vmcnt(4)
    buffer_load_dwordx4 v[88:91], v1, s[36:39], s65 offen offset:2048 nt
    s_waitcnt vmcnt(4)
    buffer_load_dwordx4 v[92:95], v1, s[36:39], s65 offen offset:3072 nt
    s_waitcnt vmcnt(4)
    buffer_load_dwordx4 v[96:99], v2, s[36:39], s65 offen offset:0 nt
    s_waitcnt vmcnt(4)
    buffer_load_dwordx4 v[100:103], v2, s[36:39], s65 offen offset:1024 nt
    s_waitcnt vmcnt(4)
    buffer_load_dwordx4 v[104:107], v2, s[36:39], s65 offen offset:2048 nt
    s_waitcnt vmcnt(4)
    buffer_load_dwordx4 v[108:111], v2, s[36:39], s65 offen offset:3072 nt
    s_waitcnt vmcnt(4)
    buffer_load_dwordx4 v[112:115], v1, s[36:39], s66 offen offset:0 nt
    s_waitcnt vmcnt(4)
    buffer_load_dwordx4 v[116:119], v1, s[36:39], s66 offen offset:1024 nt
    s_waitcnt vmcnt(4)
    buffer_load_dwordx4 v[120:123], v1, s[36:39], s66 offen offset:2048 nt
    s_waitcnt vmcnt(4)
    buffer_load_dwordx4 v[124:127], v1, s[36:39], s66 offen offset:3072 nt
    s_waitcnt vmcnt(4)
    buffer_load_dwordx4 v[128:131], v2, s[36:39], s66 offen offset:0 nt
    s_waitcnt vmcnt(4)
    buffer_load_dwordx4 v[132:135], v2, s[36:39], s66 offen offset:1024 nt
    s_waitcnt vmcnt(4)
    buffer_load_dwordx4 v[136:139], v2, s[36:39], s66 offen offset:2048 nt
    s_waitcnt vmcnt(4)
    buffer_load_dwordx4 v[140:143], v2, s[36:39], s66 offen offset:3072 nt
    s_waitcnt vmcnt(4)
    buffer_load_dwordx4 v[144:147], v1, s[36:39], s67 offen offset:0 nt
    s_waitcnt vmcnt(4)
    buffer_load_dwordx4 v[148:151], v1, s[36:39], s67 offen offset:1024 nt
    s_waitcnt vmcnt(4)
    buffer_load_dwordx4 v[152:155], v1, s[36:39], s67 offen offset:2048 nt
    s_waitcnt vmcnt(4)
    buffer_load_dwordx4 v[156:159], v1, s[36:39], s67 offen offset:3072 nt
    s_waitcnt vmcnt(4)
    buffer_load_dwordx4 v[160:163], v2, s[36:39], s67 offen offset:0 nt
    s_waitcnt vmcnt(4)
    buffer_load_dwordx4 v[164:167], v2, s[36:39], s67 offen offset:1024 nt
    s_waitcnt vmcnt(4)
    buffer_load_dwordx4 v[168:171], v2, s[36:39], s67 offen offset:2048 nt
    s_waitcnt vmcnt(4)
    buffer_load_dwordx4 v[172:175], v2, s[36:39], s67 offen offset:3072 nt
    s_waitcnt vmcnt(4)
    buffer_load_dwordx4 v[176:179], v1, s[36:39], s68 offen offset:0 nt
    s_waitcnt vmcnt(4)
    buffer_load_dwordx4 v[180:183], v1, s[36:39], s68 offen offset:1024 nt
    s_waitcnt vmcnt(4)
    buffer_load_dwordx4 v[184:187], v1, s[36:39], s68 offen offset:2048 nt
    s_waitcnt vmcnt(4)
    buffer_load_dwordx4 v[188:191], v1, s[36:39], s68 offen offset:3072 nt
    s_waitcnt vmcnt(4)
    buffer_load_dwordx4 v[192:195], v2, s[36:39], s68 offen offset:0 nt
    s_waitcnt vmcnt(4)
    buffer_load_dwordx4 v[196:199], v2, s[36:39], s68 offen offset:1024 nt
    s_waitcnt vmcnt(4)
    buffer_load_dwordx4 v[200:203], v2, s[36:39], s68 offen offset:2048 nt
    s_waitcnt vmcnt(4)
    buffer_load_dwordx4 v[204:207], v2, s[36:39], s68 offen offset:3072 nt
    s_waitcnt vmcnt(4)
    buffer_load_dwordx4 v[208:211], v1, s[36:39], s69 offen offset:0 nt
    s_waitcnt vmcnt(4)
    buffer_load_dwordx4 v[212:215], v1, s[36:39], s69 offen offset:1024 nt
    s_waitcnt vmcnt(4)
    buffer_load_dwordx4 v[216:219], v1, s[36:39], s69 offen offset:2048 nt
    s_waitcnt vmcnt(4)
    buffer_load_dwordx4 v[220:223], v1, s[36:39], s69 offen offset:3072 nt
    s_waitcnt vmcnt(4)
    buffer_load_dwordx4 v[224:227], v2, s[36:39], s69 offen offset:0 nt
    buffer_load_dwordx4 v[228:231], v2, s[36:39], s69 offen offset:1024 nt
    buffer_load_dwordx4 v[232:235], v2, s[36:39], s69 offen offset:2048 nt
    s_barrier
    ds_read_b128 v[8:11], v27 offset:0
    s_waitcnt lgkmcnt(0)
    s_add_u32 s62, s62, 0x9e3779b9
    v_dot2_f32_bf16 v32, v48, v8, 0
    v_dot2_f32_bf16 v32, v49, v9, v32
    v_dot2_f32_bf16 v32, v50, v10, v32
    v_dot2_f32_bf16 v32, v51, v11, v32
    v_dot2_f32_bf16 v33, v52, v8, 0
    v_dot2_f32_bf16 v33, v53, v9, v33
    v_dot2_f32_bf16 v33, v54, v10, v33
    v_dot2_f32_bf16 v33, v55, v11, v33
    v_dot2_f32_bf16 v34, v56, v8, 0
    v_dot2_f32_bf16 v34, v57, v9, v34
    v_dot2_f32_bf16 v34, v58, v10, v34
    v_dot2_f32_bf16 v34, v59, v11, v34
    v_dot2_f32_bf16 v35, v60, v8, 0
    v_dot2_f32_bf16 v35, v61, v9, v35
    v_dot2_f32_bf16 v35, v62, v10, v35
    v_dot2_f32_bf16 v35, v63, v11, v35
    v_dot2_f32_bf16 v36, v64, v8, 0
    v_dot2_f32_bf16 v36, v65, v9, v36
    v_dot2_f32_bf16 v36, v66, v10, v36
    v_dot2_f32_bf16 v36, v67, v11, v36
    v_dot2_f32_bf16 v37, v68, v8, 0
    v_dot2_f32_bf16 v37, v69, v9, v37
    v_dot2_f32_bf16 v37, v70, v10, v37
    v_dot2_f32_bf16 v37, v71, v11, v37
    v_dot2_f32_bf16 v38, v72, v8, 0
    v_dot2_f32_bf16 v38, v73, v9, v38
    v_dot2_f32_bf16 v38, v74, v10, v38
    v_dot2_f32_bf16 v38, v75, v11, v38
    v_dot2_f32_bf16 v39, v76, v8, 0
    v_dot2_f32_bf16 v39, v77, v9, v39
    v_dot2_f32_bf16 v39, v78, v10, v39
    v_dot2_f32_bf16 v39, v79, v11, v39
    v_dot2_f32_bf16 v40, v80, v8, 0
    v_dot2_f32_bf16 v40, v81, v9, v40
    v_dot2_f32_bf16 v40, v82, v10, v40
    v_dot2_f32_bf16 v40, v83, v11, v40
    v_dot2_f32_bf16 v41, v84, v8, 0
    v_dot2_f32_bf16 v41, v85, v9, v41
    v_dot2_f32_bf16 v41, v86, v10, v41
    v_dot2_f32_bf16 v41, v87, v11, v41
    v_dot2_f32_bf16 v42, v88, v8, 0
    v_dot2_f32_bf16 v42, v89, v9, v42
    v_dot2_f32_bf16 v42, v90, v10, v42
    v_dot2_f32_bf16 v42, v91, v11, v42
    v_dot2_f32_bf16 v43, v92, v8, 0
    v_dot2_f32_bf16 v43, v93, v9, v43
    v_dot2_f32_bf16 v43, v94, v10, v43
    v_dot2_f32_bf16 v43, v95, v11, v43
    s_waitcnt vmcnt(4)
    buffer_load_dwordx4 v[236:239], v2, s[36:39], s69 offen offset:3072 nt
    v_dot2_f32_bf16 v44, v96, v8, 0
    v_dot2_f32_bf16 v44, v97, v9, v44
    v_dot2_f32_bf16 v44, v98, v10, v44
    v_dot2_f32_bf16 v44, v99, v11, v44
    v_dot2_f32_bf16 v45, v100, v8, 0
    v_dot2_f32_bf16 v45, v101, v9, v45
    v_dot2_f32_bf16 v45, v102, v10, v45
    v_dot2_f32_bf16 v45, v103, v11, v45
    v_dot2_f32_bf16 v46, v104, v8, 0
    v_dot2_f32_bf16 v46, v105, v9, v46
    v_dot2_f32_bf16 v46, v106, v10, v46
    v_dot2_f32_bf16 v46, v107, v11, v46
    s_cmp_eq_u32 s35, 0
    s_cselect_b64 s[36:37], s[36:37], s[48:49]
    buffer_load_dwordx4 v[240:243], v1, s[36:39], s70 offen offset:0 nt
    v_dot2_f32_bf16 v47, v108, v8, 0
    v_dot2_f32_bf16 v47, v109, v9, v47
    v_dot2_f32_bf16 v47, v110, v10, v47
    v_dot2_f32_bf16 v47, v111, v11, v47
    v_add_f32_dpp v32, v32, v32 row_mirror row_mask:0xf bank_mask:0xf
    v_add_f32_dpp v33, v33, v33 row_mirror row_mask:0xf bank_mask:0xf
    v_add_f32_dpp v34, v34, v34 row_mirror row_mask:0xf bank_mask:0xf
    v_add_f32_dpp v35, v35, v35 row_mirror row_mask:0xf bank_mask:0xf
    v_add_f32_dpp v36, v36, v36 row_mirror row_mask:0xf bank_mask:0xf
    v_add_f32_dpp v37, v37, v37 row_mirror row_mask:0xf bank_mask:0xf
    v_add_f32_dpp v38, v38, v38 row_mirror row_mask:0xf bank_mask:0xf
    v_add_f32_dpp v39, v39, v39 row_mirror row_mask:0xf bank_mask:0xf
    v_add_f32_dpp v32, v40, v40 row_mirror row_mask:0xf bank_mask:0xc
    v_add_f32_dpp v33, v41, v41 row_mirror row_mask:0xf bank_mask:0xc
    v_add_f32_dpp v34, v42, v42 row_mirror row_mask:0xf bank_mask:0xc
    v_add_f32_dpp v35, v43, v43 row_mirror row_mask:0xf bank_mask:0xc
    v_add_f32_dpp v36, v44, v44 row_mirror row_mask:0xf bank_mask:0xc
    v_add_f32_dpp v37, v45, v45 row_mirror row_mask:0xf bank_mask:0xc
    v_add_f32_dpp v38, v46, v46 row_mirror row_mask:0xf bank_mask:0xc
    v_add_f32_dpp v39, v47, v47 row_mirror row_mask:0xf bank_mask:0xc
    v_add_f32_dpp v32, v32, v32 row_half_mirror row_mask:0xf bank_mask:0xf
    v_add_f32_dpp v33, v33, v33 row_half_mirror row_mask:0xf bank_mask:0xf
    v_add_f32_dpp v34, v34, v34 row_half_mirror row_mask:0xf bank_mask:0xf
    v_add_f32_dpp v35, v35, v35 row_half_mirror row_mask:0xf bank_mask:0xf
    v_add_f32_dpp v32, v36, v36 row_half_mirror row_mask:0xf bank_mask:0xa
    v_add_f32_dpp v33, v37, v37 row_half_mirror row_mask:0xf bank_mask:0xa
    v_add_f32_dpp v34, v38, v38 row_half_mirror row_mask:0xf bank_mask:0xa
    v_add_f32_dpp v35, v39, v39 row_half_mirror row_mask:0xf bank_mask:0xa
    v_add_f32_dpp v32, v32, v32 quad_perm:[2,3,0,1] row_mask:0xf bank_mask:0xf
    v_add_f32_dpp v33, v33, v33 quad_perm:[2,3,0,1] row_mask:0xf bank_mask:0xf
    v_add_f32_dpp v34, v34, v34 quad_perm:[2,3,0,1] row_mask:0xf bank_mask:0xf
    v_add_f32_dpp v35, v35, v35 quad_perm:[2,3,0,1] row_mask:0xf bank_mask:0xf
    v_cndmask_b32 v32, v32, v34, s[4:5]
    v_cndmask_b32 v33, v33, v35, s[4:5]
    s_nop 0
    v_add_f32_dpp v32, v32, v32 quad_perm:[1,0,3,2] row_mask:0xf bank_mask:0xf
    v_add_f32_dpp v33, v33, v33 quad_perm:[1,0,3,2] row_mask:0xf bank_mask:0xf
    v_cndmask_b32 v22, v32, v33, s[6:7]
    v_cvt_pk_bf16_f32 v22, 0, v22
    v_mul_f32 v22, s81, v22
    v_cvt_pk_bf16_f32 v22, 0, v22
    v_dot2_f32_bf16 v32, v112, v8, 0
    v_dot2_f32_bf16 v32, v113, v9, v32
    v_dot2_f32_bf16 v32, v114, v10, v32
    v_dot2_f32_bf16 v32, v115, v11, v32
    v_dot2_f32_bf16 v33, v116, v8, 0
    v_dot2_f32_bf16 v33, v117, v9, v33
    v_dot2_f32_bf16 v33, v118, v10, v33
    v_dot2_f32_bf16 v33, v119, v11, v33
    v_dot2_f32_bf16 v34, v120, v8, 0
    v_dot2_f32_bf16 v34, v121, v9, v34
    v_dot2_f32_bf16 v34, v122, v10, v34
    v_dot2_f32_bf16 v34, v123, v11, v34
    v_dot2_f32_bf16 v35, v124, v8, 0
    v_dot2_f32_bf16 v35, v125, v9, v35
    v_dot2_f32_bf16 v35, v126, v10, v35
    v_dot2_f32_bf16 v35, v127, v11, v35
    s_waitcnt vmcnt(4)
    buffer_load_dwordx4 v[244:247], v1, s[36:39], s70 offen offset:1024 nt
    v_dot2_f32_bf16 v36, v128, v8, 0
    v_dot2_f32_bf16 v36, v129, v9, v36
    v_dot2_f32_bf16 v36, v130, v10, v36
    v_dot2_f32_bf16 v36, v131, v11, v36
    v_dot2_f32_bf16 v37, v132, v8, 0
    v_dot2_f32_bf16 v37, v133, v9, v37
    v_dot2_f32_bf16 v37, v134, v10, v37
    v_dot2_f32_bf16 v37, v135, v11, v37
    v_dot2_f32_bf16 v38, v136, v8, 0
    v_dot2_f32_bf16 v38, v137, v9, v38
    v_dot2_f32_bf16 v38, v138, v10, v38
    v_dot2_f32_bf16 v38, v139, v11, v38
    v_dot2_f32_bf16 v39, v140, v8, 0
    v_dot2_f32_bf16 v39, v141, v9, v39
    v_dot2_f32_bf16 v39, v142, v10, v39
    v_dot2_f32_bf16 v39, v143, v11, v39
    s_waitcnt vmcnt(4)
    buffer_load_dwordx4 v[248:251], v1, s[36:39], s70 offen offset:2048 nt
    v_dot2_f32_bf16 v40, v144, v8, 0
    v_dot2_f32_bf16 v40, v145, v9, v40
    v_dot2_f32_bf16 v40, v146, v10, v40
    v_dot2_f32_bf16 v40, v147, v11, v40
    v_dot2_f32_bf16 v41, v148, v8, 0
    v_dot2_f32_bf16 v41, v149, v9, v41
    v_dot2_f32_bf16 v41, v150, v10, v41
    v_dot2_f32_bf16 v41, v151, v11, v41
    v_dot2_f32_bf16 v42, v152, v8, 0
    v_dot2_f32_bf16 v42, v153, v9, v42
    v_dot2_f32_bf16 v42, v154, v10, v42
    v_dot2_f32_bf16 v42, v155, v11, v42
    v_dot2_f32_bf16 v43, v156, v8, 0
    v_dot2_f32_bf16 v43, v157, v9, v43
    v_dot2_f32_bf16 v43, v158, v10, v43
    v_dot2_f32_bf16 v43, v159, v11, v43
    s_waitcnt vmcnt(4)
    buffer_load_dwordx4 v[252:255], v1, s[36:39], s70 offen offset:3072 nt
    v_dot2_f32_bf16 v44, v160, v8, 0
    v_dot2_f32_bf16 v44, v161, v9, v44
    v_dot2_f32_bf16 v44, v162, v10, v44
    v_dot2_f32_bf16 v44, v163, v11, v44
    v_dot2_f32_bf16 v45, v164, v8, 0
    v_dot2_f32_bf16 v45, v165, v9, v45
    v_dot2_f32_bf16 v45, v166, v10, v45
    v_dot2_f32_bf16 v45, v167, v11, v45
    v_dot2_f32_bf16 v46, v168, v8, 0
    v_dot2_f32_bf16 v46, v169, v9, v46
    v_dot2_f32_bf16 v46, v170, v10, v46
    v_dot2_f32_bf16 v46, v171, v11, v46
    buffer_load_dwordx4 v[48:51], v2, s[36:39], s70 offen offset:0 nt
    v_dot2_f32_bf16 v47, v172, v8, 0
    v_dot2_f32_bf16 v47, v173, v9, v47
    v_dot2_f32_bf16 v47, v174, v10, v47
    v_dot2_f32_bf16 v47, v175, v11, v47
    v_add_f32_dpp v32, v32, v32 row_mirror row_mask:0xf bank_mask:0xf
    v_add_f32_dpp v33, v33, v33 row_mirror row_mask:0xf bank_mask:0xf
    v_add_f32_dpp v34, v34, v34 row_mirror row_mask:0xf bank_mask:0xf
    v_add_f32_dpp v35, v35, v35 row_mirror row_mask:0xf bank_mask:0xf
    v_add_f32_dpp v36, v36, v36 row_mirror row_mask:0xf bank_mask:0xf
    v_add_f32_dpp v37, v37, v37 row_mirror row_mask:0xf bank_mask:0xf
    v_add_f32_dpp v38, v38, v38 row_mirror row_mask:0xf bank_mask:0xf
    v_add_f32_dpp v39, v39, v39 row_mirror row_mask:0xf bank_mask:0xf
    v_add_f32_dpp v32, v40, v40 row_mirror row_mask:0xf bank_mask:0xc
    v_add_f32_dpp v33, v41, v41 row_mirror row_mask:0xf bank_mask:0xc
    v_add_f32_dpp v34, v42, v42 row_mirror row_mask:0xf bank_mask:0xc
    v_add_f32_dpp v35, v43, v43 row_mirror row_mask:0xf bank_mask:0xc
    v_add_f32_dpp v36, v44, v44 row_mirror row_mask:0xf bank_mask:0xc
    v_add_f32_dpp v37, v45, v45 row_mirror row_mask:0xf bank_mask:0xc
    v_add_f32_dpp v38, v46, v46 row_mirror row_mask:0xf bank_mask:0xc
    v_add_f32_dpp v39, v47, v47 row_mirror row_mask:0xf bank_mask:0xc
    v_add_f32_dpp v32, v32, v32 row_half_mirror row_mask:0xf bank_mask:0xf
    v_add_f32_dpp v33, v33, v33 row_half_mirror row_mask:0xf bank_mask:0xf
    v_add_f32_dpp v34, v34, v34 row_half_mirror row_mask:0xf bank_mask:0xf
    v_add_f32_dpp v35, v35, v35 row_half_mirror row_mask:0xf bank_mask:0xf
    v_add_f32_dpp v32, v36, v36 row_half_mirror row_mask:0xf bank_mask:0xa
    v_add_f32_dpp v33, v37, v37 row_half_mirror row_mask:0xf bank_mask:0xa
    v_add_f32_dpp v34, v38, v38 row_half_mirror row_mask:0xf bank_mask:0xa
    v_add_f32_dpp v35, v39, v39 row_half_mirror row_mask:0xf bank_mask:0xa
    v_add_f32_dpp v32, v32, v32 quad_perm:[2,3,0,1] row_mask:0xf bank_mask:0xf
    v_add_f32_dpp v33, v33, v33 quad_perm:[2,3,0,1] row_mask:0xf bank_mask:0xf
    v_add_f32_dpp v34, v34, v34 quad_perm:[2,3,0,1] row_mask:0xf bank_mask:0xf
    v_add_f32_dpp v35, v35, v35 quad_perm:[2,3,0,1] row_mask:0xf bank_mask:0xf
    v_cndmask_b32 v32, v32, v34, s[4:5]
    v_cndmask_b32 v33, v33, v35, s[4:5]
    s_nop 0
    v_add_f32_dpp v32, v32, v32 quad_perm:[1,0,3,2] row_mask:0xf bank_mask:0xf
    v_add_f32_dpp v33, v33, v33 quad_perm:[1,0,3,2] row_mask:0xf bank_mask:0xf
    v_cndmask_b32 v23, v32, v33, s[6:7]
    v_cvt_pk_bf16_f32 v23, 0, v23
    v_mul_f32 v23, s81, v23
    v_cvt_pk_bf16_f32 v23, 0, v23
    v_dot2_f32_bf16 v32, v176, v8, 0
    v_dot2_f32_bf16 v32, v177, v9, v32
    v_dot2_f32_bf16 v32, v178, v10, v32
    v_dot2_f32_bf16 v32, v179, v11, v32
    v_dot2_f32_bf16 v33, v180, v8, 0
    v_dot2_f32_bf16 v33, v181, v9, v33
    v_dot2_f32_bf16 v33, v182, v10, v33
    v_dot2_f32_bf16 v33, v183, v11, v33
    v_dot2_f32_bf16 v34, v184, v8, 0
    v_dot2_f32_bf16 v34, v185, v9, v34
    v_dot2_f32_bf16 v34, v186, v10, v34
    v_dot2_f32_bf16 v34, v187, v11, v34
    v_dot2_f32_bf16 v35, v188, v8, 0
    v_dot2_f32_bf16 v35, v189, v9, v35
    v_dot2_f32_bf16 v35, v190, v10, v35
    v_dot2_f32_bf16 v35, v191, v11, v35
    s_waitcnt vmcnt(4)
    buffer_load_dwordx4 v[52:55], v2, s[36:39], s70 offen offset:1024 nt
    v_dot2_f32_bf16 v36, v192, v8, 0
    v_dot2_f32_bf16 v36, v193, v9, v36
    v_dot2_f32_bf16 v36, v194, v10, v36
    v_dot2_f32_bf16 v36, v195, v11, v36
    v_dot2_f32_bf16 v37, v196, v8, 0
    v_dot2_f32_bf16 v37, v197, v9, v37
    v_dot2_f32_bf16 v37, v198, v10, v37
    v_dot2_f32_bf16 v37, v199, v11, v37
    v_dot2_f32_bf16 v38, v200, v8, 0
    v_dot2_f32_bf16 v38, v201, v9, v38
    v_dot2_f32_bf16 v38, v202, v10, v38
    v_dot2_f32_bf16 v38, v203, v11, v38
    v_dot2_f32_bf16 v39, v204, v8, 0
    v_dot2_f32_bf16 v39, v205, v9, v39
    v_dot2_f32_bf16 v39, v206, v10, v39
    v_dot2_f32_bf16 v39, v207, v11, v39
    s_waitcnt vmcnt(4)
    buffer_load_dwordx4 v[56:59], v2, s[36:39], s70 offen offset:2048 nt
    v_dot2_f32_bf16 v40, v208, v8, 0
    v_dot2_f32_bf16 v40, v209, v9, v40
    v_dot2_f32_bf16 v40, v210, v10, v40
    v_dot2_f32_bf16 v40, v211, v11, v40
    v_dot2_f32_bf16 v41, v212, v8, 0
    v_dot2_f32_bf16 v41, v213, v9, v41
    v_dot2_f32_bf16 v41, v214, v10, v41
    v_dot2_f32_bf16 v41, v215, v11, v41
    v_dot2_f32_bf16 v42, v216, v8, 0
    v_dot2_f32_bf16 v42, v217, v9, v42
    v_dot2_f32_bf16 v42, v218, v10, v42
    v_dot2_f32_bf16 v42, v219, v11, v42
    v_dot2_f32_bf16 v43, v220, v8, 0
    v_dot2_f32_bf16 v43, v221, v9, v43
    v_dot2_f32_bf16 v43, v222, v10, v43
    v_dot2_f32_bf16 v43, v223, v11, v43
    s_waitcnt vmcnt(4)
    buffer_load_dwordx4 v[60:63], v2, s[36:39], s70 offen offset:3072 nt
    v_dot2_f32_bf16 v44, v224, v8, 0
    v_dot2_f32_bf16 v44, v225, v9, v44
    v_dot2_f32_bf16 v44, v226, v10, v44
    v_dot2_f32_bf16 v44, v227, v11, v44
    v_dot2_f32_bf16 v45, v228, v8, 0
    v_dot2_f32_bf16 v45, v229, v9, v45
    v_dot2_f32_bf16 v45, v230, v10, v45
    v_dot2_f32_bf16 v45, v231, v11, v45
    v_dot2_f32_bf16 v46, v232, v8, 0
    v_dot2_f32_bf16 v46, v233, v9, v46
    v_dot2_f32_bf16 v46, v234, v10, v46
    v_dot2_f32_bf16 v46, v235, v11, v46
    buffer_load_dwordx4 v[64:67], v1, s[36:39], s71 offen offset:0 nt
    v_dot2_f32_bf16 v47, v236, v8, 0
    v_dot2_f32_bf16 v47, v237, v9, v47
    v_dot2_f32_bf16 v47, v238, v10, v47
    v_dot2_f32_bf16 v47, v239, v11, v47
    ds_read_b128 v[8:11], v3 offset:0
    v_add_f32_dpp v32, v32, v32 row_mirror row_mask:0xf bank_mask:0xf
    v_add_f32_dpp v33, v33, v33 row_mirror row_mask:0xf bank_mask:0xf
    v_add_f32_dpp v34, v34, v34 row_mirror row_mask:0xf bank_mask:0xf
    v_add_f32_dpp v35, v35, v35 row_mirror row_mask:0xf bank_mask:0xf
    v_add_f32_dpp v36, v36, v36 row_mirror row_mask:0xf bank_mask:0xf
    v_add_f32_dpp v37, v37, v37 row_mirror row_mask:0xf bank_mask:0xf
    v_add_f32_dpp v38, v38, v38 row_mirror row_mask:0xf bank_mask:0xf
    v_add_f32_dpp v39, v39, v39 row_mirror row_mask:0xf bank_mask:0xf
    v_add_f32_dpp v32, v40, v40 row_mirror row_mask:0xf bank_mask:0xc
    v_add_f32_dpp v33, v41, v41 row_mirror row_mask:0xf bank_mask:0xc
    v_add_f32_dpp v34, v42, v42 row_mirror row_mask:0xf bank_mask:0xc
    v_add_f32_dpp v35, v43, v43 row_mirror row_mask:0xf bank_mask:0xc
    v_add_f32_dpp v36, v44, v44 row_mirror row_mask:0xf bank_mask:0xc
    v_add_f32_dpp v37, v45, v45 row_mirror row_mask:0xf bank_mask:0xc
    v_add_f32_dpp v38, v46, v46 row_mirror row_mask:0xf bank_mask:0xc
    v_add_f32_dpp v39, v47, v47 row_mirror row_mask:0xf bank_mask:0xc
    v_add_f32_dpp v32, v32, v32 row_half_mirror row_mask:0xf bank_mask:0xf
    v_add_f32_dpp v33, v33, v33 row_half_mirror row_mask:0xf bank_mask:0xf
    v_add_f32_dpp v34, v34, v34 row_half_mirror row_mask:0xf bank_mask:0xf
    v_add_f32_dpp v35, v35, v35 row_half_mirror row_mask:0xf bank_mask:0xf
    v_add_f32_dpp v32, v36, v36 row_half_mirror row_mask:0xf bank_mask:0xa
    v_add_f32_dpp v33, v37, v37 row_half_mirror row_mask:0xf bank_mask:0xa
    v_add_f32_dpp v34, v38, v38 row_half_mirror row_mask:0xf bank_mask:0xa
    v_add_f32_dpp v35, v39, v39 row_half_mirror row_mask:0xf bank_mask:0xa
    v_add_f32_dpp v32, v32, v32 quad_perm:[2,3,0,1] row_mask:0xf bank_mask:0xf
    v_add_f32_dpp v33, v33, v33 quad_perm:[2,3,0,1] row_mask:0xf bank_mask:0xf
    v_add_f32_dpp v34, v34, v34 quad_perm:[2,3,0,1] row_mask:0xf bank_mask:0xf
    v_add_f32_dpp v35, v35, v35 quad_perm:[2,3,0,1] row_mask:0xf bank_mask:0xf
    v_cndmask_b32 v32, v32, v34, s[4:5]
    v_cndmask_b32 v33, v33, v35, s[4:5]
    s_nop 0
    v_add_f32_dpp v32, v32, v32 quad_perm:[1,0,3,2] row_mask:0xf bank_mask:0xf
    v_add_f32_dpp v33, v33, v33 quad_perm:[1,0,3,2] row_mask:0xf bank_mask:0xf
    v_cndmask_b32 v24, v32, v33, s[6:7]
    v_cvt_pk_bf16_f32 v24, 0, v24
    v_mul_f32 v24, s81, v24
    v_cvt_pk_bf16_f32 v24, 0, v24
    s_waitcnt lgkmcnt(0)
    v_dot2_f32_bf16 v32, v240, v8, 0
    v_dot2_f32_bf16 v32, v241, v9, v32
    v_dot2_f32_bf16 v32, v242, v10, v32
    v_dot2_f32_bf16 v32, v243, v11, v32
    v_dot2_f32_bf16 v33, v244, v8, 0
    v_dot2_f32_bf16 v33, v245, v9, v33
    v_dot2_f32_bf16 v33, v246, v10, v33
    v_dot2_f32_bf16 v33, v247, v11, v33
    v_dot2_f32_bf16 v34, v248, v8, 0
    v_dot2_f32_bf16 v34, v249, v9, v34
    v_dot2_f32_bf16 v34, v250, v10, v34
    v_dot2_f32_bf16 v34, v251, v11, v34
    s_bitcmp1_b64 s[18:19], 25
    s_cbranch_scc1 L_w57
    s_waitcnt vmcnt(5)
    s_bitcmp1_b64 s[18:19], 9
    s_cbranch_scc1 L_w57
    s_waitcnt vmcnt(4)
L_w57:
    buffer_load_dwordx4 v[68:71], v1, s[36:39], s71 offen offset:1024 nt
    s_memrealtime s[16:17]
    s_waitcnt lgkmcnt(0)
    s_sub_u32 s16, s16, s84
    s_sub_u32 s16, s16, 968
    s_mul_i32 s16, s16, 61
    s_ashr_i32 s16, s16, 8
    s_max_i32 s16, s16, 0
    s_min_i32 s16, s16, 63
    s_bfm_b64 s[18:19], s16, 0
    s_bitcmp1_b64 s[18:19], 37
    s_cbranch_scc1 L_w58
    s_waitcnt vmcnt(6)
    s_bitcmp1_b64 s[18:19], 21
    s_cbranch_scc1 L_w58
    s_waitcnt vmcnt(5)
    s_bitcmp1_b64 s[18:19], 5
    s_cbranch_scc1 L_w58
    s_waitcnt vmcnt(4)
L_w58:
    buffer_load_dwordx4 v[72:75], v1, s[36:39], s71 offen offset:2048 nt
    s_bitcmp1_b64 s[18:19], 61
    s_cbranch_scc1 L_w59
    s_waitcnt vmcnt(7)
    s_bitcmp1_b64 s[18:19], 45
    s_cbranch_scc1 L_w59
    s_waitcnt vmcnt(6)
    s_bitcmp1_b64 s[18:19], 29
    s_cbranch_scc1 L_w59
    s_waitcnt vmcnt(5)
    s_bitcmp1_b64 s[18:19], 13
    s_cbranch_scc1 L_w59
    s_waitcnt vmcnt(4)
L_w59:
    buffer_load_dwordx4 v[76:79], v1, s[36:39], s71 offen offset:3072 nt
    s_waitcnt vmcnt(8)
    s_bitcmp1_b64 s[18:19], 51
    s_cbranch_scc1 L_w60
    s_waitcnt vmcnt(7)
    s_bitcmp1_b64 s[18:19], 35
    s_cbranch_scc1 L_w60
    s_waitcnt vmcnt(6)
    s_bitcmp1_b64 s[18:19], 19
    s_cbranch_scc1 L_w60
    s_waitcnt vmcnt(5)
    s_bitcmp1_b64 s[18:19], 3
    s_cbranch_scc1 L_w60
    s_waitcnt vmcnt(4)
L_w60:
    buffer_load_dwordx4 v[80:83], v2, s[36:39], s71 offen offset:0 nt
    v_dot2_f32_bf16 v35, v252, v8, 0
    v_dot2_f32_bf16 v35, v253, v9, v35
    v_dot2_f32_bf16 v35, v254, v10, v35
    v_dot2_f32_bf16 v35, v255, v11, v35
    s_waitcnt vmcnt(8)
    s_bitcmp1_b64 s[18:19], 59
    s_cbranch_scc1 L_w61
    s_waitcnt vmcnt(7)
    s_bitcmp1_b64 s[18:19], 43
    s_cbranch_scc1 L_w61
    s_waitcnt vmcnt(6)
    s_bitcmp1_b64 s[18:19], 27
    s_cbranch_scc1 L_w61
    s_waitcnt vmcnt(5)
    s_bitcmp1_b64 s[18:19], 11
    s_cbranch_scc1 L_w61
    s_waitcnt vmcnt(4)
L_w61:
    buffer_load_dwordx4 v[84:87], v2, s[36:39], s71 offen offset:1024 nt
    v_dot2_f32_bf16 v36, v48, v8, 0
    v_dot2_f32_bf16 v36, v49, v9, v36
    v_dot2_f32_bf16 v36, v50, v10, v36
    v_dot2_f32_bf16 v36, v51, v11, v36
    s_waitcnt vmcnt(8)
    s_bitcmp1_b64 s[18:19], 55
    s_cbranch_scc1 L_w62
    s_waitcnt vmcnt(7)
    s_bitcmp1_b64 s[18:19], 39
    s_cbranch_scc1 L_w62
    s_waitcnt vmcnt(6)
    s_bitcmp1_b64 s[18:19], 23
    s_cbranch_scc1 L_w62
    s_waitcnt vmcnt(5)
    s_bitcmp1_b64 s[18:19], 7
    s_cbranch_scc1 L_w62
    s_waitcnt vmcnt(4)
L_w62:
    buffer_load_dwordx4 v[88:91], v2, s[36:39], s71 offen offset:2048 nt
    s_memrealtime s[16:17]
    v_dot2_f32_bf16 v37, v52, v8, 0
    v_dot2_f32_bf16 v37, v53, v9, v37
    v_dot2_f32_bf16 v37, v54, v10, v37
    v_dot2_f32_bf16 v37, v55, v11, v37
    s_waitcnt vmcnt(8)
    s_waitcnt lgkmcnt(0)
    s_sub_u32 s16, s16, s84
    s_sub_u32 s16, s16, 1048
    s_mul_i32 s16, s16, 61
    s_ashr_i32 s16, s16, 8
    s_max_i32 s16, s16, 0
    s_min_i32 s16, s16, 63
    s_bfm_b64 s[18:19], s16, 0
    s_bitcmp1_b64 s[18:19], 63
    s_cbranch_scc1 L_w63
    s_waitcnt vmcnt(7)
    s_bitcmp1_b64 s[18:19], 47
    s_cbranch_scc1 L_w63
    s_waitcnt vmcnt(6)
    s_bitcmp1_b64 s[18:19], 31
    s_cbranch_scc1 L_w63
    s_waitcnt vmcnt(5)
    s_bitcmp1_b64 s[18:19], 15
    s_cbranch_scc1 L_w63
    s_waitcnt vmcnt(4)
L_w63:
    buffer_load_dwordx4 v[92:95], v2, s[36:39], s71 offen offset:3072 nt
    v_dot2_f32_bf16 v38, v56, v8, 0
    v_dot2_f32_bf16 v38, v57, v9, v38
    v_dot2_f32_bf16 v38, v58, v10, v38
    v_dot2_f32_bf16 v38, v59, v11, v38
    s_waitcnt vmcnt(8)
    s_bitcmp1_b64 s[18:19], 48
    s_cbranch_scc1 L_w64
    s_waitcnt vmcnt(7)
    s_bitcmp1_b64 s[18:19], 32
    s_cbranch_scc1 L_w64
    s_waitcnt vmcnt(6)
    s_bitcmp1_b64 s[18:19], 16
    s_cbranch_scc1 L_w64
    s_waitcnt vmcnt(5)
    s_bitcmp1_b64 s[18:19], 0
    s_cbranch_scc1 L_w64
    s_waitcnt vmcnt(4)
L_w64:
    buffer_load_dwordx4 v[96:99], v1, s[36:39], s72 offen offset:0 nt
    v_dot2_f32_bf16 v39, v60, v8, 0
    v_dot2_f32_bf16 v39, v61, v9, v39
    v_dot2_f32_bf16 v39, v62, v10, v39
    v_dot2_f32_bf16 v39, v63, v11, v39
    s_waitcnt vmcnt(8)
    s_bitcmp1_b64 s[18:19], 56
    s_cbranch_scc1 L_w65
    s_waitcnt vmcnt(7)
    s_bitcmp1_b64 s[18:19], 40
    s_cbranch_scc1 L_w65
    s_waitcnt vmcnt(6)
    s_bitcmp1_b64 s[18:19], 24
    s_cbranch_scc1 L_w65
    s_waitcnt vmcnt(5)
    s_bitcmp1_b64 s[18:19], 8
    s_cbranch_scc1 L_w65
    s_waitcnt vmcnt(4)
L_w65:
    buffer_load_dwordx4 v[100:103], v1, s[36:39], s72 offen offset:1024 nt
    v_dot2_f32_bf16 v40, v64, v8, 0
    v_dot2_f32_bf16 v40, v65, v9, v40
    v_dot2_f32_bf16 v40, v66, v10, v40
    v_dot2_f32_bf16 v40, v67, v11, v40
    s_waitcnt vmcnt(8)
    s_bitcmp1_b64 s[18:19], 52
    s_cbranch_scc1 L_w66
    s_waitcnt vmcnt(7)
    s_bitcmp1_b64 s[18:19], 36
    s_cbranch_scc1 L_w66
    s_waitcnt vmcnt(6)
    s_bitcmp1_b64 s[18:19], 20
    s_cbranch_scc1 L_w66
    s_waitcnt vmcnt(5)
    s_bitcmp1_b64 s[18:19], 4
    s_cbranch_scc1 L_w66
    s_waitcnt vmcnt(4)
L_w66:
    buffer_load_dwordx4 v[104:107], v1, s[36:39], s72 offen offset:2048 nt
    v_dot2_f32_bf16 v41, v68, v8, 0
    v_dot2_f32_bf16 v41, v69, v9, v41
    v_dot2_f32_bf16 v41, v70, v10, v41
    v_dot2_f32_bf16 v41, v71, v11, v41
    s_waitcnt vmcnt(8)
    s_bitcmp1_b64 s[18:19], 60
    s_cbranch_scc1 L_w67
    s_waitcnt vmcnt(7)
    s_bitcmp1_b64 s[18:19], 44
    s_cbranch_scc1 L_w67
    s_waitcnt vmcnt(6)
    s_bitcmp1_b64 s[18:19], 28
    s_cbranch_scc1 L_w67
    s_waitcnt vmcnt(5)
    s_bitcmp1_b64 s[18:19], 12
    s_cbranch_scc1 L_w67
    s_waitcnt vmcnt(4)
L_w67:
    buffer_load_dwordx4 v[108:111], v1, s[36:39], s72 offen offset:3072 nt
    v_dot2_f32_bf16 v42, v72, v8, 0
    v_dot2_f32_bf16 v42, v73, v9, v42
    v_dot2_f32_bf16 v42, v74, v10, v42
    v_dot2_f32_bf16 v42, v75, v11, v42
    s_waitcnt vmcnt(8)
    s_bitcmp1_b64 s[18:19], 50
    s_cbranch_scc1 L_w68
    s_waitcnt vmcnt(7)
    s_bitcmp1_b64 s[18:19], 34
    s_cbranch_scc1 L_w68
    s_waitcnt vmcnt(6)
    s_bitcmp1_b64 s[18:19], 18
    s_cbranch_scc1 L_w68
    s_waitcnt vmcnt(5)
    s_bitcmp1_b64 s[18:19], 2
    s_cbranch_scc1 L_w68
    s_waitcnt vmcnt(4)
L_w68:
    buffer_load_dwordx4 v[112:115], v2, s[36:39], s72 offen offset:0 nt
    s_memrealtime s[16:17]
    v_dot2_f32_bf16 v43, v76, v8, 0
    v_dot2_f32_bf16 v43, v77, v9, v43
    v_dot2_f32_bf16 v43, v78, v10, v43
    v_dot2_f32_bf16 v43, v79, v11, v43
    s_waitcnt vmcnt(8)
    s_waitcnt lgkmcnt(0)
    s_sub_u32 s16, s16, s84
    s_sub_u32 s16, s16, 1144
    s_mul_i32 s16, s16, 61
    s_ashr_i32 s16, s16, 8
    s_max_i32 s16, s16, 0
    s_min_i32 s16, s16, 63
    s_bfm_b64 s[18:19], s16, 0
    s_bitcmp1_b64 s[18:19], 58
    s_cbranch_scc1 L_w69
    s_waitcnt vmcnt(7)
    s_bitcmp1_b64 s[18:19], 42
    s_cbranch_scc1 L_w69
    s_waitcnt vmcnt(6)
    s_bitcmp1_b64 s[18:19], 26
    s_cbranch_scc1 L_w69
    s_waitcnt vmcnt(5)
    s_bitcmp1_b64 s[18:19], 10
    s_cbranch_scc1 L_w69
    s_waitcnt vmcnt(4)
L_w69:
    buffer_load_dwordx4 v[116:119], v2, s[36:39], s72 offen offset:1024 nt
    v_dot2_f32_bf16 v44, v80, v8, 0
    v_dot2_f32_bf16 v44, v81, v9, v44
    v_dot2_f32_bf16 v44, v82, v10, v44
    v_dot2_f32_bf16 v44, v83, v11, v44
    s_waitcnt vmcnt(8)
    s_bitcmp1_b64 s[18:19], 54
    s_cbranch_scc1 L_w70
    s_waitcnt vmcnt(7)
    s_bitcmp1_b64 s[18:19], 38
    s_cbranch_scc1 L_w70
    s_waitcnt vmcnt(6)
    s_bitcmp1_b64 s[18:19], 22
    s_cbranch_scc1 L_w70
    s_waitcnt vmcnt(5)
    s_bitcmp1_b64 s[18:19], 6
    s_cbranch_scc1 L_w70
    s_waitcnt vmcnt(4)
L_w70:
    buffer_load_dwordx4 v[120:123], v2, s[36:39], s72 offen offset:2048 nt
    v_dot2_f32_bf16 v45, v84, v8, 0
    v_dot2_f32_bf16 v45, v85, v9, v45
    v_dot2_f32_bf16 v45, v86, v10, v45
    v_dot2_f32_bf16 v45, v87, v11, v45
    s_waitcnt vmcnt(8)
    s_bitcmp1_b64 s[18:19], 62
    s_cbranch_scc1 L_w71
    s_waitcnt vmcnt(7)
    s_bitcmp1_b64 s[18:19], 46
    s_cbranch_scc1 L_w71
    s_waitcnt vmcnt(6)
    s_bitcmp1_b64 s[18:19], 30
    s_cbranch_scc1 L_w71
    s_waitcnt vmcnt(5)
    s_bitcmp1_b64 s[18:19], 14
    s_cbranch_scc1 L_w71
    s_waitcnt vmcnt(4)
L_w71:
    buffer_load_dwordx4 v[124:127], v2, s[36:39], s72 offen offset:3072 nt
    v_dot2_f32_bf16 v46, v88, v8, 0
    v_dot2_f32_bf16 v46, v89, v9, v46
    v_dot2_f32_bf16 v46, v90, v10, v46
    v_dot2_f32_bf16 v46, v91, v11, v46
    s_waitcnt vmcnt(8)
    s_bitcmp1_b64 s[18:19], 49
    s_cbranch_scc1 L_w72
    s_waitcnt vmcnt(7)
    s_bitcmp1_b64 s[18:19], 33
    s_cbranch_scc1 L_w72
    s_waitcnt vmcnt(6)
    s_bitcmp1_b64 s[18:19], 17
    s_cbranch_scc1 L_w72
    s_waitcnt vmcnt(5)
    s_bitcmp1_b64 s[18:19], 1
    s_cbranch_scc1 L_w72
    s_waitcnt vmcnt(4)
L_w72:
    buffer_load_dwordx4 v[128:131], v1, s[36:39], s73 offen offset:0 nt
    buffer_load_dwordx4 v[132:135], v1, s[36:39], s73 offen offset:1024 nt
    v_dot2_f32_bf16 v47, v92, v8, 0
    v_dot2_f32_bf16 v47, v93, v9, v47
    v_dot2_f32_bf16 v47, v94, v10, v47
    v_dot2_f32_bf16 v47, v95, v11, v47
    v_add_f32_dpp v32, v32, v32 row_mirror row_mask:0xf bank_mask:0xf
    v_add_f32_dpp v33, v33, v33 row_mirror row_mask:0xf bank_mask:0xf
    v_add_f32_dpp v34, v34, v34 row_mirror row_mask:0xf bank_mask:0xf
    v_add_f32_dpp v35, v35, v35 row_mirror row_mask:0xf bank_mask:0xf
    v_add_f32_dpp v36, v36, v36 row_mirror row_mask:0xf bank_mask:0xf
    v_add_f32_dpp v37, v37, v37 row_mirror row_mask:0xf bank_mask:0xf
    v_add_f32_dpp v38, v38, v38 row_mirror row_mask:0xf bank_mask:0xf
    v_add_f32_dpp v39, v39, v39 row_mirror row_mask:0xf bank_mask:0xf
    v_add_f32_dpp v32, v40, v40 row_mirror row_mask:0xf bank_mask:0xc
    v_add_f32_dpp v33, v41, v41 row_mirror row_mask:0xf bank_mask:0xc
    v_add_f32_dpp v34, v42, v42 row_mirror row_mask:0xf bank_mask:0xc
    v_add_f32_dpp v35, v43, v43 row_mirror row_mask:0xf bank_mask:0xc
    v_add_f32_dpp v36, v44, v44 row_mirror row_mask:0xf bank_mask:0xc
    v_add_f32_dpp v37, v45, v45 row_mirror row_mask:0xf bank_mask:0xc
    v_add_f32_dpp v38, v46, v46 row_mirror row_mask:0xf bank_mask:0xc
    v_add_f32_dpp v39, v47, v47 row_mirror row_mask:0xf bank_mask:0xc
    v_add_f32_dpp v32, v32, v32 row_half_mirror row_mask:0xf bank_mask:0xf
    v_add_f32_dpp v33, v33, v33 row_half_mirror row_mask:0xf bank_mask:0xf
    v_add_f32_dpp v34, v34, v34 row_half_mirror row_mask:0xf bank_mask:0xf
    v_add_f32_dpp v35, v35, v35 row_half_mirror row_mask:0xf bank_mask:0xf
    v_add_f32_dpp v32, v36, v36 row_half_mirror row_mask:0xf bank_mask:0xa
    v_add_f32_dpp v33, v37, v37 row_half_mirror row_mask:0xf bank_mask:0xa
    v_add_f32_dpp v34, v38, v38 row_half_mirror row_mask:0xf bank_mask:0xa
    v_add_f32_dpp v35, v39, v39 row_half_mirror row_mask:0xf bank_mask:0xa
    v_add_f32_dpp v32, v32, v32 quad_perm:[2,3,0,1] row_mask:0xf bank_mask:0xf
    v_add_f32_dpp v33, v33, v33 quad_perm:[2,3,0,1] row_mask:0xf bank_mask:0xf
    v_add_f32_dpp v34, v34, v34 quad_perm:[2,3,0,1] row_mask:0xf bank_mask:0xf
    v_add_f32_dpp v35, v35, v35 quad_perm:[2,3,0,1] row_mask:0xf bank_mask:0xf
    v_cndmask_b32 v32, v32, v34, s[4:5]
    v_cndmask_b32 v33, v33, v35, s[4:5]
    s_nop 0
    v_add_f32_dpp v32, v32, v32 quad_perm:[1,0,3,2] row_mask:0xf bank_mask:0xf
    v_add_f32_dpp v33, v33, v33 quad_perm:[1,0,3,2] row_mask:0xf bank_mask:0xf
    v_cndmask_b32 v25, v32, v33, s[6:7]
    v_cvt_pk_bf16_f32 v25, 0, v25
    v_mul_f32 v25, s81, v25
    v_cvt_pk_bf16_f32 v25, 0, v25
    s_waitcnt vmcnt(8)
    s_bitcmp1_b64 s[18:19], 53
    s_cbranch_scc1 L_w74
    s_waitcnt vmcnt(7)
    s_bitcmp1_b64 s[18:19], 37
    s_cbranch_scc1 L_w74
    s_waitcnt vmcnt(6)
    s_bitcmp1_b64 s[18:19], 21
    s_cbranch_scc1 L_w74
    s_waitcnt vmcnt(5)
    s_bitcmp1_b64 s[18:19], 5
    s_cbranch_scc1 L_w74
    s_waitcnt vmcnt(4)
L_w74:
    buffer_load_dwordx4 v[136:139], v1, s[36:39], s73 offen offset:2048 nt
    s_memrealtime s[16:17]
    v_dot2_f32_bf16 v32, v96, v8, 0
    v_dot2_f32_bf16 v32, v97, v9, v32
    v_dot2_f32_bf16 v32, v98, v10, v32
    v_dot2_f32_bf16 v32, v99, v11, v32
    v_dot2_f32_bf16 v33, v100, v8, 0
    v_dot2_f32_bf16 v33, v101, v9, v33
    v_dot2_f32_bf16 v33, v102, v10, v33
    v_dot2_f32_bf16 v33, v103, v11, v33
    s_waitcnt vmcnt(8)
    s_waitcnt lgkmcnt(0)
    s_sub_u32 s16, s16, s84
    s_sub_u32 s16, s16, 1240
    s_mul_i32 s16, s16, 61
    s_ashr_i32 s16, s16, 8
    s_max_i32 s16, s16, 0
    s_min_i32 s16, s16, 63
    s_bfm_b64 s[18:19], s16, 0
    s_bitcmp1_b64 s[18:19], 61
    s_cbranch_scc1 L_w75
    s_waitcnt vmcnt(7)
    s_bitcmp1_b64 s[18:19], 45
    s_cbranch_scc1 L_w75
    s_waitcnt vmcnt(6)
    s_bitcmp1_b64 s[18:19], 29
    s_cbranch_scc1 L_w75
    s_waitcnt vmcnt(5)
    s_bitcmp1_b64 s[18:19], 13
    s_cbranch_scc1 L_w75
    s_waitcnt vmcnt(4)
L_w75:
    buffer_load_dwordx4 v[140:143], v1, s[36:39], s73 offen offset:3072 nt
    v_dot2_f32_bf16 v34, v104, v8, 0
    v_dot2_f32_bf16 v34, v105, v9, v34
    v_dot2_f32_bf16 v34, v106, v10, v34
    v_dot2_f32_bf16 v34, v107, v11, v34
    s_waitcnt vmcnt(8)
    s_bitcmp1_b64 s[18:19], 51
    s_cbranch_scc1 L_w76
    s_waitcnt vmcnt(7)
    s_bitcmp1_b64 s[18:19], 35
    s_cbranch_scc1 L_w76
    s_waitcnt vmcnt(6)
    s_bitcmp1_b64 s[18:19], 19
    s_cbranch_scc1 L_w76
    s_waitcnt vmcnt(5)
    s_bitcmp1_b64 s[18:19], 3
    s_cbranch_scc1 L_w76
    s_waitcnt vmcnt(4)
L_w76:
    buffer_load_dwordx4 v[144:147], v2, s[36:39], s73 offen offset:0 nt
    v_dot2_f32_bf16 v35, v108, v8, 0
    v_dot2_f32_bf16 v35, v109, v9, v35
    v_dot2_f32_bf16 v35, v110, v10, v35
    v_dot2_f32_bf16 v35, v111, v11, v35
    s_waitcnt vmcnt(8)
    s_bitcmp1_b64 s[18:19], 59
    s_cbranch_scc1 L_w77
    s_waitcnt vmcnt(7)
    s_bitcmp1_b64 s[18:19], 43
    s_cbranch_scc1 L_w77
    s_waitcnt vmcnt(6)
    s_bitcmp1_b64 s[18:19], 27
    s_cbranch_scc1 L_w77
    s_waitcnt vmcnt(5)
    s_bitcmp1_b64 s[18:19], 11
    s_cbranch_scc1 L_w77
    s_waitcnt vmcnt(4)
L_w77:
    buffer_load_dwordx4 v[148:151], v2, s[36:39], s73 offen offset:1024 nt
    v_dot2_f32_bf16 v36, v112, v8, 0
    v_dot2_f32_bf16 v36, v113, v9, v36
    v_dot2_f32_bf16 v36, v114, v10, v36
    v_dot2_f32_bf16 v36, v115, v11, v36
    s_waitcnt vmcnt(8)
    s_bitcmp1_b64 s[18:19], 55
    s_cbranch_scc1 L_w78
    s_waitcnt vmcnt(7)
    s_bitcmp1_b64 s[18:19], 39
    s_cbranch_scc1 L_w78
    s_waitcnt vmcnt(6)
    s_bitcmp1_b64 s[18:19], 23
    s_cbranch_scc1 L_w78
    s_waitcnt vmcnt(5)
    s_bitcmp1_b64 s[18:19], 7
    s_cbranch_scc1 L_w78
    s_waitcnt vmcnt(4)
L_w78:
    buffer_load_dwordx4 v[152:155], v2, s[36:39], s73 offen offset:2048 nt
    v_dot2_f32_bf16 v37, v116, v8, 0
    v_dot2_f32_bf16 v37, v117, v9, v37
    v_dot2_f32_bf16 v37, v118, v10, v37
    v_dot2_f32_bf16 v37, v119, v11, v37
    s_waitcnt vmcnt(8)
    s_bitcmp1_b64 s[18:19], 63
    s_cbranch_scc1 L_w79
    s_waitcnt vmcnt(7)
    s_bitcmp1_b64 s[18:19], 47
    s_cbranch_scc1 L_w79
    s_waitcnt vmcnt(6)
    s_bitcmp1_b64 s[18:19], 31
    s_cbranch_scc1 L_w79
    s_waitcnt vmcnt(5)
    s_bitcmp1_b64 s[18:19], 15
    s_cbranch_scc1 L_w79
    s_waitcnt vmcnt(4)
L_w79:
    buffer_load_dwordx4 v[156:159], v2, s[36:39], s73 offen offset:3072 nt
    v_dot2_f32_bf16 v38, v120, v8, 0
    v_dot2_f32_bf16 v38, v121, v9, v38
    v_dot2_f32_bf16 v38, v122, v10, v38
    v_dot2_f32_bf16 v38, v123, v11, v38
    s_waitcnt vmcnt(8)
    s_bitcmp1_b64 s[18:19], 48
    s_cbranch_scc1 L_w80
    s_waitcnt vmcnt(7)
    s_bitcmp1_b64 s[18:19], 32
    s_cbranch_scc1 L_w80
    s_waitcnt vmcnt(6)
    s_bitcmp1_b64 s[18:19], 16
    s_cbranch_scc1 L_w80
    s_waitcnt vmcnt(5)
    s_bitcmp1_b64 s[18:19], 0
    s_cbranch_scc1 L_w80
    s_waitcnt vmcnt(4)
L_w80:
    buffer_load_dwordx4 v[160:163], v1, s[48:51], s64 offen offset:0 nt
    s_memrealtime s[16:17]
    v_dot2_f32_bf16 v39, v124, v8, 0
    v_dot2_f32_bf16 v39, v125, v9, v39
    v_dot2_f32_bf16 v39, v126, v10, v39
    v_dot2_f32_bf16 v39, v127, v11, v39
    s_waitcnt vmcnt(8)
    s_waitcnt lgkmcnt(0)
    s_sub_u32 s16, s16, s84
    s_sub_u32 s16, s16, 1336
    s_mul_i32 s16, s16, 61
    s_ashr_i32 s16, s16, 8
    s_max_i32 s16, s16, 0
    s_min_i32 s16, s16, 63
    s_bfm_b64 s[18:19], s16, 0
    s_bitcmp1_b64 s[18:19], 56
    s_cbranch_scc1 L_w81
    s_waitcnt vmcnt(7)
    s_bitcmp1_b64 s[18:19], 40
    s_cbranch_scc1 L_w81
    s_waitcnt vmcnt(6)
    s_bitcmp1_b64 s[18:19], 24
    s_cbranch_scc1 L_w81
    s_waitcnt vmcnt(5)
    s_bitcmp1_b64 s[18:19], 8
    s_cbranch_scc1 L_w81
    s_waitcnt vmcnt(4)
L_w81:
    buffer_load_dwordx4 v[164:167], v1, s[48:51], s64 offen offset:1024 nt
    v_dot2_f32_bf16 v40, v128, v8, 0
    v_dot2_f32_bf16 v40, v129, v9, v40
    v_dot2_f32_bf16 v40, v130, v10, v40
    v_dot2_f32_bf16 v40, v131, v11, v40
    s_waitcnt vmcnt(8)
    s_bitcmp1_b64 s[18:19], 52
    s_cbranch_scc1 L_w82
    s_waitcnt vmcnt(7)
    s_bitcmp1_b64 s[18:19], 36
    s_cbranch_scc1 L_w82
    s_waitcnt vmcnt(6)
    s_bitcmp1_b64 s[18:19], 20
    s_cbranch_scc1 L_w82
    s_waitcnt vmcnt(5)
    s_bitcmp1_b64 s[18:19], 4
    s_cbranch_scc1 L_w82
    s_waitcnt vmcnt(4)
L_w82:
    buffer_load_dwordx4 v[168:171], v1, s[48:51], s64 offen offset:2048 nt
    v_dot2_f32_bf16 v41, v132, v8, 0
    v_dot2_f32_bf16 v41, v133, v9, v41
    v_dot2_f32_bf16 v41, v134, v10, v41
    v_dot2_f32_bf16 v41, v135, v11, v41
    s_waitcnt vmcnt(8)
    s_bitcmp1_b64 s[18:19], 60
    s_cbranch_scc1 L_w83
    s_waitcnt vmcnt(7)
    s_bitcmp1_b64 s[18:19], 44
    s_cbranch_scc1 L_w83
    s_waitcnt vmcnt(6)
    s_bitcmp1_b64 s[18:19], 28
    s_cbranch_scc1 L_w83
    s_waitcnt vmcnt(5)
    s_bitcmp1_b64 s[18:19], 12
    s_cbranch_scc1 L_w83
    s_waitcnt vmcnt(4)
L_w83:
    buffer_load_dwordx4 v[172:175], v1, s[48:51], s64 offen offset:3072 nt
    v_dot2_f32_bf16 v42, v136, v8, 0
    v_dot2_f32_bf16 v42, v137, v9, v42
    v_dot2_f32_bf16 v42, v138, v10, v42
    v_dot2_f32_bf16 v42, v139, v11, v42
    s_waitcnt vmcnt(8)
    s_bitcmp1_b64 s[18:19], 50
    s_cbranch_scc1 L_w84
    s_waitcnt vmcnt(7)
    s_bitcmp1_b64 s[18:19], 34
    s_cbranch_scc1 L_w84
    s_waitcnt vmcnt(6)
    s_bitcmp1_b64 s[18:19], 18
    s_cbranch_scc1 L_w84
    s_waitcnt vmcnt(5)
    s_bitcmp1_b64 s[18:19], 2
    s_cbranch_scc1 L_w84
    s_waitcnt vmcnt(4)
L_w84:
    buffer_load_dwordx4 v[176:179], v2, s[48:51], s64 offen offset:0 nt
    v_dot2_f32_bf16 v43, v140, v8, 0
    v_dot2_f32_bf16 v43, v141, v9, v43
    v_dot2_f32_bf16 v43, v142, v10, v43
    v_dot2_f32_bf16 v43, v143, v11, v43
    s_waitcnt vmcnt(8)
    s_bitcmp1_b64 s[18:19], 58
    s_cbranch_scc1 L_w85
    s_waitcnt vmcnt(7)
    s_bitcmp1_b64 s[18:19], 42
    s_cbranch_scc1 L_w85
    s_waitcnt vmcnt(6)
    s_bitcmp1_b64 s[18:19], 26
    s_cbranch_scc1 L_w85
    s_waitcnt vmcnt(5)
    s_bitcmp1_b64 s[18:19], 10
    s_cbranch_scc1 L_w85
    s_waitcnt vmcnt(4)
L_w85:
    buffer_load_dwordx4 v[180:183], v2, s[48:51], s64 offen offset:1024 nt
    v_dot2_f32_bf16 v44, v144, v8, 0
    v_dot2_f32_bf16 v44, v145, v9, v44
    v_dot2_f32_bf16 v44, v146, v10, v44
    v_dot2_f32_bf16 v44, v147, v11, v44
    s_waitcnt vmcnt(8)
    s_bitcmp1_b64 s[18:19], 54
    s_cbranch_scc1 L_w86
    s_waitcnt vmcnt(7)
    s_bitcmp1_b64 s[18:19], 38
    s_cbranch_scc1 L_w86
    s_waitcnt vmcnt(6)
    s_bitcmp1_b64 s[18:19], 22
    s_cbranch_scc1 L_w86
    s_waitcnt vmcnt(5)
    s_bitcmp1_b64 s[18:19], 6
    s_cbranch_scc1 L_w86
    s_waitcnt vmcnt(4)
L_w86:
    buffer_load_dwordx4 v[184:187], v2, s[48:51], s64 offen offset:2048 nt
    s_memrealtime s[16:17]
    v_dot2_f32_bf16 v45, v148, v8, 0
    v_dot2_f32_bf16 v45, v149, v9, v45
    v_dot2_f32_bf16 v45, v150, v10, v45
    v_dot2_f32_bf16 v45, v151, v11, v45
    s_waitcnt vmcnt(8)
    s_waitcnt lgkmcnt(0)
    s_sub_u32 s16, s16, s84
    s_sub_u32 s16, s16, 1432
    s_mul_i32 s16, s16, 61
    s_ashr_i32 s16, s16, 8
    s_max_i32 s16, s16, 0
    s_min_i32 s16, s16, 63
    s_bfm_b64 s[18:19], s16, 0
    s_bitcmp1_b64 s[18:19], 62
    s_cbranch_scc1 L_w87
    s_waitcnt vmcnt(7)
    s_bitcmp1_b64 s[18:19], 46
    s_cbranch_scc1 L_w87
    s_waitcnt vmcnt(6)
    s_bitcmp1_b64 s[18:19], 30
    s_cbranch_scc1 L_w87
    s_waitcnt vmcnt(5)
    s_bitcmp1_b64 s[18:19], 14
    s_cbranch_scc1 L_w87
    s_waitcnt vmcnt(4)
L_w87:
    buffer_load_dwordx4 v[188:191], v2, s[48:51], s64 offen offset:3072 nt
    v_dot2_f32_bf16 v46, v152, v8, 0
    v_dot2_f32_bf16 v46, v153, v9, v46
    v_dot2_f32_bf16 v46, v154, v10, v46
    v_dot2_f32_bf16 v46, v155, v11, v46
    s_waitcnt vmcnt(8)
    s_bitcmp1_b64 s[18:19], 49
    s_cbranch_scc1 L_w88
    s_waitcnt vmcnt(7)
    s_bitcmp1_b64 s[18:19], 33
    s_cbranch_scc1 L_w88
    s_waitcnt vmcnt(6)
    s_bitcmp1_b64 s[18:19], 17
    s_cbranch_scc1 L_w88
    s_waitcnt vmcnt(5)
    s_bitcmp1_b64 s[18:19], 1
    s_cbranch_scc1 L_w88
    s_waitcnt vmcnt(4)
L_w88:
    buffer_load_dwordx4 v[192:195], v1, s[48:51], s65 offen offset:0 nt
    buffer_load_dwordx4 v[196:199], v1, s[48:51], s65 offen offset:1024 nt
    v_dot2_f32_bf16 v47, v156, v8, 0
    v_dot2_f32_bf16 v47, v157, v9, v47
    v_dot2_f32_bf16 v47, v158, v10, v47
    v_dot2_f32_bf16 v47, v159, v11, v47
    ds_read_b128 v[8:11], v27 offset:256
    v_add_f32_dpp v32, v32, v32 row_mirror row_mask:0xf bank_mask:0xf
    v_add_f32_dpp v33, v33, v33 row_mirror row_mask:0xf bank_mask:0xf
    v_add_f32_dpp v34, v34, v34 row_mirror row_mask:0xf bank_mask:0xf
    v_add_f32_dpp v35, v35, v35 row_mirror row_mask:0xf bank_mask:0xf
    v_add_f32_dpp v36, v36, v36 row_mirror row_mask:0xf bank_mask:0xf
    v_add_f32_dpp v37, v37, v37 row_mirror row_mask:0xf bank_mask:0xf
    v_add_f32_dpp v38, v38, v38 row_mirror row_mask:0xf bank_mask:0xf
    v_add_f32_dpp v39, v39, v39 row_mirror row_mask:0xf bank_mask:0xf
    v_add_f32_dpp v32, v40, v40 row_mirror row_mask:0xf bank_mask:0xc
    v_add_f32_dpp v33, v41, v41 row_mirror row_mask:0xf bank_mask:0xc
    v_add_f32_dpp v34, v42, v42 row_mirror row_mask:0xf bank_mask:0xc
    v_add_f32_dpp v35, v43, v43 row_mirror row_mask:0xf bank_mask:0xc
    v_add_f32_dpp v36, v44, v44 row_mirror row_mask:0xf bank_mask:0xc
    v_add_f32_dpp v37, v45, v45 row_mirror row_mask:0xf bank_mask:0xc
    v_add_f32_dpp v38, v46, v46 row_mirror row_mask:0xf bank_mask:0xc
    v_add_f32_dpp v39, v47, v47 row_mirror row_mask:0xf bank_mask:0xc
    v_add_f32_dpp v32, v32, v32 row_half_mirror row_mask:0xf bank_mask:0xf
    v_add_f32_dpp v33, v33, v33 row_half_mirror row_mask:0xf bank_mask:0xf
    v_add_f32_dpp v34, v34, v34 row_half_mirror row_mask:0xf bank_mask:0xf
    v_add_f32_dpp v35, v35, v35 row_half_mirror row_mask:0xf bank_mask:0xf
    v_add_f32_dpp v32, v36, v36 row_half_mirror row_mask:0xf bank_mask:0xa
    v_add_f32_dpp v33, v37, v37 row_half_mirror row_mask:0xf bank_mask:0xa
    v_add_f32_dpp v34, v38, v38 row_half_mirror row_mask:0xf bank_mask:0xa
    v_add_f32_dpp v35, v39, v39 row_half_mirror row_mask:0xf bank_mask:0xa
    v_add_f32_dpp v32, v32, v32 quad_perm:[2,3,0,1] row_mask:0xf bank_mask:0xf
    v_add_f32_dpp v33, v33, v33 quad_perm:[2,3,0,1] row_mask:0xf bank_mask:0xf
    v_add_f32_dpp v34, v34, v34 quad_perm:[2,3,0,1] row_mask:0xf bank_mask:0xf
    v_add_f32_dpp v35, v35, v35 quad_perm:[2,3,0,1] row_mask:0xf bank_mask:0xf
    v_cndmask_b32 v32, v32, v34, s[4:5]
    v_cndmask_b32 v33, v33, v35, s[4:5]
    s_nop 0
    v_add_f32_dpp v32, v32, v32 quad_perm:[1,0,3,2] row_mask:0xf bank_mask:0xf
    v_add_f32_dpp v33, v33, v33 quad_perm:[1,0,3,2] row_mask:0xf bank_mask:0xf
    v_cndmask_b32 v26, v32, v33, s[6:7]
    v_cvt_pk_bf16_f32 v26, 0, v26
    v_mul_f32 v26, s81, v26
    v_cvt_pk_bf16_f32 v26, 0, v26
    s_waitcnt lgkmcnt(0)
    s_waitcnt vmcnt(8)
    s_bitcmp1_b64 s[18:19], 53
    s_cbranch_scc1 L_w90
    s_waitcnt vmcnt(7)
    s_bitcmp1_b64 s[18:19], 37
    s_cbranch_scc1 L_w90
    s_waitcnt vmcnt(6)
    s_bitcmp1_b64 s[18:19], 21
    s_cbranch_scc1 L_w90
    s_waitcnt vmcnt(5)
    s_bitcmp1_b64 s[18:19], 5
    s_cbranch_scc1 L_w90
    s_waitcnt vmcnt(4)
L_w90:
    buffer_load_dwordx4 v[200:203], v1, s[48:51], s65 offen offset:2048 nt
    v_dot2_f32_bf16 v32, v160, v8, 0
    v_dot2_f32_bf16 v32, v161, v9, v32
    v_dot2_f32_bf16 v32, v162, v10, v32
    v_dot2_f32_bf16 v32, v163, v11, v32
    v_dot2_f32_bf16 v33, v164, v8, 0
    v_dot2_f32_bf16 v33, v165, v9, v33
    v_dot2_f32_bf16 v33, v166, v10, v33
    v_dot2_f32_bf16 v33, v167, v11, v33
    s_waitcnt vmcnt(8)
    s_bitcmp1_b64 s[18:19], 61
    s_cbranch_scc1 L_w91
    s_waitcnt vmcnt(7)
    s_bitcmp1_b64 s[18:19], 45
    s_cbranch_scc1 L_w91
    s_waitcnt vmcnt(6)
    s_bitcmp1_b64 s[18:19], 29
    s_cbranch_scc1 L_w91
    s_waitcnt vmcnt(5)
    s_bitcmp1_b64 s[18:19], 13
    s_cbranch_scc1 L_w91
    s_waitcnt vmcnt(4)
L_w91:
    buffer_load_dwordx4 v[204:207], v1, s[48:51], s65 offen offset:3072 nt
    v_dot2_f32_bf16 v34, v168, v8, 0
    v_dot2_f32_bf16 v34, v169, v9, v34
    v_dot2_f32_bf16 v34, v170, v10, v34
    v_dot2_f32_bf16 v34, v171, v11, v34
    s_waitcnt vmcnt(8)
    s_bitcmp1_b64 s[18:19], 51
    s_cbranch_scc1 L_w92
    s_waitcnt vmcnt(7)
    s_bitcmp1_b64 s[18:19], 35
    s_cbranch_scc1 L_w92
    s_waitcnt vmcnt(6)
    s_bitcmp1_b64 s[18:19], 19
    s_cbranch_scc1 L_w92
    s_waitcnt vmcnt(5)
    s_bitcmp1_b64 s[18:19], 3
    s_cbranch_scc1 L_w92
    s_waitcnt vmcnt(4)
L_w92:
    buffer_load_dwordx4 v[208:211], v2, s[48:51], s65 offen offset:0 nt
    s_memrealtime s[16:17]
    v_dot2_f32_bf16 v35, v172, v8, 0
    v_dot2_f32_bf16 v35, v173, v9, v35
    v_dot2_f32_bf16 v35, v174, v10, v35
    v_dot2_f32_bf16 v35, v175, v11, v35
    s_waitcnt vmcnt(8)
    s_waitcnt lgkmcnt(0)
    s_sub_u32 s16, s16, s84
    s_sub_u32 s16, s16, 1528
    s_mul_i32 s16, s16, 61
    s_ashr_i32 s16, s16, 8
    s_max_i32 s16, s16, 0
    s_min_i32 s16, s16, 63
    s_bfm_b64 s[18:19], s16, 0
    s_bitcmp1_b64 s[18:19], 59
    s_cbranch_scc1 L_w93
    s_waitcnt vmcnt(7)
    s_bitcmp1_b64 s[18:19], 43
    s_cbranch_scc1 L_w93
    s_waitcnt vmcnt(6)
    s_bitcmp1_b64 s[18:19], 27
    s_cbranch_scc1 L_w93
    s_waitcnt vmcnt(5)
    s_bitcmp1_b64 s[18:19], 11
    s_cbranch_scc1 L_w93
    s_waitcnt vmcnt(4)
L_w93:
    buffer_load_dwordx4 v[212:215], v2, s[48:51], s65 offen offset:1024 nt
    v_dot2_f32_bf16 v36, v176, v8, 0
    v_dot2_f32_bf16 v36, v177, v9, v36
    v_dot2_f32_bf16 v36, v178, v10, v36
    v_dot2_f32_bf16 v36, v179, v11, v36
    s_waitcnt vmcnt(8)
    s_bitcmp1_b64 s[18:19], 55
    s_cbranch_scc1 L_w94
    s_waitcnt vmcnt(7)
    s_bitcmp1_b64 s[18:19], 39
    s_cbranch_scc1 L_w94
    s_waitcnt vmcnt(6)
    s_bitcmp1_b64 s[18:19], 23
    s_cbranch_scc1 L_w94
    s_waitcnt vmcnt(5)
    s_bitcmp1_b64 s[18:19], 7
    s_cbranch_scc1 L_w94
    s_waitcnt vmcnt(4)
L_w94:
    buffer_load_dwordx4 v[216:219], v2, s[48:51], s65 offen offset:2048 nt
    v_dot2_f32_bf16 v37, v180, v8, 0
    v_dot2_f32_bf16 v37, v181, v9, v37
    v_dot2_f32_bf16 v37, v182, v10, v37
    v_dot2_f32_bf16 v37, v183, v11, v37
    s_waitcnt vmcnt(8)
    s_bitcmp1_b64 s[18:19], 63
    s_cbranch_scc1 L_w95
    s_waitcnt vmcnt(7)
    s_bitcmp1_b64 s[18:19], 47
    s_cbranch_scc1 L_w95
    s_waitcnt vmcnt(6)
    s_bitcmp1_b64 s[18:19], 31
    s_cbranch_scc1 L_w95
    s_waitcnt vmcnt(5)
    s_bitcmp1_b64 s[18:19], 15
    s_cbranch_scc1 L_w95
    s_waitcnt vmcnt(4)
L_w95:
    buffer_load_dwordx4 v[220:223], v2, s[48:51], s65 offen offset:3072 nt
    v_dot2_f32_bf16 v38, v184, v8, 0
    v_dot2_f32_bf16 v38, v185, v9, v38
    v_dot2_f32_bf16 v38, v186, v10, v38
    v_dot2_f32_bf16 v38, v187, v11, v38
    s_waitcnt vmcnt(8)
    s_bitcmp1_b64 s[18:19], 48
    s_cbranch_scc1 L_w96
    s_waitcnt vmcnt(7)
    s_bitcmp1_b64 s[18:19], 32
    s_cbranch_scc1 L_w96
    s_waitcnt vmcnt(6)
    s_bitcmp1_b64 s[18:19], 16
    s_cbranch_scc1 L_w96
    s_waitcnt vmcnt(5)
    s_bitcmp1_b64 s[18:19], 0
    s_cbranch_scc1 L_w96
    s_waitcnt vmcnt(4)
L_w96:
    buffer_load_dwordx4 v[224:227], v1, s[48:51], s66 offen offset:0 nt
    v_dot2_f32_bf16 v39, v188, v8, 0
    v_dot2_f32_bf16 v39, v189, v9, v39
    v_dot2_f32_bf16 v39, v190, v10, v39
    v_dot2_f32_bf16 v39, v191, v11, v39
    s_waitcnt vmcnt(8)
    s_bitcmp1_b64 s[18:19], 56
    s_cbranch_scc1 L_w97
    s_waitcnt vmcnt(7)
    s_bitcmp1_b64 s[18:19], 40
    s_cbranch_scc1 L_w97
    s_waitcnt vmcnt(6)
    s_bitcmp1_b64 s[18:19], 24
    s_cbranch_scc1 L_w97
    s_waitcnt vmcnt(5)
    s_bitcmp1_b64 s[18:19], 8
    s_cbranch_scc1 L_w97
    s_waitcnt vmcnt(4)
L_w97:
    buffer_load_dwordx4 v[228:231], v1, s[48:51], s66 offen offset:1024 nt
    v_dot2_f32_bf16 v40, v192, v8, 0
    v_dot2_f32_bf16 v40, v193, v9, v40
    v_dot2_f32_bf16 v40, v194, v10, v40
    v_dot2_f32_bf16 v40, v195, v11, v40
    s_waitcnt vmcnt(8)
    s_bitcmp1_b64 s[18:19], 52
    s_cbranch_scc1 L_w98
    s_waitcnt vmcnt(7)
    s_bitcmp1_b64 s[18:19], 36
    s_cbranch_scc1 L_w98
    s_waitcnt vmcnt(6)
    s_bitcmp1_b64 s[18:19], 20
    s_cbranch_scc1 L_w98
    s_waitcnt vmcnt(5)
    s_bitcmp1_b64 s[18:19], 4
    s_cbranch_scc1 L_w98
    s_waitcnt vmcnt(4)
L_w98:
    buffer_load_dwordx4 v[232:235], v1, s[48:51], s66 offen offset:2048 nt
    s_memrealtime s[16:17]
    v_dot2_f32_bf16 v41, v196, v8, 0
    v_dot2_f32_bf16 v41, v197, v9, v41
    v_dot2_f32_bf16 v41, v198, v10, v41
    v_dot2_f32_bf16 v41, v199, v11, v41
    s_waitcnt vmcnt(8)
    s_waitcnt lgkmcnt(0)
    s_sub_u32 s16, s16, s84
    s_sub_u32 s16, s16, 1624
    s_mul_i32 s16, s16, 61
    s_ashr_i32 s16, s16, 8
    s_max_i32 s16, s16, 0
    s_min_i32 s16, s16, 63
    s_bfm_b64 s[18:19], s16, 0
    s_bitcmp1_b64 s[18:19], 60
    s_cbranch_scc1 L_w99
    s_waitcnt vmcnt(7)
    s_bitcmp1_b64 s[18:19], 44
    s_cbranch_scc1 L_w99
    s_waitcnt vmcnt(6)
    s_bitcmp1_b64 s[18:19], 28
    s_cbranch_scc1 L_w99
    s_waitcnt vmcnt(5)
    s_bitcmp1_b64 s[18:19], 12
    s_cbranch_scc1 L_w99
    s_waitcnt vmcnt(4)
L_w99:
    buffer_load_dwordx4 v[236:239], v1, s[48:51], s66 offen offset:3072 nt
    v_dot2_f32_bf16 v42, v200, v8, 0
    v_dot2_f32_bf16 v42, v201, v9, v42
    v_dot2_f32_bf16 v42, v202, v10, v42
    v_dot2_f32_bf16 v42, v203, v11, v42
    s_waitcnt vmcnt(8)
    s_bitcmp1_b64 s[18:19], 50
    s_cbranch_scc1 L_w100
    s_waitcnt vmcnt(7)
    s_bitcmp1_b64 s[18:19], 34
    s_cbranch_scc1 L_w100
    s_waitcnt vmcnt(6)
    s_bitcmp1_b64 s[18:19], 18
    s_cbranch_scc1 L_w100
    s_waitcnt vmcnt(5)
    s_bitcmp1_b64 s[18:19], 2
    s_cbranch_scc1 L_w100
    s_waitcnt vmcnt(4)
L_w100:
    buffer_load_dwordx4 v[240:243], v2, s[48:51], s66 offen offset:0 nt
    v_dot2_f32_bf16 v43, v204, v8, 0
    v_dot2_f32_bf16 v43, v205, v9, v43
    v_dot2_f32_bf16 v43, v206, v10, v43
    v_dot2_f32_bf16 v43, v207, v11, v43
    s_waitcnt vmcnt(8)
    s_bitcmp1_b64 s[18:19], 58
    s_cbranch_scc1 L_w101
    s_waitcnt vmcnt(7)
    s_bitcmp1_b64 s[18:19], 42
    s_cbranch_scc1 L_w101
    s_waitcnt vmcnt(6)
    s_bitcmp1_b64 s[18:19], 26
    s_cbranch_scc1 L_w101
    s_waitcnt vmcnt(5)
    s_bitcmp1_b64 s[18:19], 10
    s_cbranch_scc1 L_w101
    s_waitcnt vmcnt(4)
L_w101:
    buffer_load_dwordx4 v[244:247], v2, s[48:51], s66 offen offset:1024 nt
    v_dot2_f32_bf16 v44, v208, v8, 0
    v_dot2_f32_bf16 v44, v209, v9, v44
    v_dot2_f32_bf16 v44, v210, v10, v44
    v_dot2_f32_bf16 v44, v211, v11, v44
    s_waitcnt vmcnt(8)
    s_bitcmp1_b64 s[18:19], 54
    s_cbranch_scc1 L_w102
    s_waitcnt vmcnt(7)
    s_bitcmp1_b64 s[18:19], 38
    s_cbranch_scc1 L_w102
    s_waitcnt vmcnt(6)
    s_bitcmp1_b64 s[18:19], 22
    s_cbranch_scc1 L_w102
    s_waitcnt vmcnt(5)
    s_bitcmp1_b64 s[18:19], 6
    s_cbranch_scc1 L_w102
    s_waitcnt vmcnt(4)
L_w102:
    buffer_load_dwordx4 v[248:251], v2, s[48:51], s66 offen offset:2048 nt
    v_dot2_f32_bf16 v45, v212, v8, 0
    v_dot2_f32_bf16 v45, v213, v9, v45
    v_dot2_f32_bf16 v45, v214, v10, v45
    v_dot2_f32_bf16 v45, v215, v11, v45
    s_waitcnt vmcnt(8)
    s_bitcmp1_b64 s[18:19], 62
    s_cbranch_scc1 L_w103
    s_waitcnt vmcnt(7)
    s_bitcmp1_b64 s[18:19], 46
    s_cbranch_scc1 L_w103
    s_waitcnt vmcnt(6)
    s_bitcmp1_b64 s[18:19], 30
    s_cbranch_scc1 L_w103
    s_waitcnt vmcnt(5)
    s_bitcmp1_b64 s[18:19], 14
    s_cbranch_scc1 L_w103
    s_waitcnt vmcnt(4)
L_w103:
    buffer_load_dwordx4 v[252:255], v2, s[48:51], s66 offen offset:3072 nt
    v_dot2_f32_bf16 v46, v216, v8, 0
    v_dot2_f32_bf16 v46, v217, v9, v46
    v_dot2_f32_bf16 v46, v218, v10, v46
    v_dot2_f32_bf16 v46, v219, v11, v46
    s_waitcnt vmcnt(8)
    s_bitcmp1_b64 s[18:19], 49
    s_cbranch_scc1 L_w104
    s_waitcnt vmcnt(7)
    s_bitcmp1_b64 s[18:19], 33
    s_cbranch_scc1 L_w104
    s_waitcnt vmcnt(6)
    s_bitcmp1_b64 s[18:19], 17
    s_cbranch_scc1 L_w104
    s_waitcnt vmcnt(5)
    s_bitcmp1_b64 s[18:19], 1
    s_cbranch_scc1 L_w104
    s_waitcnt vmcnt(4)
L_w104:
    buffer_load_dwordx4 v[48:51], v1, s[48:51], s67 offen offset:0 nt
    s_memrealtime s[16:17]
    buffer_load_dwordx4 v[52:55], v1, s[48:51], s67 offen offset:1024 nt
    v_dot2_f32_bf16 v47, v220, v8, 0
    v_dot2_f32_bf16 v47, v221, v9, v47
    v_dot2_f32_bf16 v47, v222, v10, v47
    v_dot2_f32_bf16 v47, v223, v11, v47
    v_add_f32_dpp v32, v32, v32 row_mirror row_mask:0xf bank_mask:0xf
    v_add_f32_dpp v33, v33, v33 row_mirror row_mask:0xf bank_mask:0xf
    v_add_f32_dpp v34, v34, v34 row_mirror row_mask:0xf bank_mask:0xf
    v_add_f32_dpp v35, v35, v35 row_mirror row_mask:0xf bank_mask:0xf
    v_add_f32_dpp v36, v36, v36 row_mirror row_mask:0xf bank_mask:0xf
    v_add_f32_dpp v37, v37, v37 row_mirror row_mask:0xf bank_mask:0xf
    v_add_f32_dpp v38, v38, v38 row_mirror row_mask:0xf bank_mask:0xf
    v_add_f32_dpp v39, v39, v39 row_mirror row_mask:0xf bank_mask:0xf
    v_add_f32_dpp v32, v40, v40 row_mirror row_mask:0xf bank_mask:0xc
    v_add_f32_dpp v33, v41, v41 row_mirror row_mask:0xf bank_mask:0xc
    v_add_f32_dpp v34, v42, v42 row_mirror row_mask:0xf bank_mask:0xc
    v_add_f32_dpp v35, v43, v43 row_mirror row_mask:0xf bank_mask:0xc
    v_add_f32_dpp v36, v44, v44 row_mirror row_mask:0xf bank_mask:0xc
    v_add_f32_dpp v37, v45, v45 row_mirror row_mask:0xf bank_mask:0xc
    v_add_f32_dpp v38, v46, v46 row_mirror row_mask:0xf bank_mask:0xc
    v_add_f32_dpp v39, v47, v47 row_mirror row_mask:0xf bank_mask:0xc
    v_add_f32_dpp v32, v32, v32 row_half_mirror row_mask:0xf bank_mask:0xf
    v_add_f32_dpp v33, v33, v33 row_half_mirror row_mask:0xf bank_mask:0xf
    v_add_f32_dpp v34, v34, v34 row_half_mirror row_mask:0xf bank_mask:0xf
    v_add_f32_dpp v35, v35, v35 row_half_mirror row_mask:0xf bank_mask:0xf
    v_add_f32_dpp v32, v36, v36 row_half_mirror row_mask:0xf bank_mask:0xa
    v_add_f32_dpp v33, v37, v37 row_half_mirror row_mask:0xf bank_mask:0xa
    v_add_f32_dpp v34, v38, v38 row_half_mirror row_mask:0xf bank_mask:0xa
    v_add_f32_dpp v35, v39, v39 row_half_mirror row_mask:0xf bank_mask:0xa
    v_add_f32_dpp v32, v32, v32 quad_perm:[2,3,0,1] row_mask:0xf bank_mask:0xf
    v_add_f32_dpp v33, v33, v33 quad_perm:[2,3,0,1] row_mask:0xf bank_mask:0xf
    v_add_f32_dpp v34, v34, v34 quad_perm:[2,3,0,1] row_mask:0xf bank_mask:0xf
    v_add_f32_dpp v35, v35, v35 quad_perm:[2,3,0,1] row_mask:0xf bank_mask:0xf
    v_cndmask_b32 v32, v32, v34, s[4:5]
    v_cndmask_b32 v33, v33, v35, s[4:5]
    s_nop 0
    v_add_f32_dpp v32, v32, v32 quad_perm:[1,0,3,2] row_mask:0xf bank_mask:0xf
    v_add_f32_dpp v33, v33, v33 quad_perm:[1,0,3,2] row_mask:0xf bank_mask:0xf
    v_cndmask_b32 v28, v32, v33, s[6:7]
    v_cvt_pk_bf16_f32 v28, 0, v28
    v_mul_f32 v28, s81, v28
    v_cvt_pk_bf16_f32 v28, 0, v28
    s_waitcnt vmcnt(8)
    s_waitcnt lgkmcnt(0)
    s_sub_u32 s16, s16, s84
    s_sub_u32 s16, s16, 1720
    s_mul_i32 s16, s16, 61
    s_ashr_i32 s16, s16, 8
    s_max_i32 s16, s16, 0
    s_min_i32 s16, s16, 63
    s_bfm_b64 s[18:19], s16, 0
    s_bitcmp1_b64 s[18:19], 53
    s_cbranch_scc1 L_w106
    s_waitcnt vmcnt(7)
    s_bitcmp1_b64 s[18:19], 37
    s_cbranch_scc1 L_w106
    s_waitcnt vmcnt(6)
    s_bitcmp1_b64 s[18:19], 21
    s_cbranch_scc1 L_w106
    s_waitcnt vmcnt(5)
    s_bitcmp1_b64 s[18:19], 5
    s_cbranch_scc1 L_w106
    s_waitcnt vmcnt(4)
L_w106:
    buffer_load_dwordx4 v[56:59], v1, s[48:51], s67 offen offset:2048 nt
    v_dot2_f32_bf16 v32, v224, v8, 0
    v_dot2_f32_bf16 v32, v225, v9, v32
    v_dot2_f32_bf16 v32, v226, v10, v32
    v_dot2_f32_bf16 v32, v227, v11, v32
    v_dot2_f32_bf16 v33, v228, v8, 0
    v_dot2_f32_bf16 v33, v229, v9, v33
    v_dot2_f32_bf16 v33, v230, v10, v33
    v_dot2_f32_bf16 v33, v231, v11, v33
    s_waitcnt vmcnt(8)
    s_bitcmp1_b64 s[18:19], 61
    s_cbranch_scc1 L_w107
    s_waitcnt vmcnt(7)
    s_bitcmp1_b64 s[18:19], 45
    s_cbranch_scc1 L_w107
    s_waitcnt vmcnt(6)
    s_bitcmp1_b64 s[18:19], 29
    s_cbranch_scc1 L_w107
    s_waitcnt vmcnt(5)
    s_bitcmp1_b64 s[18:19], 13
    s_cbranch_scc1 L_w107
    s_waitcnt vmcnt(4)
L_w107:
    buffer_load_dwordx4 v[60:63], v1, s[48:51], s67 offen offset:3072 nt
    v_dot2_f32_bf16 v34, v232, v8, 0
    v_dot2_f32_bf16 v34, v233, v9, v34
    v_dot2_f32_bf16 v34, v234, v10, v34
    v_dot2_f32_bf16 v34, v235, v11, v34
    s_waitcnt vmcnt(8)
    s_bitcmp1_b64 s[18:19], 51
    s_cbranch_scc1 L_w108
    s_waitcnt vmcnt(7)
    s_bitcmp1_b64 s[18:19], 35
    s_cbranch_scc1 L_w108
    s_waitcnt vmcnt(6)
    s_bitcmp1_b64 s[18:19], 19
    s_cbranch_scc1 L_w108
    s_waitcnt vmcnt(5)
    s_bitcmp1_b64 s[18:19], 3
    s_cbranch_scc1 L_w108
    s_waitcnt vmcnt(4)
L_w108:
    buffer_load_dwordx4 v[64:67], v2, s[48:51], s67 offen offset:0 nt
    v_dot2_f32_bf16 v35, v236, v8, 0
    v_dot2_f32_bf16 v35, v237, v9, v35
    v_dot2_f32_bf16 v35, v238, v10, v35
    v_dot2_f32_bf16 v35, v239, v11, v35
    s_waitcnt vmcnt(8)
    s_bitcmp1_b64 s[18:19], 59
    s_cbranch_scc1 L_w109
    s_waitcnt vmcnt(7)
    s_bitcmp1_b64 s[18:19], 43
    s_cbranch_scc1 L_w109
    s_waitcnt vmcnt(6)
    s_bitcmp1_b64 s[18:19], 27
    s_cbranch_scc1 L_w109
    s_waitcnt vmcnt(5)
    s_bitcmp1_b64 s[18:19], 11
    s_cbranch_scc1 L_w109
    s_waitcnt vmcnt(4)
L_w109:
    buffer_load_dwordx4 v[68:71], v2, s[48:51], s67 offen offset:1024 nt
    v_dot2_f32_bf16 v36, v240, v8, 0
    v_dot2_f32_bf16 v36, v241, v9, v36
    v_dot2_f32_bf16 v36, v242, v10, v36
    v_dot2_f32_bf16 v36, v243, v11, v36
    s_waitcnt vmcnt(8)
    s_bitcmp1_b64 s[18:19], 55
    s_cbranch_scc1 L_w110
    s_waitcnt vmcnt(7)
    s_bitcmp1_b64 s[18:19], 39
    s_cbranch_scc1 L_w110
    s_waitcnt vmcnt(6)
    s_bitcmp1_b64 s[18:19], 23
    s_cbranch_scc1 L_w110
    s_waitcnt vmcnt(5)
    s_bitcmp1_b64 s[18:19], 7
    s_cbranch_scc1 L_w110
    s_waitcnt vmcnt(4)
L_w110:
    buffer_load_dwordx4 v[72:75], v2, s[48:51], s67 offen offset:2048 nt
    s_memrealtime s[16:17]
    v_dot2_f32_bf16 v37, v244, v8, 0
    v_dot2_f32_bf16 v37, v245, v9, v37
    v_dot2_f32_bf16 v37, v246, v10, v37
    v_dot2_f32_bf16 v37, v247, v11, v37
    s_waitcnt vmcnt(8)
    s_waitcnt lgkmcnt(0)
    s_sub_u32 s16, s16, s84
    s_sub_u32 s16, s16, 1816
    s_mul_i32 s16, s16, 61
    s_ashr_i32 s16, s16, 8
    s_max_i32 s16, s16, 0
    s_min_i32 s16, s16, 63
    s_bfm_b64 s[18:19], s16, 0
    s_bitcmp1_b64 s[18:19], 63
    s_cbranch_scc1 L_w111
    s_waitcnt vmcnt(7)
    s_bitcmp1_b64 s[18:19], 47
    s_cbranch_scc1 L_w111
    s_waitcnt vmcnt(6)
    s_bitcmp1_b64 s[18:19], 31
    s_cbranch_scc1 L_w111
    s_waitcnt vmcnt(5)
    s_bitcmp1_b64 s[18:19], 15
    s_cbranch_scc1 L_w111
    s_waitcnt vmcnt(4)
L_w111:
    buffer_load_dwordx4 v[76:79], v2, s[48:51], s67 offen offset:3072 nt
    v_dot2_f32_bf16 v38, v248, v8, 0
    v_dot2_f32_bf16 v38, v249, v9, v38
    v_dot2_f32_bf16 v38, v250, v10, v38
    v_dot2_f32_bf16 v38, v251, v11, v38
    s_waitcnt vmcnt(8)
    s_bitcmp1_b64 s[18:19], 48
    s_cbranch_scc1 L_w112
    s_waitcnt vmcnt(7)
    s_bitcmp1_b64 s[18:19], 32
    s_cbranch_scc1 L_w112
    s_waitcnt vmcnt(6)
    s_bitcmp1_b64 s[18:19], 16
    s_cbranch_scc1 L_w112
    s_waitcnt vmcnt(5)
    s_bitcmp1_b64 s[18:19], 0
    s_cbranch_scc1 L_w112
    s_waitcnt vmcnt(4)
L_w112:
    buffer_load_dwordx4 v[80:83], v1, s[48:51], s68 offen offset:0 nt
    v_dot2_f32_bf16 v39, v252, v8, 0
    v_dot2_f32_bf16 v39, v253, v9, v39
    v_dot2_f32_bf16 v39, v254, v10, v39
    v_dot2_f32_bf16 v39, v255, v11, v39
    s_waitcnt vmcnt(8)
    s_bitcmp1_b64 s[18:19], 56
    s_cbranch_scc1 L_w113
    s_waitcnt vmcnt(7)
    s_bitcmp1_b64 s[18:19], 40
    s_cbranch_scc1 L_w113
    s_waitcnt vmcnt(6)
    s_bitcmp1_b64 s[18:19], 24
    s_cbranch_scc1 L_w113
    s_waitcnt vmcnt(5)
    s_bitcmp1_b64 s[18:19], 8
    s_cbranch_scc1 L_w113
    s_waitcnt vmcnt(4)
L_w113:
    buffer_load_dwordx4 v[84:87], v1, s[48:51], s68 offen offset:1024 nt
    v_dot2_f32_bf16 v40, v48, v8, 0
    v_dot2_f32_bf16 v40, v49, v9, v40
    v_dot2_f32_bf16 v40, v50, v10, v40
    v_dot2_f32_bf16 v40, v51, v11, v40
    s_waitcnt vmcnt(8)
    s_bitcmp1_b64 s[18:19], 52
    s_cbranch_scc1 L_w114
    s_waitcnt vmcnt(7)
    s_bitcmp1_b64 s[18:19], 36
    s_cbranch_scc1 L_w114
    s_waitcnt vmcnt(6)
    s_bitcmp1_b64 s[18:19], 20
    s_cbranch_scc1 L_w114
    s_waitcnt vmcnt(5)
    s_bitcmp1_b64 s[18:19], 4
    s_cbranch_scc1 L_w114
    s_waitcnt vmcnt(4)
L_w114:
    buffer_load_dwordx4 v[88:91], v1, s[48:51], s68 offen offset:2048 nt
    v_dot2_f32_bf16 v41, v52, v8, 0
    v_dot2_f32_bf16 v41, v53, v9, v41
    v_dot2_f32_bf16 v41, v54, v10, v41
    v_dot2_f32_bf16 v41, v55, v11, v41
    s_waitcnt vmcnt(8)
    s_bitcmp1_b64 s[18:19], 60
    s_cbranch_scc1 L_w115
    s_waitcnt vmcnt(7)
    s_bitcmp1_b64 s[18:19], 44
    s_cbranch_scc1 L_w115
    s_waitcnt vmcnt(6)
    s_bitcmp1_b64 s[18:19], 28
    s_cbranch_scc1 L_w115
    s_waitcnt vmcnt(5)
    s_bitcmp1_b64 s[18:19], 12
    s_cbranch_scc1 L_w115
    s_waitcnt vmcnt(4)
L_w115:
    buffer_load_dwordx4 v[92:95], v1, s[48:51], s68 offen offset:3072 nt
    v_dot2_f32_bf16 v42, v56, v8, 0
    v_dot2_f32_bf16 v42, v57, v9, v42
    v_dot2_f32_bf16 v42, v58, v10, v42
    v_dot2_f32_bf16 v42, v59, v11, v42
    s_waitcnt vmcnt(8)
    s_bitcmp1_b64 s[18:19], 50
    s_cbranch_scc1 L_w116
    s_waitcnt vmcnt(7)
    s_bitcmp1_b64 s[18:19], 34
    s_cbranch_scc1 L_w116
    s_waitcnt vmcnt(6)
    s_bitcmp1_b64 s[18:19], 18
    s_cbranch_scc1 L_w116
    s_waitcnt vmcnt(5)
    s_bitcmp1_b64 s[18:19], 2
    s_cbranch_scc1 L_w116
    s_waitcnt vmcnt(4)
L_w116:
    buffer_load_dwordx4 v[96:99], v2, s[48:51], s68 offen offset:0 nt
    s_memrealtime s[16:17]
    v_dot2_f32_bf16 v43, v60, v8, 0
    v_dot2_f32_bf16 v43, v61, v9, v43
    v_dot2_f32_bf16 v43, v62, v10, v43
    v_dot2_f32_bf16 v43, v63, v11, v43
    s_waitcnt vmcnt(8)
    s_waitcnt lgkmcnt(0)
    s_sub_u32 s16, s16, s84
    s_sub_u32 s16, s16, 1912
    s_mul_i32 s16, s16, 61
    s_ashr_i32 s16, s16, 8
    s_max_i32 s16, s16, 0
    s_min_i32 s16, s16, 63
    s_bfm_b64 s[18:19], s16, 0
    s_bitcmp1_b64 s[18:19], 58
    s_cbranch_scc1 L_w117
    s_waitcnt vmcnt(7)
    s_bitcmp1_b64 s[18:19], 42
    s_cbranch_scc1 L_w117
    s_waitcnt vmcnt(6)
    s_bitcmp1_b64 s[18:19], 26
    s_cbranch_scc1 L_w117
    s_waitcnt vmcnt(5)
    s_bitcmp1_b64 s[18:19], 10
    s_cbranch_scc1 L_w117
    s_waitcnt vmcnt(4)
L_w117:
    buffer_load_dwordx4 v[100:103], v2, s[48:51], s68 offen offset:1024 nt
    v_dot2_f32_bf16 v44, v64, v8, 0
    v_dot2_f32_bf16 v44, v65, v9, v44
    v_dot2_f32_bf16 v44, v66, v10, v44
    v_dot2_f32_bf16 v44, v67, v11, v44
    s_waitcnt vmcnt(8)
    s_bitcmp1_b64 s[18:19], 54
    s_cbranch_scc1 L_w118
    s_waitcnt vmcnt(7)
    s_bitcmp1_b64 s[18:19], 38
    s_cbranch_scc1 L_w118
    s_waitcnt vmcnt(6)
    s_bitcmp1_b64 s[18:19], 22
    s_cbranch_scc1 L_w118
    s_waitcnt vmcnt(5)
    s_bitcmp1_b64 s[18:19], 6
    s_cbranch_scc1 L_w118
    s_waitcnt vmcnt(4)
L_w118:
    buffer_load_dwordx4 v[104:107], v2, s[48:51], s68 offen offset:2048 nt
    v_dot2_f32_bf16 v45, v68, v8, 0
    v_dot2_f32_bf16 v45, v69, v9, v45
    v_dot2_f32_bf16 v45, v70, v10, v45
    v_dot2_f32_bf16 v45, v71, v11, v45
    s_waitcnt vmcnt(8)
    s_bitcmp1_b64 s[18:19], 62
    s_cbranch_scc1 L_w119
    s_waitcnt vmcnt(7)
    s_bitcmp1_b64 s[18:19], 46
    s_cbranch_scc1 L_w119
    s_waitcnt vmcnt(6)
    s_bitcmp1_b64 s[18:19], 30
    s_cbranch_scc1 L_w119
    s_waitcnt vmcnt(5)
    s_bitcmp1_b64 s[18:19], 14
    s_cbranch_scc1 L_w119
    s_waitcnt vmcnt(4)
L_w119:
    buffer_load_dwordx4 v[108:111], v2, s[48:51], s68 offen offset:3072 nt
    v_dot2_f32_bf16 v46, v72, v8, 0
    v_dot2_f32_bf16 v46, v73, v9, v46
    v_dot2_f32_bf16 v46, v74, v10, v46
    v_dot2_f32_bf16 v46, v75, v11, v46
    s_waitcnt vmcnt(8)
    s_bitcmp1_b64 s[18:19], 49
    s_cbranch_scc1 L_w120
    s_waitcnt vmcnt(7)
    s_bitcmp1_b64 s[18:19], 33
    s_cbranch_scc1 L_w120
    s_waitcnt vmcnt(6)
    s_bitcmp1_b64 s[18:19], 17
    s_cbranch_scc1 L_w120
    s_waitcnt vmcnt(5)
    s_bitcmp1_b64 s[18:19], 1
    s_cbranch_scc1 L_w120
    s_waitcnt vmcnt(4)
L_w120:
    buffer_load_dwordx4 v[112:115], v1, s[48:51], s69 offen offset:0 nt
    buffer_load_dwordx4 v[116:119], v1, s[48:51], s69 offen offset:1024 nt
    v_dot2_f32_bf16 v47, v76, v8, 0
    v_dot2_f32_bf16 v47, v77, v9, v47
    v_dot2_f32_bf16 v47, v78, v10, v47
    v_dot2_f32_bf16 v47, v79, v11, v47
    v_add_f32_dpp v32, v32, v32 row_mirror row_mask:0xf bank_mask:0xf
    v_add_f32_dpp v33, v33, v33 row_mirror row_mask:0xf bank_mask:0xf
    v_add_f32_dpp v34, v34, v34 row_mirror row_mask:0xf bank_mask:0xf
    v_add_f32_dpp v35, v35, v35 row_mirror row_mask:0xf bank_mask:0xf
    v_add_f32_dpp v36, v36, v36 row_mirror row_mask:0xf bank_mask:0xf
    v_add_f32_dpp v37, v37, v37 row_mirror row_mask:0xf bank_mask:0xf
    v_add_f32_dpp v38, v38, v38 row_mirror row_mask:0xf bank_mask:0xf
    v_add_f32_dpp v39, v39, v39 row_mirror row_mask:0xf bank_mask:0xf
    v_add_f32_dpp v32, v40, v40 row_mirror row_mask:0xf bank_mask:0xc
    v_add_f32_dpp v33, v41, v41 row_mirror row_mask:0xf bank_mask:0xc
    v_add_f32_dpp v34, v42, v42 row_mirror row_mask:0xf bank_mask:0xc
    v_add_f32_dpp v35, v43, v43 row_mirror row_mask:0xf bank_mask:0xc
    v_add_f32_dpp v36, v44, v44 row_mirror row_mask:0xf bank_mask:0xc
    v_add_f32_dpp v37, v45, v45 row_mirror row_mask:0xf bank_mask:0xc
    v_add_f32_dpp v38, v46, v46 row_mirror row_mask:0xf bank_mask:0xc
    v_add_f32_dpp v39, v47, v47 row_mirror row_mask:0xf bank_mask:0xc
    v_add_f32_dpp v32, v32, v32 row_half_mirror row_mask:0xf bank_mask:0xf
    v_add_f32_dpp v33, v33, v33 row_half_mirror row_mask:0xf bank_mask:0xf
    v_add_f32_dpp v34, v34, v34 row_half_mirror row_mask:0xf bank_mask:0xf
    v_add_f32_dpp v35, v35, v35 row_half_mirror row_mask:0xf bank_mask:0xf
    v_add_f32_dpp v32, v36, v36 row_half_mirror row_mask:0xf bank_mask:0xa
    v_add_f32_dpp v33, v37, v37 row_half_mirror row_mask:0xf bank_mask:0xa
    v_add_f32_dpp v34, v38, v38 row_half_mirror row_mask:0xf bank_mask:0xa
    v_add_f32_dpp v35, v39, v39 row_half_mirror row_mask:0xf bank_mask:0xa
    v_add_f32_dpp v32, v32, v32 quad_perm:[2,3,0,1] row_mask:0xf bank_mask:0xf
    v_add_f32_dpp v33, v33, v33 quad_perm:[2,3,0,1] row_mask:0xf bank_mask:0xf
    v_add_f32_dpp v34, v34, v34 quad_perm:[2,3,0,1] row_mask:0xf bank_mask:0xf
    v_add_f32_dpp v35, v35, v35 quad_perm:[2,3,0,1] row_mask:0xf bank_mask:0xf
    v_cndmask_b32 v32, v32, v34, s[4:5]
    v_cndmask_b32 v33, v33, v35, s[4:5]
    s_nop 0
    v_add_f32_dpp v32, v32, v32 quad_perm:[1,0,3,2] row_mask:0xf bank_mask:0xf
    v_add_f32_dpp v33, v33, v33 quad_perm:[1,0,3,2] row_mask:0xf bank_mask:0xf
    v_cndmask_b32 v29, v32, v33, s[6:7]
    v_cvt_pk_bf16_f32 v29, 0, v29
    v_mul_f32 v29, s81, v29
    v_cvt_pk_bf16_f32 v29, 0, v29
    s_waitcnt vmcnt(8)
    s_bitcmp1_b64 s[18:19], 53
    s_cbranch_scc1 L_w122
    s_waitcnt vmcnt(7)
    s_bitcmp1_b64 s[18:19], 37
    s_cbranch_scc1 L_w122
    s_waitcnt vmcnt(6)
    s_bitcmp1_b64 s[18:19], 21
    s_cbranch_scc1 L_w122
    s_waitcnt vmcnt(5)
    s_bitcmp1_b64 s[18:19], 5
    s_cbranch_scc1 L_w122
    s_waitcnt vmcnt(4)
L_w122:
    buffer_load_dwordx4 v[120:123], v1, s[48:51], s69 offen offset:2048 nt
    s_memrealtime s[16:17]
    v_dot2_f32_bf16 v32, v80, v8, 0
    v_dot2_f32_bf16 v32, v81, v9, v32
    v_dot2_f32_bf16 v32, v82, v10, v32
    v_dot2_f32_bf16 v32, v83, v11, v32
    v_dot2_f32_bf16 v33, v84, v8, 0
    v_dot2_f32_bf16 v33, v85, v9, v33
    v_dot2_f32_bf16 v33, v86, v10, v33
    v_dot2_f32_bf16 v33, v87, v11, v33
    s_waitcnt vmcnt(8)
    s_waitcnt lgkmcnt(0)
    s_sub_u32 s16, s16, s84
    s_sub_u32 s16, s16, 2008
    s_mul_i32 s16, s16, 61
    s_ashr_i32 s16, s16, 8
    s_max_i32 s16, s16, 0
    s_min_i32 s16, s16, 63
    s_bfm_b64 s[18:19], s16, 0
    s_bitcmp1_b64 s[18:19], 61
    s_cbranch_scc1 L_w123
    s_waitcnt vmcnt(7)
    s_bitcmp1_b64 s[18:19], 45
    s_cbranch_scc1 L_w123
    s_waitcnt vmcnt(6)
    s_bitcmp1_b64 s[18:19], 29
    s_cbranch_scc1 L_w123
    s_waitcnt vmcnt(5)
    s_bitcmp1_b64 s[18:19], 13
    s_cbranch_scc1 L_w123
    s_waitcnt vmcnt(4)
L_w123:
    buffer_load_dwordx4 v[124:127], v1, s[48:51], s69 offen offset:3072 nt
    v_dot2_f32_bf16 v34, v88, v8, 0
    v_dot2_f32_bf16 v34, v89, v9, v34
    v_dot2_f32_bf16 v34, v90, v10, v34
    v_dot2_f32_bf16 v34, v91, v11, v34
    s_waitcnt vmcnt(8)
    s_bitcmp1_b64 s[18:19], 51
    s_cbranch_scc1 L_w124
    s_waitcnt vmcnt(7)
    s_bitcmp1_b64 s[18:19], 35
    s_cbranch_scc1 L_w124
    s_waitcnt vmcnt(6)
    s_bitcmp1_b64 s[18:19], 19
    s_cbranch_scc1 L_w124
    s_waitcnt vmcnt(5)
    s_bitcmp1_b64 s[18:19], 3
    s_cbranch_scc1 L_w124
    s_waitcnt vmcnt(4)
L_w124:
    buffer_load_dwordx4 v[128:131], v2, s[48:51], s69 offen offset:0 nt
    v_dot2_f32_bf16 v35, v92, v8, 0
    v_dot2_f32_bf16 v35, v93, v9, v35
    v_dot2_f32_bf16 v35, v94, v10, v35
    v_dot2_f32_bf16 v35, v95, v11, v35
    s_waitcnt vmcnt(8)
    s_bitcmp1_b64 s[18:19], 59
    s_cbranch_scc1 L_w125
    s_waitcnt vmcnt(7)
    s_bitcmp1_b64 s[18:19], 43
    s_cbranch_scc1 L_w125
    s_waitcnt vmcnt(6)
    s_bitcmp1_b64 s[18:19], 27
    s_cbranch_scc1 L_w125
    s_waitcnt vmcnt(5)
    s_bitcmp1_b64 s[18:19], 11
    s_cbranch_scc1 L_w125
    s_waitcnt vmcnt(4)
L_w125:
    buffer_load_dwordx4 v[132:135], v2, s[48:51], s69 offen offset:1024 nt
    v_dot2_f32_bf16 v36, v96, v8, 0
    v_dot2_f32_bf16 v36, v97, v9, v36
    v_dot2_f32_bf16 v36, v98, v10, v36
    v_dot2_f32_bf16 v36, v99, v11, v36
    s_waitcnt vmcnt(8)
    s_bitcmp1_b64 s[18:19], 55
    s_cbranch_scc1 L_w126
    s_waitcnt vmcnt(7)
    s_bitcmp1_b64 s[18:19], 39
    s_cbranch_scc1 L_w126
    s_waitcnt vmcnt(6)
    s_bitcmp1_b64 s[18:19], 23
    s_cbranch_scc1 L_w126
    s_waitcnt vmcnt(5)
    s_bitcmp1_b64 s[18:19], 7
    s_cbranch_scc1 L_w126
    s_waitcnt vmcnt(4)
L_w126:
    buffer_load_dwordx4 v[136:139], v2, s[48:51], s69 offen offset:2048 nt
    v_dot2_f32_bf16 v37, v100, v8, 0
    v_dot2_f32_bf16 v37, v101, v9, v37
    v_dot2_f32_bf16 v37, v102, v10, v37
    v_dot2_f32_bf16 v37, v103, v11, v37
    s_waitcnt vmcnt(8)
    s_bitcmp1_b64 s[18:19], 63
    s_cbranch_scc1 L_w127
    s_waitcnt vmcnt(7)
    s_bitcmp1_b64 s[18:19], 47
    s_cbranch_scc1 L_w127
    s_waitcnt vmcnt(6)
    s_bitcmp1_b64 s[18:19], 31
    s_cbranch_scc1 L_w127
    s_waitcnt vmcnt(5)
    s_bitcmp1_b64 s[18:19], 15
    s_cbranch_scc1 L_w127
    s_waitcnt vmcnt(4)
L_w127:
    buffer_load_dwordx4 v[140:143], v2, s[48:51], s69 offen offset:3072 nt
    v_dot2_f32_bf16 v38, v104, v8, 0
    v_dot2_f32_bf16 v38, v105, v9, v38
    v_dot2_f32_bf16 v38, v106, v10, v38
    v_dot2_f32_bf16 v38, v107, v11, v38
    s_waitcnt vmcnt(8)
    s_bitcmp1_b64 s[18:19], 48
    s_cbranch_scc1 L_w128
    s_waitcnt vmcnt(7)
    s_bitcmp1_b64 s[18:19], 32
    s_cbranch_scc1 L_w128
    s_waitcnt vmcnt(6)
    s_bitcmp1_b64 s[18:19], 16
    s_cbranch_scc1 L_w128
    s_waitcnt vmcnt(5)
    s_bitcmp1_b64 s[18:19], 0
    s_cbranch_scc1 L_w128
    s_waitcnt vmcnt(4)
L_w128:
    buffer_load_dwordx4 v[144:147], v1, s[40:43], s64 offen offset:0 nt
    s_memrealtime s[16:17]
    v_dot2_f32_bf16 v39, v108, v8, 0
    v_dot2_f32_bf16 v39, v109, v9, v39
    v_dot2_f32_bf16 v39, v110, v10, v39
    v_dot2_f32_bf16 v39, v111, v11, v39
    s_waitcnt vmcnt(8)
    s_waitcnt lgkmcnt(0)
    s_sub_u32 s16, s16, s84
    s_sub_u32 s16, s16, 2104
    s_mul_i32 s16, s16, 61
    s_ashr_i32 s16, s16, 8
    s_max_i32 s16, s16, 0
    s_min_i32 s16, s16, 63
    s_bfm_b64 s[18:19], s16, 0
    s_bitcmp1_b64 s[18:19], 56
    s_cbranch_scc1 L_w129
    s_waitcnt vmcnt(7)
    s_bitcmp1_b64 s[18:19], 40
    s_cbranch_scc1 L_w129
    s_waitcnt vmcnt(6)
    s_bitcmp1_b64 s[18:19], 24
    s_cbranch_scc1 L_w129
    s_waitcnt vmcnt(5)
    s_bitcmp1_b64 s[18:19], 8
    s_cbranch_scc1 L_w129
    s_waitcnt vmcnt(4)
L_w129:
    buffer_load_dwordx4 v[148:151], v1, s[40:43], s64 offen offset:1024 nt
    v_dot2_f32_bf16 v40, v112, v8, 0
    v_dot2_f32_bf16 v40, v113, v9, v40
    v_dot2_f32_bf16 v40, v114, v10, v40
    v_dot2_f32_bf16 v40, v115, v11, v40
    s_waitcnt vmcnt(8)
    s_bitcmp1_b64 s[18:19], 52
    s_cbranch_scc1 L_w130
    s_waitcnt vmcnt(7)
    s_bitcmp1_b64 s[18:19], 36
    s_cbranch_scc1 L_w130
    s_waitcnt vmcnt(6)
    s_bitcmp1_b64 s[18:19], 20
    s_cbranch_scc1 L_w130
    s_waitcnt vmcnt(5)
    s_bitcmp1_b64 s[18:19], 4
    s_cbranch_scc1 L_w130
    s_waitcnt vmcnt(4)
L_w130:
    buffer_load_dwordx4 v[152:155], v1, s[40:43], s64 offen offset:2048 nt
    v_dot2_f32_bf16 v41, v116, v8, 0
    v_dot2_f32_bf16 v41, v117, v9, v41
    v_dot2_f32_bf16 v41, v118, v10, v41
    v_dot2_f32_bf16 v41, v119, v11, v41
    s_waitcnt vmcnt(8)
    s_bitcmp1_b64 s[18:19], 60
    s_cbranch_scc1 L_w131
    s_waitcnt vmcnt(7)
    s_bitcmp1_b64 s[18:19], 44
    s_cbranch_scc1 L_w131
    s_waitcnt vmcnt(6)
    s_bitcmp1_b64 s[18:19], 28
    s_cbranch_scc1 L_w131
    s_waitcnt vmcnt(5)
    s_bitcmp1_b64 s[18:19], 12
    s_cbranch_scc1 L_w131
    s_waitcnt vmcnt(4)
L_w131:
    buffer_load_dwordx4 v[156:159], v1, s[40:43], s64 offen offset:3072 nt
    v_dot2_f32_bf16 v42, v120, v8, 0
    v_dot2_f32_bf16 v42, v121, v9, v42
    v_dot2_f32_bf16 v42, v122, v10, v42
    v_dot2_f32_bf16 v42, v123, v11, v42
    s_waitcnt vmcnt(8)
    s_bitcmp1_b64 s[18:19], 50
    s_cbranch_scc1 L_w132
    s_waitcnt vmcnt(7)
    s_bitcmp1_b64 s[18:19], 34
    s_cbranch_scc1 L_w132
    s_waitcnt vmcnt(6)
    s_bitcmp1_b64 s[18:19], 18
    s_cbranch_scc1 L_w132
    s_waitcnt vmcnt(5)
    s_bitcmp1_b64 s[18:19], 2
    s_cbranch_scc1 L_w132
    s_waitcnt vmcnt(4)
L_w132:
    buffer_load_dwordx4 v[160:163], v2, s[40:43], s64 offen offset:0 nt
    v_dot2_f32_bf16 v43, v124, v8, 0
    v_dot2_f32_bf16 v43, v125, v9, v43
    v_dot2_f32_bf16 v43, v126, v10, v43
    v_dot2_f32_bf16 v43, v127, v11, v43
    s_waitcnt vmcnt(8)
    s_bitcmp1_b64 s[18:19], 58
    s_cbranch_scc1 L_w133
    s_waitcnt vmcnt(7)
    s_bitcmp1_b64 s[18:19], 42
    s_cbranch_scc1 L_w133
    s_waitcnt vmcnt(6)
    s_bitcmp1_b64 s[18:19], 26
    s_cbranch_scc1 L_w133
    s_waitcnt vmcnt(5)
    s_bitcmp1_b64 s[18:19], 10
    s_cbranch_scc1 L_w133
    s_waitcnt vmcnt(4)
L_w133:
    buffer_load_dwordx4 v[164:167], v2, s[40:43], s64 offen offset:1024 nt
    v_dot2_f32_bf16 v44, v128, v8, 0
    v_dot2_f32_bf16 v44, v129, v9, v44
    v_dot2_f32_bf16 v44, v130, v10, v44
    v_dot2_f32_bf16 v44, v131, v11, v44
    s_waitcnt vmcnt(8)
    s_bitcmp1_b64 s[18:19], 54
    s_cbranch_scc1 L_w134
    s_waitcnt vmcnt(7)
    s_bitcmp1_b64 s[18:19], 38
    s_cbranch_scc1 L_w134
    s_waitcnt vmcnt(6)
    s_bitcmp1_b64 s[18:19], 22
    s_cbranch_scc1 L_w134
    s_waitcnt vmcnt(5)
    s_bitcmp1_b64 s[18:19], 6
    s_cbranch_scc1 L_w134
    s_waitcnt vmcnt(4)
L_w134:
    buffer_load_dwordx4 v[168:171], v2, s[40:43], s64 offen offset:2048 nt
    s_memrealtime s[16:17]
    v_dot2_f32_bf16 v45, v132, v8, 0
    v_dot2_f32_bf16 v45, v133, v9, v45
    v_dot2_f32_bf16 v45, v134, v10, v45
    v_dot2_f32_bf16 v45, v135, v11, v45
    s_waitcnt vmcnt(8)
    s_waitcnt lgkmcnt(0)
    s_sub_u32 s16, s16, s84
    s_sub_u32 s16, s16, 2200
    s_mul_i32 s16, s16, 61
    s_ashr_i32 s16, s16, 8
    s_max_i32 s16, s16, 0
    s_min_i32 s16, s16, 63
    s_bfm_b64 s[18:19], s16, 0
    s_bitcmp1_b64 s[18:19], 62
    s_cbranch_scc1 L_w135
    s_waitcnt vmcnt(7)
    s_bitcmp1_b64 s[18:19], 46
    s_cbranch_scc1 L_w135
    s_waitcnt vmcnt(6)
    s_bitcmp1_b64 s[18:19], 30
    s_cbranch_scc1 L_w135
    s_waitcnt vmcnt(5)
    s_bitcmp1_b64 s[18:19], 14
    s_cbranch_scc1 L_w135
    s_waitcnt vmcnt(4)
L_w135:
    buffer_load_dwordx4 v[172:175], v2, s[40:43], s64 offen offset:3072 nt
    v_dot2_f32_bf16 v46, v136, v8, 0
    v_dot2_f32_bf16 v46, v137, v9, v46
    v_dot2_f32_bf16 v46, v138, v10, v46
    v_dot2_f32_bf16 v46, v139, v11, v46
    s_waitcnt vmcnt(8)
    s_bitcmp1_b64 s[18:19], 49
    s_cbranch_scc1 L_w136
    s_waitcnt vmcnt(7)
    s_bitcmp1_b64 s[18:19], 33
    s_cbranch_scc1 L_w136
    s_waitcnt vmcnt(6)
    s_bitcmp1_b64 s[18:19], 17
    s_cbranch_scc1 L_w136
    s_waitcnt vmcnt(5)
    s_bitcmp1_b64 s[18:19], 1
    s_cbranch_scc1 L_w136
    s_waitcnt vmcnt(4)
L_w136:
    buffer_load_dwordx4 v[176:179], v1, s[40:43], s65 offen offset:0 nt
    buffer_load_dwordx4 v[180:183], v1, s[40:43], s65 offen offset:1024 nt
    buffer_load_dwordx4 v[184:187], v1, s[40:43], s65 offen offset:2048 nt
    v_dot2_f32_bf16 v47, v140, v8, 0
    v_dot2_f32_bf16 v47, v141, v9, v47
    v_dot2_f32_bf16 v47, v142, v10, v47
    v_dot2_f32_bf16 v47, v143, v11, v47
    v_add_f32_dpp v32, v32, v32 row_mirror row_mask:0xf bank_mask:0xf
    v_add_f32_dpp v33, v33, v33 row_mirror row_mask:0xf bank_mask:0xf
    v_add_f32_dpp v34, v34, v34 row_mirror row_mask:0xf bank_mask:0xf
    v_add_f32_dpp v35, v35, v35 row_mirror row_mask:0xf bank_mask:0xf
    v_add_f32_dpp v36, v36, v36 row_mirror row_mask:0xf bank_mask:0xf
    v_add_f32_dpp v37, v37, v37 row_mirror row_mask:0xf bank_mask:0xf
    v_add_f32_dpp v38, v38, v38 row_mirror row_mask:0xf bank_mask:0xf
    v_add_f32_dpp v39, v39, v39 row_mirror row_mask:0xf bank_mask:0xf
    v_add_f32_dpp v32, v40, v40 row_mirror row_mask:0xf bank_mask:0xc
    v_add_f32_dpp v33, v41, v41 row_mirror row_mask:0xf bank_mask:0xc
    v_add_f32_dpp v34, v42, v42 row_mirror row_mask:0xf bank_mask:0xc
    v_add_f32_dpp v35, v43, v43 row_mirror row_mask:0xf bank_mask:0xc
    v_add_f32_dpp v36, v44, v44 row_mirror row_mask:0xf bank_mask:0xc
    v_add_f32_dpp v37, v45, v45 row_mirror row_mask:0xf bank_mask:0xc
    v_add_f32_dpp v38, v46, v46 row_mirror row_mask:0xf bank_mask:0xc
    v_add_f32_dpp v39, v47, v47 row_mirror row_mask:0xf bank_mask:0xc
    v_add_f32_dpp v32, v32, v32 row_half_mirror row_mask:0xf bank_mask:0xf
    v_add_f32_dpp v33, v33, v33 row_half_mirror row_mask:0xf bank_mask:0xf
    v_add_f32_dpp v34, v34, v34 row_half_mirror row_mask:0xf bank_mask:0xf
    v_add_f32_dpp v35, v35, v35 row_half_mirror row_mask:0xf bank_mask:0xf
    v_add_f32_dpp v32, v36, v36 row_half_mirror row_mask:0xf bank_mask:0xa
    v_add_f32_dpp v33, v37, v37 row_half_mirror row_mask:0xf bank_mask:0xa
    v_add_f32_dpp v34, v38, v38 row_half_mirror row_mask:0xf bank_mask:0xa
    v_add_f32_dpp v35, v39, v39 row_half_mirror row_mask:0xf bank_mask:0xa
    v_add_f32_dpp v32, v32, v32 quad_perm:[2,3,0,1] row_mask:0xf bank_mask:0xf
    v_add_f32_dpp v33, v33, v33 quad_perm:[2,3,0,1] row_mask:0xf bank_mask:0xf
    v_add_f32_dpp v34, v34, v34 quad_perm:[2,3,0,1] row_mask:0xf bank_mask:0xf
    v_add_f32_dpp v35, v35, v35 quad_perm:[2,3,0,1] row_mask:0xf bank_mask:0xf
    v_cndmask_b32 v32, v32, v34, s[4:5]
    v_cndmask_b32 v33, v33, v35, s[4:5]
    s_nop 0
    v_add_f32_dpp v32, v32, v32 quad_perm:[1,0,3,2] row_mask:0xf bank_mask:0xf
    v_add_f32_dpp v33, v33, v33 quad_perm:[1,0,3,2] row_mask:0xf bank_mask:0xf
    v_cndmask_b32 v30, v32, v33, s[6:7]
    v_cvt_pk_bf16_f32 v30, 0, v30
    v_mul_f32 v30, s81, v30
    v_cvt_pk_bf16_f32 v30, 0, v30
    v_max_f32 v32, v25, v26
    v_max3_f32 v34, v22, v23, v24
    v_max3_f32 v36, v28, v29, v30
    v_max_f32_dpp v32, v32, v32 quad_perm:[1,0,3,2] row_mask:0xf bank_mask:0xf
    v_max_f32_dpp v34, v34, v34 quad_perm:[1,0,3,2] row_mask:0xf bank_mask:0xf
    v_max_f32_dpp v36, v36, v36 quad_perm:[1,0,3,2] row_mask:0xf bank_mask:0xf
    v_max_f32_dpp v32, v32, v32 quad_perm:[2,3,0,1] row_mask:0xf bank_mask:0xf
    v_max_f32_dpp v34, v34, v34 quad_perm:[2,3,0,1] row_mask:0xf bank_mask:0xf
    v_max_f32_dpp v36, v36, v36 quad_perm:[2,3,0,1] row_mask:0xf bank_mask:0xf
    v_max_f32_dpp v32, v32, v32 row_half_mirror row_mask:0xf bank_mask:0xf
    v_max_f32_dpp v34, v34, v34 row_half_mirror row_mask:0xf bank_mask:0xf
    v_max_f32_dpp v36, v36, v36 row_half_mirror row_mask:0xf bank_mask:0xf
    v_max_f32_dpp v32, v32, v32 row_mirror row_mask:0xf bank_mask:0xf
    v_max_f32_dpp v34, v34, v34 row_mirror row_mask:0xf bank_mask:0xf
    v_max_f32_dpp v36, v36, v36 row_mirror row_mask:0xf bank_mask:0xf
    v_mov_b32 v38, v32
    v_mov_b32 v39, v34
    v_mov_b32 v27, v36
    v_permlane16_swap_b32 v32, v38
    v_permlane16_swap_b32 v34, v39
    v_permlane16_swap_b32 v36, v27
    v_max_f32 v32, v32, v38
    v_max_f32 v34, v34, v39
    v_max_f32 v36, v36, v27
    v_mov_b32 v38, v32
    v_mov_b32 v39, v34
    v_mov_b32 v27, v36
    v_permlane32_swap_b32 v32, v38
    v_permlane32_swap_b32 v34, v39
    v_permlane32_swap_b32 v36, v27
    v_max_f32 v32, v32, v38
    v_max_f32 v34, v34, v39
    v_max_f32 v36, v36, v27
    v_sub_f32 v22, v22, v34
    v_sub_f32 v23, v23, v34
    v_sub_f32 v24, v24, v34
    v_sub_f32 v28, v28, v36
    v_sub_f32 v29, v29, v36
    v_sub_f32 v30, v30, v36
    v_sub_f32 v25, v25, v32
    v_sub_f32 v26, v26, v32
    v_mul_f32 v22, s80, v22
    v_mul_f32 v23, s80, v23
    v_mul_f32 v24, s80, v24
    v_mul_f32 v25, s80, v25
    v_mul_f32 v26, s80, v26
    v_mul_f32 v28, s80, v28
    v_mul_f32 v29, s80, v29
    v_mul_f32 v30, s80, v30
    v_exp_f32 v22, v22
    v_exp_f32 v23, v23
    v_exp_f32 v24, v24
    v_exp_f32 v25, v25
    v_exp_f32 v26, v26
    v_exp_f32 v28, v28
    v_exp_f32 v29, v29
    v_exp_f32 v30, v30
    v_add_f32 v35, v22, v23
    v_add_f32 v33, v25, v26
    v_add_f32 v37, v28, v29
    v_add_f32 v35, v35, v24
    v_add_f32 v37, v37, v30
    v_cvt_pk_bf16_f32 v40, v22, 0
    v_cvt_pk_bf16_f32 v22, 0, v22
    v_cvt_pk_bf16_f32 v41, v23, 0
    v_cvt_pk_bf16_f32 v23, 0, v23
    v_cvt_pk_bf16_f32 v42, v24, 0
    v_cvt_pk_bf16_f32 v24, 0, v24
    v_cvt_pk_bf16_f32 v43, v25, 0
    v_cvt_pk_bf16_f32 v25, 0, v25
    v_cvt_pk_bf16_f32 v44, v26, 0
    v_cvt_pk_bf16_f32 v26, 0, v26
    v_cvt_pk_bf16_f32 v45, v28, 0
    v_cvt_pk_bf16_f32 v28, 0, v28
    v_cvt_pk_bf16_f32 v46, v29, 0
    v_cvt_pk_bf16_f32 v29, 0, v29
    v_cvt_pk_bf16_f32 v47, v30, 0
    v_cvt_pk_bf16_f32 v30, 0, v30
    s_waitcnt vmcnt(8)
    s_bitcmp1_b64 s[18:19], 61
    s_cbranch_scc1 L_w139
    s_waitcnt vmcnt(7)
    s_bitcmp1_b64 s[18:19], 45
    s_cbranch_scc1 L_w139
    s_waitcnt vmcnt(6)
    s_bitcmp1_b64 s[18:19], 29
    s_cbranch_scc1 L_w139
    s_waitcnt vmcnt(5)
    s_bitcmp1_b64 s[18:19], 13
    s_cbranch_scc1 L_w139
    s_waitcnt vmcnt(4)
L_w139:
    buffer_load_dwordx4 v[188:191], v1, s[40:43], s65 offen offset:3072 nt
    v_dot2c_f32_bf16_dpp v12, v40, v144 row_newbcast:0 row_mask:0xf bank_mask:0xf
    v_dot2c_f32_bf16_dpp v13, v22, v144 row_newbcast:0 row_mask:0xf bank_mask:0xf
    v_dot2c_f32_bf16_dpp v14, v40, v145 row_newbcast:0 row_mask:0xf bank_mask:0xf
    v_dot2c_f32_bf16_dpp v15, v22, v145 row_newbcast:0 row_mask:0xf bank_mask:0xf
    v_dot2c_f32_bf16_dpp v16, v40, v146 row_newbcast:0 row_mask:0xf bank_mask:0xf
    v_dot2c_f32_bf16_dpp v17, v22, v146 row_newbcast:0 row_mask:0xf bank_mask:0xf
    v_dot2c_f32_bf16_dpp v18, v40, v147 row_newbcast:0 row_mask:0xf bank_mask:0xf
    v_dot2c_f32_bf16_dpp v19, v22, v147 row_newbcast:0 row_mask:0xf bank_mask:0xf
    v_dot2c_f32_bf16_dpp v12, v40, v148 row_newbcast:1 row_mask:0xf bank_mask:0xf
    v_dot2c_f32_bf16_dpp v13, v22, v148 row_newbcast:1 row_mask:0xf bank_mask:0xf
    v_dot2c_f32_bf16_dpp v14, v40, v149 row_newbcast:1 row_mask:0xf bank_mask:0xf
    v_dot2c_f32_bf16_dpp v15, v22, v149 row_newbcast:1 row_mask:0xf bank_mask:0xf
    v_dot2c_f32_bf16_dpp v16, v40, v150 row_newbcast:1 row_mask:0xf bank_mask:0xf
    v_dot2c_f32_bf16_dpp v17, v22, v150 row_newbcast:1 row_mask:0xf bank_mask:0xf
    v_dot2c_f32_bf16_dpp v18, v40, v151 row_newbcast:1 row_mask:0xf bank_mask:0xf
    v_dot2c_f32_bf16_dpp v19, v22, v151 row_newbcast:1 row_mask:0xf bank_mask:0xf
    v_add_f32_dpp v33, v33, v33 quad_perm:[1,0,3,2] row_mask:0xf bank_mask:0xf
    v_add_f32_dpp v35, v35, v35 quad_perm:[1,0,3,2] row_mask:0xf bank_mask:0xf
    v_add_f32_dpp v37, v37, v37 quad_perm:[1,0,3,2] row_mask:0xf bank_mask:0xf
    v_add_f32_dpp v33, v33, v33 quad_perm:[2,3,0,1] row_mask:0xf bank_mask:0xf
    v_add_f32_dpp v35, v35, v35 quad_perm:[2,3,0,1] row_mask:0xf bank_mask:0xf
    v_add_f32_dpp v37, v37, v37 quad_perm:[2,3,0,1] row_mask:0xf bank_mask:0xf
    v_add_f32_dpp v33, v33, v33 row_half_mirror row_mask:0xf bank_mask:0xf
    v_add_f32_dpp v35, v35, v35 row_half_mirror row_mask:0xf bank_mask:0xf
    v_add_f32_dpp v37, v37, v37 row_half_mirror row_mask:0xf bank_mask:0xf
    v_add_f32_dpp v33, v33, v33 row_mirror row_mask:0xf bank_mask:0xf
    v_add_f32_dpp v35, v35, v35 row_mirror row_mask:0xf bank_mask:0xf
    v_add_f32_dpp v37, v37, v37 row_mirror row_mask:0xf bank_mask:0xf
    v_mov_b32 v38, v33
    v_mov_b32 v39, v35
    v_mov_b32 v27, v37
    v_permlane16_swap_b32 v33, v38
    v_permlane16_swap_b32 v35, v39
    v_permlane16_swap_b32 v37, v27
    v_add_f32 v33, v33, v38
    v_add_f32 v35, v35, v39
    v_add_f32 v37, v37, v27
    v_mov_b32 v38, v33
    v_mov_b32 v39, v35
    v_mov_b32 v27, v37
    v_permlane32_swap_b32 v33, v38
    v_permlane32_swap_b32 v35, v39
    v_permlane32_swap_b32 v37, v27
    v_add_f32 v33, v33, v38
    v_add_f32 v35, v35, v39
    v_add_f32 v37, v37, v27
    s_mov_b64 exec, 1
    ds_write_b64 v20, v[32:33] offset:512
    ds_write_b64 v20, v[34:35] offset:544
    ds_write_b64 v20, v[36:37] offset:576
    s_mov_b64 exec, -1
    v_dot2c_f32_bf16_dpp v12, v40, v152 row_newbcast:2 row_mask:0xf bank_mask:0xf
    v_dot2c_f32_bf16_dpp v13, v22, v152 row_newbcast:2 row_mask:0xf bank_mask:0xf
    v_dot2c_f32_bf16_dpp v14, v40, v153 row_newbcast:2 row_mask:0xf bank_mask:0xf
    v_dot2c_f32_bf16_dpp v15, v22, v153 row_newbcast:2 row_mask:0xf bank_mask:0xf
    v_dot2c_f32_bf16_dpp v16, v40, v154 row_newbcast:2 row_mask:0xf bank_mask:0xf
    v_dot2c_f32_bf16_dpp v17, v22, v154 row_newbcast:2 row_mask:0xf bank_mask:0xf
    v_dot2c_f32_bf16_dpp v18, v40, v155 row_newbcast:2 row_mask:0xf bank_mask:0xf
    v_dot2c_f32_bf16_dpp v19, v22, v155 row_newbcast:2 row_mask:0xf bank_mask:0xf
    s_waitcnt vmcnt(8)
    s_bitcmp1_b64 s[18:19], 51
    s_cbranch_scc1 L_w140
    s_waitcnt vmcnt(7)
    s_bitcmp1_b64 s[18:19], 35
    s_cbranch_scc1 L_w140
    s_waitcnt vmcnt(6)
    s_bitcmp1_b64 s[18:19], 19
    s_cbranch_scc1 L_w140
    s_waitcnt vmcnt(5)
    s_bitcmp1_b64 s[18:19], 3
    s_cbranch_scc1 L_w140
    s_waitcnt vmcnt(4)
L_w140:
    buffer_load_dwordx4 v[192:195], v2, s[40:43], s65 offen offset:0 nt
    s_memrealtime s[16:17]
    v_dot2c_f32_bf16_dpp v12, v40, v156 row_newbcast:3 row_mask:0xf bank_mask:0xf
    v_dot2c_f32_bf16_dpp v13, v22, v156 row_newbcast:3 row_mask:0xf bank_mask:0xf
    v_dot2c_f32_bf16_dpp v14, v40, v157 row_newbcast:3 row_mask:0xf bank_mask:0xf
    v_dot2c_f32_bf16_dpp v15, v22, v157 row_newbcast:3 row_mask:0xf bank_mask:0xf
    v_dot2c_f32_bf16_dpp v16, v40, v158 row_newbcast:3 row_mask:0xf bank_mask:0xf
    v_dot2c_f32_bf16_dpp v17, v22, v158 row_newbcast:3 row_mask:0xf bank_mask:0xf
    v_dot2c_f32_bf16_dpp v18, v40, v159 row_newbcast:3 row_mask:0xf bank_mask:0xf
    v_dot2c_f32_bf16_dpp v19, v22, v159 row_newbcast:3 row_mask:0xf bank_mask:0xf
    s_waitcnt vmcnt(8)
    s_waitcnt lgkmcnt(0)
    s_sub_u32 s16, s16, s84
    s_sub_u32 s16, s16, 2279
    s_mul_i32 s16, s16, 61
    s_ashr_i32 s16, s16, 8
    s_max_i32 s16, s16, 0
    s_min_i32 s16, s16, 63
    s_bfm_b64 s[18:19], s16, 0
    s_bitcmp1_b64 s[18:19], 59
    s_cbranch_scc1 L_w141
    s_waitcnt vmcnt(7)
    s_bitcmp1_b64 s[18:19], 43
    s_cbranch_scc1 L_w141
    s_waitcnt vmcnt(6)
    s_bitcmp1_b64 s[18:19], 27
    s_cbranch_scc1 L_w141
    s_waitcnt vmcnt(5)
    s_bitcmp1_b64 s[18:19], 11
    s_cbranch_scc1 L_w141
    s_waitcnt vmcnt(4)
L_w141:
    buffer_load_dwordx4 v[196:199], v2, s[40:43], s65 offen offset:1024 nt
    v_dot2c_f32_bf16_dpp v12, v40, v160 row_newbcast:4 row_mask:0xf bank_mask:0xf
    v_dot2c_f32_bf16_dpp v13, v22, v160 row_newbcast:4 row_mask:0xf bank_mask:0xf
    v_dot2c_f32_bf16_dpp v14, v40, v161 row_newbcast:4 row_mask:0xf bank_mask:0xf
    v_dot2c_f32_bf16_dpp v15, v22, v161 row_newbcast:4 row_mask:0xf bank_mask:0xf
    v_dot2c_f32_bf16_dpp v16, v40, v162 row_newbcast:4 row_mask:0xf bank_mask:0xf
    v_dot2c_f32_bf16_dpp v17, v22, v162 row_newbcast:4 row_mask:0xf bank_mask:0xf
    v_dot2c_f32_bf16_dpp v18, v40, v163 row_newbcast:4 row_mask:0xf bank_mask:0xf
    v_dot2c_f32_bf16_dpp v19, v22, v163 row_newbcast:4 row_mask:0xf bank_mask:0xf
    s_waitcnt vmcnt(8)
    s_bitcmp1_b64 s[18:19], 55
    s_cbranch_scc1 L_w142
    s_waitcnt vmcnt(7)
    s_bitcmp1_b64 s[18:19], 39
    s_cbranch_scc1 L_w142
    s_waitcnt vmcnt(6)
    s_bitcmp1_b64 s[18:19], 23
    s_cbranch_scc1 L_w142
    s_waitcnt vmcnt(5)
    s_bitcmp1_b64 s[18:19], 7
    s_cbranch_scc1 L_w142
    s_waitcnt vmcnt(4)
L_w142:
    buffer_load_dwordx4 v[200:203], v2, s[40:43], s65 offen offset:2048 nt
    v_dot2c_f32_bf16_dpp v12, v40, v164 row_newbcast:5 row_mask:0xf bank_mask:0xf
    v_dot2c_f32_bf16_dpp v13, v22, v164 row_newbcast:5 row_mask:0xf bank_mask:0xf
    v_dot2c_f32_bf16_dpp v14, v40, v165 row_newbcast:5 row_mask:0xf bank_mask:0xf
    v_dot2c_f32_bf16_dpp v15, v22, v165 row_newbcast:5 row_mask:0xf bank_mask:0xf
    v_dot2c_f32_bf16_dpp v16, v40, v166 row_newbcast:5 row_mask:0xf bank_mask:0xf
    v_dot2c_f32_bf16_dpp v17, v22, v166 row_newbcast:5 row_mask:0xf bank_mask:0xf
    v_dot2c_f32_bf16_dpp v18, v40, v167 row_newbcast:5 row_mask:0xf bank_mask:0xf
    v_dot2c_f32_bf16_dpp v19, v22, v167 row_newbcast:5 row_mask:0xf bank_mask:0xf
    s_waitcnt vmcnt(8)
    s_bitcmp1_b64 s[18:19], 63
    s_cbranch_scc1 L_w143
    s_waitcnt vmcnt(7)
    s_bitcmp1_b64 s[18:19], 47
    s_cbranch_scc1 L_w143
    s_waitcnt vmcnt(6)
    s_bitcmp1_b64 s[18:19], 31
    s_cbranch_scc1 L_w143
    s_waitcnt vmcnt(5)
    s_bitcmp1_b64 s[18:19], 15
    s_cbranch_scc1 L_w143
    s_waitcnt vmcnt(4)
L_w143:
    buffer_load_dwordx4 v[204:207], v2, s[40:43], s65 offen offset:3072 nt
    v_dot2c_f32_bf16_dpp v12, v40, v168 row_newbcast:6 row_mask:0xf bank_mask:0xf
    v_dot2c_f32_bf16_dpp v13, v22, v168 row_newbcast:6 row_mask:0xf bank_mask:0xf
    v_dot2c_f32_bf16_dpp v14, v40, v169 row_newbcast:6 row_mask:0xf bank_mask:0xf
    v_dot2c_f32_bf16_dpp v15, v22, v169 row_newbcast:6 row_mask:0xf bank_mask:0xf
    v_dot2c_f32_bf16_dpp v16, v40, v170 row_newbcast:6 row_mask:0xf bank_mask:0xf
    v_dot2c_f32_bf16_dpp v17, v22, v170 row_newbcast:6 row_mask:0xf bank_mask:0xf
    v_dot2c_f32_bf16_dpp v18, v40, v171 row_newbcast:6 row_mask:0xf bank_mask:0xf
    v_dot2c_f32_bf16_dpp v19, v22, v171 row_newbcast:6 row_mask:0xf bank_mask:0xf
    s_waitcnt vmcnt(8)
    s_bitcmp1_b64 s[18:19], 48
    s_cbranch_scc1 L_w144
    s_waitcnt vmcnt(7)
    s_bitcmp1_b64 s[18:19], 32
    s_cbranch_scc1 L_w144
    s_waitcnt vmcnt(6)
    s_bitcmp1_b64 s[18:19], 16
    s_cbranch_scc1 L_w144
    s_waitcnt vmcnt(5)
    s_bitcmp1_b64 s[18:19], 0
    s_cbranch_scc1 L_w144
    s_waitcnt vmcnt(4)
L_w144:
    buffer_load_dwordx4 v[208:211], v1, s[40:43], s66 offen offset:0 nt
    v_dot2c_f32_bf16_dpp v12, v40, v172 row_newbcast:7 row_mask:0xf bank_mask:0xf
    v_dot2c_f32_bf16_dpp v13, v22, v172 row_newbcast:7 row_mask:0xf bank_mask:0xf
    v_dot2c_f32_bf16_dpp v14, v40, v173 row_newbcast:7 row_mask:0xf bank_mask:0xf
    v_dot2c_f32_bf16_dpp v15, v22, v173 row_newbcast:7 row_mask:0xf bank_mask:0xf
    v_dot2c_f32_bf16_dpp v16, v40, v174 row_newbcast:7 row_mask:0xf bank_mask:0xf
    v_dot2c_f32_bf16_dpp v17, v22, v174 row_newbcast:7 row_mask:0xf bank_mask:0xf
    v_dot2c_f32_bf16_dpp v18, v40, v175 row_newbcast:7 row_mask:0xf bank_mask:0xf
    v_dot2c_f32_bf16_dpp v19, v22, v175 row_newbcast:7 row_mask:0xf bank_mask:0xf
    s_waitcnt vmcnt(8)
    s_bitcmp1_b64 s[18:19], 56
    s_cbranch_scc1 L_w145
    s_waitcnt vmcnt(7)
    s_bitcmp1_b64 s[18:19], 40
    s_cbranch_scc1 L_w145
    s_waitcnt vmcnt(6)
    s_bitcmp1_b64 s[18:19], 24
    s_cbranch_scc1 L_w145
    s_waitcnt vmcnt(5)
    s_bitcmp1_b64 s[18:19], 8
    s_cbranch_scc1 L_w145
    s_waitcnt vmcnt(4)
L_w145:
    buffer_load_dwordx4 v[212:215], v1, s[40:43], s66 offen offset:1024 nt
    v_dot2c_f32_bf16_dpp v12, v40, v176 row_newbcast:8 row_mask:0xf bank_mask:0xf
    v_dot2c_f32_bf16_dpp v13, v22, v176 row_newbcast:8 row_mask:0xf bank_mask:0xf
    v_dot2c_f32_bf16_dpp v14, v40, v177 row_newbcast:8 row_mask:0xf bank_mask:0xf
    v_dot2c_f32_bf16_dpp v15, v22, v177 row_newbcast:8 row_mask:0xf bank_mask:0xf
    v_dot2c_f32_bf16_dpp v16, v40, v178 row_newbcast:8 row_mask:0xf bank_mask:0xf
    v_dot2c_f32_bf16_dpp v17, v22, v178 row_newbcast:8 row_mask:0xf bank_mask:0xf
    v_dot2c_f32_bf16_dpp v18, v40, v179 row_newbcast:8 row_mask:0xf bank_mask:0xf
    v_dot2c_f32_bf16_dpp v19, v22, v179 row_newbcast:8 row_mask:0xf bank_mask:0xf
    s_waitcnt vmcnt(8)
    s_bitcmp1_b64 s[18:19], 52
    s_cbranch_scc1 L_w146
    s_waitcnt vmcnt(7)
    s_bitcmp1_b64 s[18:19], 36
    s_cbranch_scc1 L_w146
    s_waitcnt vmcnt(6)
    s_bitcmp1_b64 s[18:19], 20
    s_cbranch_scc1 L_w146
    s_waitcnt vmcnt(5)
    s_bitcmp1_b64 s[18:19], 4
    s_cbranch_scc1 L_w146
    s_waitcnt vmcnt(4)
L_w146:
    buffer_load_dwordx4 v[216:219], v1, s[40:43], s66 offen offset:2048 nt
    ds_read_b32 v3, v31 offset:676
    s_memrealtime s[16:17]
    v_dot2c_f32_bf16_dpp v12, v40, v180 row_newbcast:9 row_mask:0xf bank_mask:0xf
    v_dot2c_f32_bf16_dpp v13, v22, v180 row_newbcast:9 row_mask:0xf bank_mask:0xf
    v_dot2c_f32_bf16_dpp v14, v40, v181 row_newbcast:9 row_mask:0xf bank_mask:0xf
    v_dot2c_f32_bf16_dpp v15, v22, v181 row_newbcast:9 row_mask:0xf bank_mask:0xf
    v_dot2c_f32_bf16_dpp v16, v40, v182 row_newbcast:9 row_mask:0xf bank_mask:0xf
    v_dot2c_f32_bf16_dpp v17, v22, v182 row_newbcast:9 row_mask:0xf bank_mask:0xf
    v_dot2c_f32_bf16_dpp v18, v40, v183 row_newbcast:9 row_mask:0xf bank_mask:0xf
    v_dot2c_f32_bf16_dpp v19, v22, v183 row_newbcast:9 row_mask:0xf bank_mask:0xf
    s_waitcnt vmcnt(8)
    s_waitcnt lgkmcnt(0)
    v_readfirstlane_b32 s15, v3
    s_sub_u32 s16, s16, s84
    s_sub_u32 s16, s16, s15
    s_sub_u32 s16, s16, 2357
    s_mul_i32 s16, s16, 61
    s_ashr_i32 s16, s16, 8
    s_max_i32 s16, s16, 0
    s_min_i32 s16, s16, 63
    s_bfm_b64 s[18:19], s16, 0
    s_bitcmp1_b64 s[18:19], 60
    s_cbranch_scc1 L_w147
    s_waitcnt vmcnt(7)
    s_bitcmp1_b64 s[18:19], 44
    s_cbranch_scc1 L_w147
    s_waitcnt vmcnt(6)
    s_bitcmp1_b64 s[18:19], 28
    s_cbranch_scc1 L_w147
    s_waitcnt vmcnt(5)
    s_bitcmp1_b64 s[18:19], 12
    s_cbranch_scc1 L_w147
    s_waitcnt vmcnt(4)
L_w147:
    buffer_load_dwordx4 v[220:223], v1, s[40:43], s66 offen offset:3072 nt
    v_dot2c_f32_bf16_dpp v12, v40, v184 row_newbcast:10 row_mask:0xf bank_mask:0xf
    v_dot2c_f32_bf16_dpp v13, v22, v184 row_newbcast:10 row_mask:0xf bank_mask:0xf
    v_dot2c_f32_bf16_dpp v14, v40, v185 row_newbcast:10 row_mask:0xf bank_mask:0xf
    v_dot2c_f32_bf16_dpp v15, v22, v185 row_newbcast:10 row_mask:0xf bank_mask:0xf
    v_dot2c_f32_bf16_dpp v16, v40, v186 row_newbcast:10 row_mask:0xf bank_mask:0xf
    v_dot2c_f32_bf16_dpp v17, v22, v186 row_newbcast:10 row_mask:0xf bank_mask:0xf
    v_dot2c_f32_bf16_dpp v18, v40, v187 row_newbcast:10 row_mask:0xf bank_mask:0xf
    v_dot2c_f32_bf16_dpp v19, v22, v187 row_newbcast:10 row_mask:0xf bank_mask:0xf
    s_waitcnt vmcnt(8)
    s_bitcmp1_b64 s[18:19], 50
    s_cbranch_scc1 L_w148
    s_waitcnt vmcnt(7)
    s_bitcmp1_b64 s[18:19], 34
    s_cbranch_scc1 L_w148
    s_waitcnt vmcnt(6)
    s_bitcmp1_b64 s[18:19], 18
    s_cbranch_scc1 L_w148
    s_waitcnt vmcnt(5)
    s_bitcmp1_b64 s[18:19], 2
    s_cbranch_scc1 L_w148
    s_waitcnt vmcnt(4)
L_w148:
    buffer_load_dwordx4 v[224:227], v2, s[40:43], s66 offen offset:0 nt
    v_dot2c_f32_bf16_dpp v12, v40, v188 row_newbcast:11 row_mask:0xf bank_mask:0xf
    v_dot2c_f32_bf16_dpp v13, v22, v188 row_newbcast:11 row_mask:0xf bank_mask:0xf
    v_dot2c_f32_bf16_dpp v14, v40, v189 row_newbcast:11 row_mask:0xf bank_mask:0xf
    v_dot2c_f32_bf16_dpp v15, v22, v189 row_newbcast:11 row_mask:0xf bank_mask:0xf
    v_dot2c_f32_bf16_dpp v16, v40, v190 row_newbcast:11 row_mask:0xf bank_mask:0xf
    v_dot2c_f32_bf16_dpp v17, v22, v190 row_newbcast:11 row_mask:0xf bank_mask:0xf
    v_dot2c_f32_bf16_dpp v18, v40, v191 row_newbcast:11 row_mask:0xf bank_mask:0xf
    v_dot2c_f32_bf16_dpp v19, v22, v191 row_newbcast:11 row_mask:0xf bank_mask:0xf
    s_waitcnt vmcnt(8)
    s_bitcmp1_b64 s[18:19], 58
    s_cbranch_scc1 L_w149
    s_waitcnt vmcnt(7)
    s_bitcmp1_b64 s[18:19], 42
    s_cbranch_scc1 L_w149
    s_waitcnt vmcnt(6)
    s_bitcmp1_b64 s[18:19], 26
    s_cbranch_scc1 L_w149
    s_waitcnt vmcnt(5)
    s_bitcmp1_b64 s[18:19], 10
    s_cbranch_scc1 L_w149
    s_waitcnt vmcnt(4)
L_w149:
    buffer_load_dwordx4 v[228:231], v2, s[40:43], s66 offen offset:1024 nt
    v_dot2c_f32_bf16_dpp v12, v40, v192 row_newbcast:12 row_mask:0xf bank_mask:0xf
    v_dot2c_f32_bf16_dpp v13, v22, v192 row_newbcast:12 row_mask:0xf bank_mask:0xf
    v_dot2c_f32_bf16_dpp v14, v40, v193 row_newbcast:12 row_mask:0xf bank_mask:0xf
    v_dot2c_f32_bf16_dpp v15, v22, v193 row_newbcast:12 row_mask:0xf bank_mask:0xf
    v_dot2c_f32_bf16_dpp v16, v40, v194 row_newbcast:12 row_mask:0xf bank_mask:0xf
    v_dot2c_f32_bf16_dpp v17, v22, v194 row_newbcast:12 row_mask:0xf bank_mask:0xf
    v_dot2c_f32_bf16_dpp v18, v40, v195 row_newbcast:12 row_mask:0xf bank_mask:0xf
    v_dot2c_f32_bf16_dpp v19, v22, v195 row_newbcast:12 row_mask:0xf bank_mask:0xf
    s_waitcnt vmcnt(8)
    s_bitcmp1_b64 s[18:19], 54
    s_cbranch_scc1 L_w150
    s_waitcnt vmcnt(7)
    s_bitcmp1_b64 s[18:19], 38
    s_cbranch_scc1 L_w150
    s_waitcnt vmcnt(6)
    s_bitcmp1_b64 s[18:19], 22
    s_cbranch_scc1 L_w150
    s_waitcnt vmcnt(5)
    s_bitcmp1_b64 s[18:19], 6
    s_cbranch_scc1 L_w150
    s_waitcnt vmcnt(4)
L_w150:
    buffer_load_dwordx4 v[232:235], v2, s[40:43], s66 offen offset:2048 nt
    v_dot2c_f32_bf16_dpp v12, v40, v196 row_newbcast:13 row_mask:0xf bank_mask:0xf
    v_dot2c_f32_bf16_dpp v13, v22, v196 row_newbcast:13 row_mask:0xf bank_mask:0xf
    v_dot2c_f32_bf16_dpp v14, v40, v197 row_newbcast:13 row_mask:0xf bank_mask:0xf
    v_dot2c_f32_bf16_dpp v15, v22, v197 row_newbcast:13 row_mask:0xf bank_mask:0xf
    v_dot2c_f32_bf16_dpp v16, v40, v198 row_newbcast:13 row_mask:0xf bank_mask:0xf
    v_dot2c_f32_bf16_dpp v17, v22, v198 row_newbcast:13 row_mask:0xf bank_mask:0xf
    v_dot2c_f32_bf16_dpp v18, v40, v199 row_newbcast:13 row_mask:0xf bank_mask:0xf
    v_dot2c_f32_bf16_dpp v19, v22, v199 row_newbcast:13 row_mask:0xf bank_mask:0xf
    s_waitcnt vmcnt(8)
    s_bitcmp1_b64 s[18:19], 62
    s_cbranch_scc1 L_w151
    s_waitcnt vmcnt(7)
    s_bitcmp1_b64 s[18:19], 46
    s_cbranch_scc1 L_w151
    s_waitcnt vmcnt(6)
    s_bitcmp1_b64 s[18:19], 30
    s_cbranch_scc1 L_w151
    s_waitcnt vmcnt(5)
    s_bitcmp1_b64 s[18:19], 14
    s_cbranch_scc1 L_w151
    s_waitcnt vmcnt(4)
L_w151:
    buffer_load_dwordx4 v[236:239], v2, s[40:43], s66 offen offset:3072 nt
    v_dot2c_f32_bf16_dpp v12, v40, v200 row_newbcast:14 row_mask:0xf bank_mask:0xf
    v_dot2c_f32_bf16_dpp v13, v22, v200 row_newbcast:14 row_mask:0xf bank_mask:0xf
    v_dot2c_f32_bf16_dpp v14, v40, v201 row_newbcast:14 row_mask:0xf bank_mask:0xf
    v_dot2c_f32_bf16_dpp v15, v22, v201 row_newbcast:14 row_mask:0xf bank_mask:0xf
    v_dot2c_f32_bf16_dpp v16, v40, v202 row_newbcast:14 row_mask:0xf bank_mask:0xf
    v_dot2c_f32_bf16_dpp v17, v22, v202 row_newbcast:14 row_mask:0xf bank_mask:0xf
    v_dot2c_f32_bf16_dpp v18, v40, v203 row_newbcast:14 row_mask:0xf bank_mask:0xf
    v_dot2c_f32_bf16_dpp v19, v22, v203 row_newbcast:14 row_mask:0xf bank_mask:0xf
    s_waitcnt vmcnt(8)
    s_bitcmp1_b64 s[18:19], 49
    s_cbranch_scc1 L_w152
    s_waitcnt vmcnt(7)
    s_bitcmp1_b64 s[18:19], 33
    s_cbranch_scc1 L_w152
    s_waitcnt vmcnt(6)
    s_bitcmp1_b64 s[18:19], 17
    s_cbranch_scc1 L_w152
    s_waitcnt vmcnt(5)
    s_bitcmp1_b64 s[18:19], 1
    s_cbranch_scc1 L_w152
    s_waitcnt vmcnt(4)
L_w152:
    buffer_load_dwordx4 v[240:243], v1, s[40:43], s67 offen offset:0 nt
    ds_read_b32 v3, v31 offset:676
    s_memrealtime s[16:17]
    v_dot2c_f32_bf16_dpp v12, v40, v204 row_newbcast:15 row_mask:0xf bank_mask:0xf
    v_dot2c_f32_bf16_dpp v13, v22, v204 row_newbcast:15 row_mask:0xf bank_mask:0xf
    v_dot2c_f32_bf16_dpp v14, v40, v205 row_newbcast:15 row_mask:0xf bank_mask:0xf
    v_dot2c_f32_bf16_dpp v15, v22, v205 row_newbcast:15 row_mask:0xf bank_mask:0xf
    v_dot2c_f32_bf16_dpp v16, v40, v206 row_newbcast:15 row_mask:0xf bank_mask:0xf
    v_dot2c_f32_bf16_dpp v17, v22, v206 row_newbcast:15 row_mask:0xf bank_mask:0xf
    v_dot2c_f32_bf16_dpp v18, v40, v207 row_newbcast:15 row_mask:0xf bank_mask:0xf
    v_dot2c_f32_bf16_dpp v19, v22, v207 row_newbcast:15 row_mask:0xf bank_mask:0xf
    s_waitcnt vmcnt(8)
    s_waitcnt lgkmcnt(0)
    v_readfirstlane_b32 s15, v3
    s_sub_u32 s16, s16, s84
    s_sub_u32 s16, s16, s15
    s_sub_u32 s16, s16, 2436
    s_mul_i32 s16, s16, 61
    s_ashr_i32 s16, s16, 8
    s_max_i32 s16, s16, 0
    s_min_i32 s16, s16, 63
    s_bfm_b64 s[18:19], s16, 0
    s_bitcmp1_b64 s[18:19], 57
    s_cbranch_scc1 L_w153
    s_waitcnt vmcnt(7)
    s_bitcmp1_b64 s[18:19], 41
    s_cbranch_scc1 L_w153
    s_waitcnt vmcnt(6)
    s_bitcmp1_b64 s[18:19], 25
    s_cbranch_scc1 L_w153
    s_waitcnt vmcnt(5)
    s_bitcmp1_b64 s[18:19], 9
    s_cbranch_scc1 L_w153
    s_waitcnt vmcnt(4)
L_w153:
    buffer_load_dwordx4 v[244:247], v1, s[40:43], s67 offen offset:1024 nt
    v_dot2c_f32_bf16_dpp v12, v41, v208 row_newbcast:0 row_mask:0xf bank_mask:0xf
    v_dot2c_f32_bf16_dpp v13, v23, v208 row_newbcast:0 row_mask:0xf bank_mask:0xf
    v_dot2c_f32_bf16_dpp v14, v41, v209 row_newbcast:0 row_mask:0xf bank_mask:0xf
    v_dot2c_f32_bf16_dpp v15, v23, v209 row_newbcast:0 row_mask:0xf bank_mask:0xf
    v_dot2c_f32_bf16_dpp v16, v41, v210 row_newbcast:0 row_mask:0xf bank_mask:0xf
    v_dot2c_f32_bf16_dpp v17, v23, v210 row_newbcast:0 row_mask:0xf bank_mask:0xf
    v_dot2c_f32_bf16_dpp v18, v41, v211 row_newbcast:0 row_mask:0xf bank_mask:0xf
    v_dot2c_f32_bf16_dpp v19, v23, v211 row_newbcast:0 row_mask:0xf bank_mask:0xf
    s_waitcnt vmcnt(8)
    s_bitcmp1_b64 s[18:19], 53
    s_cbranch_scc1 L_w154
    s_waitcnt vmcnt(7)
    s_bitcmp1_b64 s[18:19], 37
    s_cbranch_scc1 L_w154
    s_waitcnt vmcnt(6)
    s_bitcmp1_b64 s[18:19], 21
    s_cbranch_scc1 L_w154
    s_waitcnt vmcnt(5)
    s_bitcmp1_b64 s[18:19], 5
    s_cbranch_scc1 L_w154
    s_waitcnt vmcnt(4)
L_w154:
    buffer_load_dwordx4 v[248:251], v1, s[40:43], s67 offen offset:2048 nt
    v_dot2c_f32_bf16_dpp v12, v41, v212 row_newbcast:1 row_mask:0xf bank_mask:0xf
    v_dot2c_f32_bf16_dpp v13, v23, v212 row_newbcast:1 row_mask:0xf bank_mask:0xf
    v_dot2c_f32_bf16_dpp v14, v41, v213 row_newbcast:1 row_mask:0xf bank_mask:0xf
    v_dot2c_f32_bf16_dpp v15, v23, v213 row_newbcast:1 row_mask:0xf bank_mask:0xf
    v_dot2c_f32_bf16_dpp v16, v41, v214 row_newbcast:1 row_mask:0xf bank_mask:0xf
    v_dot2c_f32_bf16_dpp v17, v23, v214 row_newbcast:1 row_mask:0xf bank_mask:0xf
    v_dot2c_f32_bf16_dpp v18, v41, v215 row_newbcast:1 row_mask:0xf bank_mask:0xf
    v_dot2c_f32_bf16_dpp v19, v23, v215 row_newbcast:1 row_mask:0xf bank_mask:0xf
    s_waitcnt vmcnt(8)
    s_bitcmp1_b64 s[18:19], 61
    s_cbranch_scc1 L_w155
    s_waitcnt vmcnt(7)
    s_bitcmp1_b64 s[18:19], 45
    s_cbranch_scc1 L_w155
    s_waitcnt vmcnt(6)
    s_bitcmp1_b64 s[18:19], 29
    s_cbranch_scc1 L_w155
    s_waitcnt vmcnt(5)
    s_bitcmp1_b64 s[18:19], 13
    s_cbranch_scc1 L_w155
    s_waitcnt vmcnt(4)
L_w155:
    buffer_load_dwordx4 v[252:255], v1, s[40:43], s67 offen offset:3072 nt
    v_dot2c_f32_bf16_dpp v12, v41, v216 row_newbcast:2 row_mask:0xf bank_mask:0xf
    v_dot2c_f32_bf16_dpp v13, v23, v216 row_newbcast:2 row_mask:0xf bank_mask:0xf
    v_dot2c_f32_bf16_dpp v14, v41, v217 row_newbcast:2 row_mask:0xf bank_mask:0xf
    v_dot2c_f32_bf16_dpp v15, v23, v217 row_newbcast:2 row_mask:0xf bank_mask:0xf
    v_dot2c_f32_bf16_dpp v16, v41, v218 row_newbcast:2 row_mask:0xf bank_mask:0xf
    v_dot2c_f32_bf16_dpp v17, v23, v218 row_newbcast:2 row_mask:0xf bank_mask:0xf
    v_dot2c_f32_bf16_dpp v18, v41, v219 row_newbcast:2 row_mask:0xf bank_mask:0xf
    v_dot2c_f32_bf16_dpp v19, v23, v219 row_newbcast:2 row_mask:0xf bank_mask:0xf
    s_waitcnt vmcnt(8)
    s_bitcmp1_b64 s[18:19], 51
    s_cbranch_scc1 L_w156
    s_waitcnt vmcnt(7)
    s_bitcmp1_b64 s[18:19], 35
    s_cbranch_scc1 L_w156
    s_waitcnt vmcnt(6)
    s_bitcmp1_b64 s[18:19], 19
    s_cbranch_scc1 L_w156
    s_waitcnt vmcnt(5)
    s_bitcmp1_b64 s[18:19], 3
    s_cbranch_scc1 L_w156
    s_waitcnt vmcnt(4)
L_w156:
    buffer_load_dwordx4 v[48:51], v2, s[40:43], s67 offen offset:0 nt
    v_dot2c_f32_bf16_dpp v12, v41, v220 row_newbcast:3 row_mask:0xf bank_mask:0xf
    v_dot2c_f32_bf16_dpp v13, v23, v220 row_newbcast:3 row_mask:0xf bank_mask:0xf
    v_dot2c_f32_bf16_dpp v14, v41, v221 row_newbcast:3 row_mask:0xf bank_mask:0xf
    v_dot2c_f32_bf16_dpp v15, v23, v221 row_newbcast:3 row_mask:0xf bank_mask:0xf
    v_dot2c_f32_bf16_dpp v16, v41, v222 row_newbcast:3 row_mask:0xf bank_mask:0xf
    v_dot2c_f32_bf16_dpp v17, v23, v222 row_newbcast:3 row_mask:0xf bank_mask:0xf
    v_dot2c_f32_bf16_dpp v18, v41, v223 row_newbcast:3 row_mask:0xf bank_mask:0xf
    v_dot2c_f32_bf16_dpp v19, v23, v223 row_newbcast:3 row_mask:0xf bank_mask:0xf
    s_waitcnt vmcnt(8)
    s_bitcmp1_b64 s[18:19], 59
    s_cbranch_scc1 L_w157
    s_waitcnt vmcnt(7)
    s_bitcmp1_b64 s[18:19], 43
    s_cbranch_scc1 L_w157
    s_waitcnt vmcnt(6)
    s_bitcmp1_b64 s[18:19], 27
    s_cbranch_scc1 L_w157
    s_waitcnt vmcnt(5)
    s_bitcmp1_b64 s[18:19], 11
    s_cbranch_scc1 L_w157
    s_waitcnt vmcnt(4)
L_w157:
    buffer_load_dwordx4 v[52:55], v2, s[40:43], s67 offen offset:1024 nt
    v_dot2c_f32_bf16_dpp v12, v41, v224 row_newbcast:4 row_mask:0xf bank_mask:0xf
    v_dot2c_f32_bf16_dpp v13, v23, v224 row_newbcast:4 row_mask:0xf bank_mask:0xf
    v_dot2c_f32_bf16_dpp v14, v41, v225 row_newbcast:4 row_mask:0xf bank_mask:0xf
    v_dot2c_f32_bf16_dpp v15, v23, v225 row_newbcast:4 row_mask:0xf bank_mask:0xf
    v_dot2c_f32_bf16_dpp v16, v41, v226 row_newbcast:4 row_mask:0xf bank_mask:0xf
    v_dot2c_f32_bf16_dpp v17, v23, v226 row_newbcast:4 row_mask:0xf bank_mask:0xf
    v_dot2c_f32_bf16_dpp v18, v41, v227 row_newbcast:4 row_mask:0xf bank_mask:0xf
    v_dot2c_f32_bf16_dpp v19, v23, v227 row_newbcast:4 row_mask:0xf bank_mask:0xf
    s_waitcnt vmcnt(8)
    s_bitcmp1_b64 s[18:19], 55
    s_cbranch_scc1 L_w158
    s_waitcnt vmcnt(7)
    s_bitcmp1_b64 s[18:19], 39
    s_cbranch_scc1 L_w158
    s_waitcnt vmcnt(6)
    s_bitcmp1_b64 s[18:19], 23
    s_cbranch_scc1 L_w158
    s_waitcnt vmcnt(5)
    s_bitcmp1_b64 s[18:19], 7
    s_cbranch_scc1 L_w158
    s_waitcnt vmcnt(4)
L_w158:
    buffer_load_dwordx4 v[56:59], v2, s[40:43], s67 offen offset:2048 nt
    ds_read_b32 v3, v31 offset:676
    s_memrealtime s[16:17]
    v_dot2c_f32_bf16_dpp v12, v41, v228 row_newbcast:5 row_mask:0xf bank_mask:0xf
    v_dot2c_f32_bf16_dpp v13, v23, v228 row_newbcast:5 row_mask:0xf bank_mask:0xf
    v_dot2c_f32_bf16_dpp v14, v41, v229 row_newbcast:5 row_mask:0xf bank_mask:0xf
    v_dot2c_f32_bf16_dpp v15, v23, v229 row_newbcast:5 row_mask:0xf bank_mask:0xf
    v_dot2c_f32_bf16_dpp v16, v41, v230 row_newbcast:5 row_mask:0xf bank_mask:0xf
    v_dot2c_f32_bf16_dpp v17, v23, v230 row_newbcast:5 row_mask:0xf bank_mask:0xf
    v_dot2c_f32_bf16_dpp v18, v41, v231 row_newbcast:5 row_mask:0xf bank_mask:0xf
    v_dot2c_f32_bf16_dpp v19, v23, v231 row_newbcast:5 row_mask:0xf bank_mask:0xf
    s_waitcnt vmcnt(8)
    s_waitcnt lgkmcnt(0)
    v_readfirstlane_b32 s15, v3
    s_sub_u32 s16, s16, s84
    s_sub_u32 s16, s16, s15
    s_sub_u32 s16, s16, 2514
    s_mul_i32 s16, s16, 61
    s_ashr_i32 s16, s16, 8
    s_max_i32 s16, s16, 0
    s_min_i32 s16, s16, 63
    s_bfm_b64 s[18:19], s16, 0
    s_bitcmp1_b64 s[18:19], 63
    s_cbranch_scc1 L_w159
    s_waitcnt vmcnt(7)
    s_bitcmp1_b64 s[18:19], 47
    s_cbranch_scc1 L_w159
    s_waitcnt vmcnt(6)
    s_bitcmp1_b64 s[18:19], 31
    s_cbranch_scc1 L_w159
    s_waitcnt vmcnt(5)
    s_bitcmp1_b64 s[18:19], 15
    s_cbranch_scc1 L_w159
    s_waitcnt vmcnt(4)
L_w159:
    buffer_load_dwordx4 v[60:63], v2, s[40:43], s67 offen offset:3072 nt
    v_dot2c_f32_bf16_dpp v12, v41, v232 row_newbcast:6 row_mask:0xf bank_mask:0xf
    v_dot2c_f32_bf16_dpp v13, v23, v232 row_newbcast:6 row_mask:0xf bank_mask:0xf
    v_dot2c_f32_bf16_dpp v14, v41, v233 row_newbcast:6 row_mask:0xf bank_mask:0xf
    v_dot2c_f32_bf16_dpp v15, v23, v233 row_newbcast:6 row_mask:0xf bank_mask:0xf
    v_dot2c_f32_bf16_dpp v16, v41, v234 row_newbcast:6 row_mask:0xf bank_mask:0xf
    v_dot2c_f32_bf16_dpp v17, v23, v234 row_newbcast:6 row_mask:0xf bank_mask:0xf
    v_dot2c_f32_bf16_dpp v18, v41, v235 row_newbcast:6 row_mask:0xf bank_mask:0xf
    v_dot2c_f32_bf16_dpp v19, v23, v235 row_newbcast:6 row_mask:0xf bank_mask:0xf
    s_waitcnt vmcnt(8)
    s_bitcmp1_b64 s[18:19], 48
    s_cbranch_scc1 L_w160
    s_waitcnt vmcnt(7)
    s_bitcmp1_b64 s[18:19], 32
    s_cbranch_scc1 L_w160
    s_waitcnt vmcnt(6)
    s_bitcmp1_b64 s[18:19], 16
    s_cbranch_scc1 L_w160
    s_waitcnt vmcnt(5)
    s_bitcmp1_b64 s[18:19], 0
    s_cbranch_scc1 L_w160
    s_waitcnt vmcnt(4)
L_w160:
    buffer_load_dwordx4 v[64:67], v1, s[40:43], s68 offen offset:0 nt
    v_dot2c_f32_bf16_dpp v12, v41, v236 row_newbcast:7 row_mask:0xf bank_mask:0xf
    v_dot2c_f32_bf16_dpp v13, v23, v236 row_newbcast:7 row_mask:0xf bank_mask:0xf
    v_dot2c_f32_bf16_dpp v14, v41, v237 row_newbcast:7 row_mask:0xf bank_mask:0xf
    v_dot2c_f32_bf16_dpp v15, v23, v237 row_newbcast:7 row_mask:0xf bank_mask:0xf
    v_dot2c_f32_bf16_dpp v16, v41, v238 row_newbcast:7 row_mask:0xf bank_mask:0xf
    v_dot2c_f32_bf16_dpp v17, v23, v238 row_newbcast:7 row_mask:0xf bank_mask:0xf
    v_dot2c_f32_bf16_dpp v18, v41, v239 row_newbcast:7 row_mask:0xf bank_mask:0xf
    v_dot2c_f32_bf16_dpp v19, v23, v239 row_newbcast:7 row_mask:0xf bank_mask:0xf
    s_waitcnt vmcnt(8)
    s_bitcmp1_b64 s[18:19], 56
    s_cbranch_scc1 L_w161
    s_waitcnt vmcnt(7)
    s_bitcmp1_b64 s[18:19], 40
    s_cbranch_scc1 L_w161
    s_waitcnt vmcnt(6)
    s_bitcmp1_b64 s[18:19], 24
    s_cbranch_scc1 L_w161
    s_waitcnt vmcnt(5)
    s_bitcmp1_b64 s[18:19], 8
    s_cbranch_scc1 L_w161
    s_waitcnt vmcnt(4)
L_w161:
    buffer_load_dwordx4 v[68:71], v1, s[40:43], s68 offen offset:1024 nt
    v_dot2c_f32_bf16_dpp v12, v41, v240 row_newbcast:8 row_mask:0xf bank_mask:0xf
    v_dot2c_f32_bf16_dpp v13, v23, v240 row_newbcast:8 row_mask:0xf bank_mask:0xf
    v_dot2c_f32_bf16_dpp v14, v41, v241 row_newbcast:8 row_mask:0xf bank_mask:0xf
    v_dot2c_f32_bf16_dpp v15, v23, v241 row_newbcast:8 row_mask:0xf bank_mask:0xf
    v_dot2c_f32_bf16_dpp v16, v41, v242 row_newbcast:8 row_mask:0xf bank_mask:0xf
    v_dot2c_f32_bf16_dpp v17, v23, v242 row_newbcast:8 row_mask:0xf bank_mask:0xf
    v_dot2c_f32_bf16_dpp v18, v41, v243 row_newbcast:8 row_mask:0xf bank_mask:0xf
    v_dot2c_f32_bf16_dpp v19, v23, v243 row_newbcast:8 row_mask:0xf bank_mask:0xf
    s_waitcnt vmcnt(8)
    s_bitcmp1_b64 s[18:19], 52
    s_cbranch_scc1 L_w162
    s_waitcnt vmcnt(7)
    s_bitcmp1_b64 s[18:19], 36
    s_cbranch_scc1 L_w162
    s_waitcnt vmcnt(6)
    s_bitcmp1_b64 s[18:19], 20
    s_cbranch_scc1 L_w162
    s_waitcnt vmcnt(5)
    s_bitcmp1_b64 s[18:19], 4
    s_cbranch_scc1 L_w162
    s_waitcnt vmcnt(4)
L_w162:
    buffer_load_dwordx4 v[72:75], v1, s[40:43], s68 offen offset:2048 nt
    v_dot2c_f32_bf16_dpp v12, v41, v244 row_newbcast:9 row_mask:0xf bank_mask:0xf
    v_dot2c_f32_bf16_dpp v13, v23, v244 row_newbcast:9 row_mask:0xf bank_mask:0xf
    v_dot2c_f32_bf16_dpp v14, v41, v245 row_newbcast:9 row_mask:0xf bank_mask:0xf
    v_dot2c_f32_bf16_dpp v15, v23, v245 row_newbcast:9 row_mask:0xf bank_mask:0xf
    v_dot2c_f32_bf16_dpp v16, v41, v246 row_newbcast:9 row_mask:0xf bank_mask:0xf
    v_dot2c_f32_bf16_dpp v17, v23, v246 row_newbcast:9 row_mask:0xf bank_mask:0xf
    v_dot2c_f32_bf16_dpp v18, v41, v247 row_newbcast:9 row_mask:0xf bank_mask:0xf
    v_dot2c_f32_bf16_dpp v19, v23, v247 row_newbcast:9 row_mask:0xf bank_mask:0xf
    s_waitcnt vmcnt(8)
    s_bitcmp1_b64 s[18:19], 60
    s_cbranch_scc1 L_w163
    s_waitcnt vmcnt(7)
    s_bitcmp1_b64 s[18:19], 44
    s_cbranch_scc1 L_w163
    s_waitcnt vmcnt(6)
    s_bitcmp1_b64 s[18:19], 28
    s_cbranch_scc1 L_w163
    s_waitcnt vmcnt(5)
    s_bitcmp1_b64 s[18:19], 12
    s_cbranch_scc1 L_w163
    s_waitcnt vmcnt(4)
L_w163:
    buffer_load_dwordx4 v[76:79], v1, s[40:43], s68 offen offset:3072 nt
    v_dot2c_f32_bf16_dpp v12, v41, v248 row_newbcast:10 row_mask:0xf bank_mask:0xf
    v_dot2c_f32_bf16_dpp v13, v23, v248 row_newbcast:10 row_mask:0xf bank_mask:0xf
    v_dot2c_f32_bf16_dpp v14, v41, v249 row_newbcast:10 row_mask:0xf bank_mask:0xf
    v_dot2c_f32_bf16_dpp v15, v23, v249 row_newbcast:10 row_mask:0xf bank_mask:0xf
    v_dot2c_f32_bf16_dpp v16, v41, v250 row_newbcast:10 row_mask:0xf bank_mask:0xf
    v_dot2c_f32_bf16_dpp v17, v23, v250 row_newbcast:10 row_mask:0xf bank_mask:0xf
    v_dot2c_f32_bf16_dpp v18, v41, v251 row_newbcast:10 row_mask:0xf bank_mask:0xf
    v_dot2c_f32_bf16_dpp v19, v23, v251 row_newbcast:10 row_mask:0xf bank_mask:0xf
    s_waitcnt vmcnt(8)
    s_bitcmp1_b64 s[18:19], 50
    s_cbranch_scc1 L_w164
    s_waitcnt vmcnt(7)
    s_bitcmp1_b64 s[18:19], 34
    s_cbranch_scc1 L_w164
    s_waitcnt vmcnt(6)
    s_bitcmp1_b64 s[18:19], 18
    s_cbranch_scc1 L_w164
    s_waitcnt vmcnt(5)
    s_bitcmp1_b64 s[18:19], 2
    s_cbranch_scc1 L_w164
    s_waitcnt vmcnt(4)
L_w164:
    buffer_load_dwordx4 v[80:83], v2, s[40:43], s68 offen offset:0 nt
    ds_read_b32 v3, v31 offset:676
    s_memrealtime s[16:17]
    v_dot2c_f32_bf16_dpp v12, v41, v252 row_newbcast:11 row_mask:0xf bank_mask:0xf
    v_dot2c_f32_bf16_dpp v13, v23, v252 row_newbcast:11 row_mask:0xf bank_mask:0xf
    v_dot2c_f32_bf16_dpp v14, v41, v253 row_newbcast:11 row_mask:0xf bank_mask:0xf
    v_dot2c_f32_bf16_dpp v15, v23, v253 row_newbcast:11 row_mask:0xf bank_mask:0xf
    v_dot2c_f32_bf16_dpp v16, v41, v254 row_newbcast:11 row_mask:0xf bank_mask:0xf
    v_dot2c_f32_bf16_dpp v17, v23, v254 row_newbcast:11 row_mask:0xf bank_mask:0xf
    v_dot2c_f32_bf16_dpp v18, v41, v255 row_newbcast:11 row_mask:0xf bank_mask:0xf
    v_dot2c_f32_bf16_dpp v19, v23, v255 row_newbcast:11 row_mask:0xf bank_mask:0xf
    s_waitcnt vmcnt(8)
    s_waitcnt lgkmcnt(0)
    v_readfirstlane_b32 s15, v3
    s_sub_u32 s16, s16, s84
    s_sub_u32 s16, s16, s15
    s_sub_u32 s16, s16, 2593
    s_mul_i32 s16, s16, 61
    s_ashr_i32 s16, s16, 8
    s_max_i32 s16, s16, 0
    s_min_i32 s16, s16, 63
    s_bfm_b64 s[18:19], s16, 0
    s_bitcmp1_b64 s[18:19], 58
    s_cbranch_scc1 L_w165
    s_waitcnt vmcnt(7)
    s_bitcmp1_b64 s[18:19], 42
    s_cbranch_scc1 L_w165
    s_waitcnt vmcnt(6)
    s_bitcmp1_b64 s[18:19], 26
    s_cbranch_scc1 L_w165
    s_waitcnt vmcnt(5)
    s_bitcmp1_b64 s[18:19], 10
    s_cbranch_scc1 L_w165
    s_waitcnt vmcnt(4)
L_w165:
    buffer_load_dwordx4 v[84:87], v2, s[40:43], s68 offen offset:1024 nt
    v_dot2c_f32_bf16_dpp v12, v41, v48 row_newbcast:12 row_mask:0xf bank_mask:0xf
    v_dot2c_f32_bf16_dpp v13, v23, v48 row_newbcast:12 row_mask:0xf bank_mask:0xf
    v_dot2c_f32_bf16_dpp v14, v41, v49 row_newbcast:12 row_mask:0xf bank_mask:0xf
    v_dot2c_f32_bf16_dpp v15, v23, v49 row_newbcast:12 row_mask:0xf bank_mask:0xf
    v_dot2c_f32_bf16_dpp v16, v41, v50 row_newbcast:12 row_mask:0xf bank_mask:0xf
    v_dot2c_f32_bf16_dpp v17, v23, v50 row_newbcast:12 row_mask:0xf bank_mask:0xf
    v_dot2c_f32_bf16_dpp v18, v41, v51 row_newbcast:12 row_mask:0xf bank_mask:0xf
    v_dot2c_f32_bf16_dpp v19, v23, v51 row_newbcast:12 row_mask:0xf bank_mask:0xf
    s_waitcnt vmcnt(8)
    s_bitcmp1_b64 s[18:19], 54
    s_cbranch_scc1 L_w166
    s_waitcnt vmcnt(7)
    s_bitcmp1_b64 s[18:19], 38
    s_cbranch_scc1 L_w166
    s_waitcnt vmcnt(6)
    s_bitcmp1_b64 s[18:19], 22
    s_cbranch_scc1 L_w166
    s_waitcnt vmcnt(5)
    s_bitcmp1_b64 s[18:19], 6
    s_cbranch_scc1 L_w166
    s_waitcnt vmcnt(4)
L_w166:
    buffer_load_dwordx4 v[88:91], v2, s[40:43], s68 offen offset:2048 nt
    v_dot2c_f32_bf16_dpp v12, v41, v52 row_newbcast:13 row_mask:0xf bank_mask:0xf
    v_dot2c_f32_bf16_dpp v13, v23, v52 row_newbcast:13 row_mask:0xf bank_mask:0xf
    v_dot2c_f32_bf16_dpp v14, v41, v53 row_newbcast:13 row_mask:0xf bank_mask:0xf
    v_dot2c_f32_bf16_dpp v15, v23, v53 row_newbcast:13 row_mask:0xf bank_mask:0xf
    v_dot2c_f32_bf16_dpp v16, v41, v54 row_newbcast:13 row_mask:0xf bank_mask:0xf
    v_dot2c_f32_bf16_dpp v17, v23, v54 row_newbcast:13 row_mask:0xf bank_mask:0xf
    v_dot2c_f32_bf16_dpp v18, v41, v55 row_newbcast:13 row_mask:0xf bank_mask:0xf
    v_dot2c_f32_bf16_dpp v19, v23, v55 row_newbcast:13 row_mask:0xf bank_mask:0xf
    s_waitcnt vmcnt(8)
    s_bitcmp1_b64 s[18:19], 62
    s_cbranch_scc1 L_w167
    s_waitcnt vmcnt(7)
    s_bitcmp1_b64 s[18:19], 46
    s_cbranch_scc1 L_w167
    s_waitcnt vmcnt(6)
    s_bitcmp1_b64 s[18:19], 30
    s_cbranch_scc1 L_w167
    s_waitcnt vmcnt(5)
    s_bitcmp1_b64 s[18:19], 14
    s_cbranch_scc1 L_w167
    s_waitcnt vmcnt(4)
L_w167:
    buffer_load_dwordx4 v[92:95], v2, s[40:43], s68 offen offset:3072 nt
    v_dot2c_f32_bf16_dpp v12, v41, v56 row_newbcast:14 row_mask:0xf bank_mask:0xf
    v_dot2c_f32_bf16_dpp v13, v23, v56 row_newbcast:14 row_mask:0xf bank_mask:0xf
    v_dot2c_f32_bf16_dpp v14, v41, v57 row_newbcast:14 row_mask:0xf bank_mask:0xf
    v_dot2c_f32_bf16_dpp v15, v23, v57 row_newbcast:14 row_mask:0xf bank_mask:0xf
    v_dot2c_f32_bf16_dpp v16, v41, v58 row_newbcast:14 row_mask:0xf bank_mask:0xf
    v_dot2c_f32_bf16_dpp v17, v23, v58 row_newbcast:14 row_mask:0xf bank_mask:0xf
    v_dot2c_f32_bf16_dpp v18, v41, v59 row_newbcast:14 row_mask:0xf bank_mask:0xf
    v_dot2c_f32_bf16_dpp v19, v23, v59 row_newbcast:14 row_mask:0xf bank_mask:0xf
    s_waitcnt vmcnt(8)
    s_bitcmp1_b64 s[18:19], 49
    s_cbranch_scc1 L_w168
    s_waitcnt vmcnt(7)
    s_bitcmp1_b64 s[18:19], 33
    s_cbranch_scc1 L_w168
    s_waitcnt vmcnt(6)
    s_bitcmp1_b64 s[18:19], 17
    s_cbranch_scc1 L_w168
    s_waitcnt vmcnt(5)
    s_bitcmp1_b64 s[18:19], 1
    s_cbranch_scc1 L_w168
    s_waitcnt vmcnt(4)
L_w168:
    buffer_load_dwordx4 v[96:99], v1, s[40:43], s69 offen offset:0 nt
    v_dot2c_f32_bf16_dpp v12, v41, v60 row_newbcast:15 row_mask:0xf bank_mask:0xf
    v_dot2c_f32_bf16_dpp v13, v23, v60 row_newbcast:15 row_mask:0xf bank_mask:0xf
    v_dot2c_f32_bf16_dpp v14, v41, v61 row_newbcast:15 row_mask:0xf bank_mask:0xf
    v_dot2c_f32_bf16_dpp v15, v23, v61 row_newbcast:15 row_mask:0xf bank_mask:0xf
    v_dot2c_f32_bf16_dpp v16, v41, v62 row_newbcast:15 row_mask:0xf bank_mask:0xf
    v_dot2c_f32_bf16_dpp v17, v23, v62 row_newbcast:15 row_mask:0xf bank_mask:0xf
    v_dot2c_f32_bf16_dpp v18, v41, v63 row_newbcast:15 row_mask:0xf bank_mask:0xf
    v_dot2c_f32_bf16_dpp v19, v23, v63 row_newbcast:15 row_mask:0xf bank_mask:0xf
    s_waitcnt vmcnt(8)
    s_bitcmp1_b64 s[18:19], 57
    s_cbranch_scc1 L_w169
    s_waitcnt vmcnt(7)
    s_bitcmp1_b64 s[18:19], 41
    s_cbranch_scc1 L_w169
    s_waitcnt vmcnt(6)
    s_bitcmp1_b64 s[18:19], 25
    s_cbranch_scc1 L_w169
    s_waitcnt vmcnt(5)
    s_bitcmp1_b64 s[18:19], 9
    s_cbranch_scc1 L_w169
    s_waitcnt vmcnt(4)
L_w169:
    buffer_load_dwordx4 v[100:103], v1, s[40:43], s69 offen offset:1024 nt
    v_dot2c_f32_bf16_dpp v12, v42, v64 row_newbcast:0 row_mask:0xf bank_mask:0xf
    v_dot2c_f32_bf16_dpp v13, v24, v64 row_newbcast:0 row_mask:0xf bank_mask:0xf
    v_dot2c_f32_bf16_dpp v14, v42, v65 row_newbcast:0 row_mask:0xf bank_mask:0xf
    v_dot2c_f32_bf16_dpp v15, v24, v65 row_newbcast:0 row_mask:0xf bank_mask:0xf
    v_dot2c_f32_bf16_dpp v16, v42, v66 row_newbcast:0 row_mask:0xf bank_mask:0xf
    v_dot2c_f32_bf16_dpp v17, v24, v66 row_newbcast:0 row_mask:0xf bank_mask:0xf
    v_dot2c_f32_bf16_dpp v18, v42, v67 row_newbcast:0 row_mask:0xf bank_mask:0xf
    v_dot2c_f32_bf16_dpp v19, v24, v67 row_newbcast:0 row_mask:0xf bank_mask:0xf
    s_waitcnt vmcnt(8)
    s_bitcmp1_b64 s[18:19], 53
    s_cbranch_scc1 L_w170
    s_waitcnt vmcnt(7)
    s_bitcmp1_b64 s[18:19], 37
    s_cbranch_scc1 L_w170
    s_waitcnt vmcnt(6)
    s_bitcmp1_b64 s[18:19], 21
    s_cbranch_scc1 L_w170
    s_waitcnt vmcnt(5)
    s_bitcmp1_b64 s[18:19], 5
    s_cbranch_scc1 L_w170
    s_waitcnt vmcnt(4)
L_w170:
    buffer_load_dwordx4 v[104:107], v1, s[40:43], s69 offen offset:2048 nt
    ds_read_b32 v3, v31 offset:676
    s_memrealtime s[16:17]
    v_dot2c_f32_bf16_dpp v12, v42, v68 row_newbcast:1 row_mask:0xf bank_mask:0xf
    v_dot2c_f32_bf16_dpp v13, v24, v68 row_newbcast:1 row_mask:0xf bank_mask:0xf
    v_dot2c_f32_bf16_dpp v14, v42, v69 row_newbcast:1 row_mask:0xf bank_mask:0xf
    v_dot2c_f32_bf16_dpp v15, v24, v69 row_newbcast:1 row_mask:0xf bank_mask:0xf
    v_dot2c_f32_bf16_dpp v16, v42, v70 row_newbcast:1 row_mask:0xf bank_mask:0xf
    v_dot2c_f32_bf16_dpp v17, v24, v70 row_newbcast:1 row_mask:0xf bank_mask:0xf
    v_dot2c_f32_bf16_dpp v18, v42, v71 row_newbcast:1 row_mask:0xf bank_mask:0xf
    v_dot2c_f32_bf16_dpp v19, v24, v71 row_newbcast:1 row_mask:0xf bank_mask:0xf
    s_waitcnt vmcnt(8)
    s_waitcnt lgkmcnt(0)
    v_readfirstlane_b32 s15, v3
    s_sub_u32 s16, s16, s84
    s_sub_u32 s16, s16, s15
    s_sub_u32 s16, s16, 2672
    s_mul_i32 s16, s16, 61
    s_ashr_i32 s16, s16, 8
    s_max_i32 s16, s16, 0
    s_min_i32 s16, s16, 63
    s_bfm_b64 s[18:19], s16, 0
    s_bitcmp1_b64 s[18:19], 61
    s_cbranch_scc1 L_w171
    s_waitcnt vmcnt(7)
    s_bitcmp1_b64 s[18:19], 45
    s_cbranch_scc1 L_w171
    s_waitcnt vmcnt(6)
    s_bitcmp1_b64 s[18:19], 29
    s_cbranch_scc1 L_w171
    s_waitcnt vmcnt(5)
    s_bitcmp1_b64 s[18:19], 13
    s_cbranch_scc1 L_w171
    s_waitcnt vmcnt(4)
L_w171:
    buffer_load_dwordx4 v[108:111], v1, s[40:43], s69 offen offset:3072 nt
    v_dot2c_f32_bf16_dpp v12, v42, v72 row_newbcast:2 row_mask:0xf bank_mask:0xf
    v_dot2c_f32_bf16_dpp v13, v24, v72 row_newbcast:2 row_mask:0xf bank_mask:0xf
    v_dot2c_f32_bf16_dpp v14, v42, v73 row_newbcast:2 row_mask:0xf bank_mask:0xf
    v_dot2c_f32_bf16_dpp v15, v24, v73 row_newbcast:2 row_mask:0xf bank_mask:0xf
    v_dot2c_f32_bf16_dpp v16, v42, v74 row_newbcast:2 row_mask:0xf bank_mask:0xf
    v_dot2c_f32_bf16_dpp v17, v24, v74 row_newbcast:2 row_mask:0xf bank_mask:0xf
    v_dot2c_f32_bf16_dpp v18, v42, v75 row_newbcast:2 row_mask:0xf bank_mask:0xf
    v_dot2c_f32_bf16_dpp v19, v24, v75 row_newbcast:2 row_mask:0xf bank_mask:0xf
    s_waitcnt vmcnt(8)
    s_bitcmp1_b64 s[18:19], 51
    s_cbranch_scc1 L_w172
    s_waitcnt vmcnt(7)
    s_bitcmp1_b64 s[18:19], 35
    s_cbranch_scc1 L_w172
    s_waitcnt vmcnt(6)
    s_bitcmp1_b64 s[18:19], 19
    s_cbranch_scc1 L_w172
    s_waitcnt vmcnt(5)
    s_bitcmp1_b64 s[18:19], 3
    s_cbranch_scc1 L_w172
    s_waitcnt vmcnt(4)
L_w172:
    buffer_load_dwordx4 v[112:115], v2, s[40:43], s69 offen offset:0 nt
    v_dot2c_f32_bf16_dpp v12, v42, v76 row_newbcast:3 row_mask:0xf bank_mask:0xf
    v_dot2c_f32_bf16_dpp v13, v24, v76 row_newbcast:3 row_mask:0xf bank_mask:0xf
    v_dot2c_f32_bf16_dpp v14, v42, v77 row_newbcast:3 row_mask:0xf bank_mask:0xf
    v_dot2c_f32_bf16_dpp v15, v24, v77 row_newbcast:3 row_mask:0xf bank_mask:0xf
    v_dot2c_f32_bf16_dpp v16, v42, v78 row_newbcast:3 row_mask:0xf bank_mask:0xf
    v_dot2c_f32_bf16_dpp v17, v24, v78 row_newbcast:3 row_mask:0xf bank_mask:0xf
    v_dot2c_f32_bf16_dpp v18, v42, v79 row_newbcast:3 row_mask:0xf bank_mask:0xf
    v_dot2c_f32_bf16_dpp v19, v24, v79 row_newbcast:3 row_mask:0xf bank_mask:0xf
    s_waitcnt vmcnt(8)
    s_bitcmp1_b64 s[18:19], 59
    s_cbranch_scc1 L_w173
    s_waitcnt vmcnt(7)
    s_bitcmp1_b64 s[18:19], 43
    s_cbranch_scc1 L_w173
    s_waitcnt vmcnt(6)
    s_bitcmp1_b64 s[18:19], 27
    s_cbranch_scc1 L_w173
    s_waitcnt vmcnt(5)
    s_bitcmp1_b64 s[18:19], 11
    s_cbranch_scc1 L_w173
    s_waitcnt vmcnt(4)
L_w173:
    buffer_load_dwordx4 v[116:119], v2, s[40:43], s69 offen offset:1024 nt
    v_dot2c_f32_bf16_dpp v12, v42, v80 row_newbcast:4 row_mask:0xf bank_mask:0xf
    v_dot2c_f32_bf16_dpp v13, v24, v80 row_newbcast:4 row_mask:0xf bank_mask:0xf
    v_dot2c_f32_bf16_dpp v14, v42, v81 row_newbcast:4 row_mask:0xf bank_mask:0xf
    v_dot2c_f32_bf16_dpp v15, v24, v81 row_newbcast:4 row_mask:0xf bank_mask:0xf
    v_dot2c_f32_bf16_dpp v16, v42, v82 row_newbcast:4 row_mask:0xf bank_mask:0xf
    v_dot2c_f32_bf16_dpp v17, v24, v82 row_newbcast:4 row_mask:0xf bank_mask:0xf
    v_dot2c_f32_bf16_dpp v18, v42, v83 row_newbcast:4 row_mask:0xf bank_mask:0xf
    v_dot2c_f32_bf16_dpp v19, v24, v83 row_newbcast:4 row_mask:0xf bank_mask:0xf
    s_waitcnt vmcnt(8)
    s_bitcmp1_b64 s[18:19], 55
    s_cbranch_scc1 L_w174
    s_waitcnt vmcnt(7)
    s_bitcmp1_b64 s[18:19], 39
    s_cbranch_scc1 L_w174
    s_waitcnt vmcnt(6)
    s_bitcmp1_b64 s[18:19], 23
    s_cbranch_scc1 L_w174
    s_waitcnt vmcnt(5)
    s_bitcmp1_b64 s[18:19], 7
    s_cbranch_scc1 L_w174
    s_waitcnt vmcnt(4)
L_w174:
    buffer_load_dwordx4 v[120:123], v2, s[40:43], s69 offen offset:2048 nt
    v_dot2c_f32_bf16_dpp v12, v42, v84 row_newbcast:5 row_mask:0xf bank_mask:0xf
    v_dot2c_f32_bf16_dpp v13, v24, v84 row_newbcast:5 row_mask:0xf bank_mask:0xf
    v_dot2c_f32_bf16_dpp v14, v42, v85 row_newbcast:5 row_mask:0xf bank_mask:0xf
    v_dot2c_f32_bf16_dpp v15, v24, v85 row_newbcast:5 row_mask:0xf bank_mask:0xf
    v_dot2c_f32_bf16_dpp v16, v42, v86 row_newbcast:5 row_mask:0xf bank_mask:0xf
    v_dot2c_f32_bf16_dpp v17, v24, v86 row_newbcast:5 row_mask:0xf bank_mask:0xf
    v_dot2c_f32_bf16_dpp v18, v42, v87 row_newbcast:5 row_mask:0xf bank_mask:0xf
    v_dot2c_f32_bf16_dpp v19, v24, v87 row_newbcast:5 row_mask:0xf bank_mask:0xf
    s_waitcnt vmcnt(8)
    s_bitcmp1_b64 s[18:19], 63
    s_cbranch_scc1 L_w175
    s_waitcnt vmcnt(7)
    s_bitcmp1_b64 s[18:19], 47
    s_cbranch_scc1 L_w175
    s_waitcnt vmcnt(6)
    s_bitcmp1_b64 s[18:19], 31
    s_cbranch_scc1 L_w175
    s_waitcnt vmcnt(5)
    s_bitcmp1_b64 s[18:19], 15
    s_cbranch_scc1 L_w175
    s_waitcnt vmcnt(4)
L_w175:
    buffer_load_dwordx4 v[124:127], v2, s[40:43], s69 offen offset:3072 nt
    v_dot2c_f32_bf16_dpp v12, v42, v88 row_newbcast:6 row_mask:0xf bank_mask:0xf
    v_dot2c_f32_bf16_dpp v13, v24, v88 row_newbcast:6 row_mask:0xf bank_mask:0xf
    v_dot2c_f32_bf16_dpp v14, v42, v89 row_newbcast:6 row_mask:0xf bank_mask:0xf
    v_dot2c_f32_bf16_dpp v15, v24, v89 row_newbcast:6 row_mask:0xf bank_mask:0xf
    v_dot2c_f32_bf16_dpp v16, v42, v90 row_newbcast:6 row_mask:0xf bank_mask:0xf
    v_dot2c_f32_bf16_dpp v17, v24, v90 row_newbcast:6 row_mask:0xf bank_mask:0xf
    v_dot2c_f32_bf16_dpp v18, v42, v91 row_newbcast:6 row_mask:0xf bank_mask:0xf
    v_dot2c_f32_bf16_dpp v19, v24, v91 row_newbcast:6 row_mask:0xf bank_mask:0xf
    s_waitcnt vmcnt(8)
    s_bitcmp1_b64 s[18:19], 48
    s_cbranch_scc1 L_w176
    s_waitcnt vmcnt(7)
    s_bitcmp1_b64 s[18:19], 32
    s_cbranch_scc1 L_w176
    s_waitcnt vmcnt(6)
    s_bitcmp1_b64 s[18:19], 16
    s_cbranch_scc1 L_w176
    s_waitcnt vmcnt(5)
    s_bitcmp1_b64 s[18:19], 0
    s_cbranch_scc1 L_w176
    s_waitcnt vmcnt(4)
L_w176:
    buffer_load_dwordx4 v[128:131], v1, s[52:55], s64 offen offset:0 nt
    ds_read_b32 v3, v31 offset:676
    s_memrealtime s[16:17]
    v_dot2c_f32_bf16_dpp v12, v42, v92 row_newbcast:7 row_mask:0xf bank_mask:0xf
    v_dot2c_f32_bf16_dpp v13, v24, v92 row_newbcast:7 row_mask:0xf bank_mask:0xf
    v_dot2c_f32_bf16_dpp v14, v42, v93 row_newbcast:7 row_mask:0xf bank_mask:0xf
    v_dot2c_f32_bf16_dpp v15, v24, v93 row_newbcast:7 row_mask:0xf bank_mask:0xf
    v_dot2c_f32_bf16_dpp v16, v42, v94 row_newbcast:7 row_mask:0xf bank_mask:0xf
    v_dot2c_f32_bf16_dpp v17, v24, v94 row_newbcast:7 row_mask:0xf bank_mask:0xf
    v_dot2c_f32_bf16_dpp v18, v42, v95 row_newbcast:7 row_mask:0xf bank_mask:0xf
    v_dot2c_f32_bf16_dpp v19, v24, v95 row_newbcast:7 row_mask:0xf bank_mask:0xf
    s_waitcnt vmcnt(8)
    s_waitcnt lgkmcnt(0)
    v_readfirstlane_b32 s15, v3
    s_sub_u32 s16, s16, s84
    s_sub_u32 s16, s16, s15
    s_sub_u32 s16, s16, 2750
    s_mul_i32 s16, s16, 61
    s_ashr_i32 s16, s16, 8
    s_max_i32 s16, s16, 0
    s_min_i32 s16, s16, 63
    s_bfm_b64 s[18:19], s16, 0
    s_bitcmp1_b64 s[18:19], 56
    s_cbranch_scc1 L_w177
    s_waitcnt vmcnt(7)
    s_bitcmp1_b64 s[18:19], 40
    s_cbranch_scc1 L_w177
    s_waitcnt vmcnt(6)
    s_bitcmp1_b64 s[18:19], 24
    s_cbranch_scc1 L_w177
    s_waitcnt vmcnt(5)
    s_bitcmp1_b64 s[18:19], 8
    s_cbranch_scc1 L_w177
    s_waitcnt vmcnt(4)
L_w177:
    buffer_load_dwordx4 v[132:135], v1, s[52:55], s64 offen offset:1024 nt
    v_dot2c_f32_bf16_dpp v12, v42, v96 row_newbcast:8 row_mask:0xf bank_mask:0xf
    v_dot2c_f32_bf16_dpp v13, v24, v96 row_newbcast:8 row_mask:0xf bank_mask:0xf
    v_dot2c_f32_bf16_dpp v14, v42, v97 row_newbcast:8 row_mask:0xf bank_mask:0xf
    v_dot2c_f32_bf16_dpp v15, v24, v97 row_newbcast:8 row_mask:0xf bank_mask:0xf
    v_dot2c_f32_bf16_dpp v16, v42, v98 row_newbcast:8 row_mask:0xf bank_mask:0xf
    v_dot2c_f32_bf16_dpp v17, v24, v98 row_newbcast:8 row_mask:0xf bank_mask:0xf
    v_dot2c_f32_bf16_dpp v18, v42, v99 row_newbcast:8 row_mask:0xf bank_mask:0xf
    v_dot2c_f32_bf16_dpp v19, v24, v99 row_newbcast:8 row_mask:0xf bank_mask:0xf
    s_waitcnt vmcnt(8)
    s_bitcmp1_b64 s[18:19], 52
    s_cbranch_scc1 L_w178
    s_waitcnt vmcnt(7)
    s_bitcmp1_b64 s[18:19], 36
    s_cbranch_scc1 L_w178
    s_waitcnt vmcnt(6)
    s_bitcmp1_b64 s[18:19], 20
    s_cbranch_scc1 L_w178
    s_waitcnt vmcnt(5)
    s_bitcmp1_b64 s[18:19], 4
    s_cbranch_scc1 L_w178
    s_waitcnt vmcnt(4)
L_w178:
    buffer_load_dwordx4 v[136:139], v1, s[52:55], s64 offen offset:2048 nt
    v_dot2c_f32_bf16_dpp v12, v42, v100 row_newbcast:9 row_mask:0xf bank_mask:0xf
    v_dot2c_f32_bf16_dpp v13, v24, v100 row_newbcast:9 row_mask:0xf bank_mask:0xf
    v_dot2c_f32_bf16_dpp v14, v42, v101 row_newbcast:9 row_mask:0xf bank_mask:0xf
    v_dot2c_f32_bf16_dpp v15, v24, v101 row_newbcast:9 row_mask:0xf bank_mask:0xf
    v_dot2c_f32_bf16_dpp v16, v42, v102 row_newbcast:9 row_mask:0xf bank_mask:0xf
    v_dot2c_f32_bf16_dpp v17, v24, v102 row_newbcast:9 row_mask:0xf bank_mask:0xf
    v_dot2c_f32_bf16_dpp v18, v42, v103 row_newbcast:9 row_mask:0xf bank_mask:0xf
    v_dot2c_f32_bf16_dpp v19, v24, v103 row_newbcast:9 row_mask:0xf bank_mask:0xf
    s_waitcnt vmcnt(8)
    s_bitcmp1_b64 s[18:19], 60
    s_cbranch_scc1 L_w179
    s_waitcnt vmcnt(7)
    s_bitcmp1_b64 s[18:19], 44
    s_cbranch_scc1 L_w179
    s_waitcnt vmcnt(6)
    s_bitcmp1_b64 s[18:19], 28
    s_cbranch_scc1 L_w179
    s_waitcnt vmcnt(5)
    s_bitcmp1_b64 s[18:19], 12
    s_cbranch_scc1 L_w179
    s_waitcnt vmcnt(4)
L_w179:
    buffer_load_dwordx4 v[140:143], v1, s[52:55], s64 offen offset:3072 nt
    v_dot2c_f32_bf16_dpp v12, v42, v104 row_newbcast:10 row_mask:0xf bank_mask:0xf
    v_dot2c_f32_bf16_dpp v13, v24, v104 row_newbcast:10 row_mask:0xf bank_mask:0xf
    v_dot2c_f32_bf16_dpp v14, v42, v105 row_newbcast:10 row_mask:0xf bank_mask:0xf
    v_dot2c_f32_bf16_dpp v15, v24, v105 row_newbcast:10 row_mask:0xf bank_mask:0xf
    v_dot2c_f32_bf16_dpp v16, v42, v106 row_newbcast:10 row_mask:0xf bank_mask:0xf
    v_dot2c_f32_bf16_dpp v17, v24, v106 row_newbcast:10 row_mask:0xf bank_mask:0xf
    v_dot2c_f32_bf16_dpp v18, v42, v107 row_newbcast:10 row_mask:0xf bank_mask:0xf
    v_dot2c_f32_bf16_dpp v19, v24, v107 row_newbcast:10 row_mask:0xf bank_mask:0xf
    s_waitcnt vmcnt(8)
    s_bitcmp1_b64 s[18:19], 50
    s_cbranch_scc1 L_w180
    s_waitcnt vmcnt(7)
    s_bitcmp1_b64 s[18:19], 34
    s_cbranch_scc1 L_w180
    s_waitcnt vmcnt(6)
    s_bitcmp1_b64 s[18:19], 18
    s_cbranch_scc1 L_w180
    s_waitcnt vmcnt(5)
    s_bitcmp1_b64 s[18:19], 2
    s_cbranch_scc1 L_w180
    s_waitcnt vmcnt(4)
L_w180:
    buffer_load_dwordx4 v[144:147], v2, s[52:55], s64 offen offset:0 nt
    v_dot2c_f32_bf16_dpp v12, v42, v108 row_newbcast:11 row_mask:0xf bank_mask:0xf
    v_dot2c_f32_bf16_dpp v13, v24, v108 row_newbcast:11 row_mask:0xf bank_mask:0xf
    v_dot2c_f32_bf16_dpp v14, v42, v109 row_newbcast:11 row_mask:0xf bank_mask:0xf
    v_dot2c_f32_bf16_dpp v15, v24, v109 row_newbcast:11 row_mask:0xf bank_mask:0xf
    v_dot2c_f32_bf16_dpp v16, v42, v110 row_newbcast:11 row_mask:0xf bank_mask:0xf
    v_dot2c_f32_bf16_dpp v17, v24, v110 row_newbcast:11 row_mask:0xf bank_mask:0xf
    v_dot2c_f32_bf16_dpp v18, v42, v111 row_newbcast:11 row_mask:0xf bank_mask:0xf
    v_dot2c_f32_bf16_dpp v19, v24, v111 row_newbcast:11 row_mask:0xf bank_mask:0xf
    s_waitcnt vmcnt(8)
    s_bitcmp1_b64 s[18:19], 58
    s_cbranch_scc1 L_w181
    s_waitcnt vmcnt(7)
    s_bitcmp1_b64 s[18:19], 42
    s_cbranch_scc1 L_w181
    s_waitcnt vmcnt(6)
    s_bitcmp1_b64 s[18:19], 26
    s_cbranch_scc1 L_w181
    s_waitcnt vmcnt(5)
    s_bitcmp1_b64 s[18:19], 10
    s_cbranch_scc1 L_w181
    s_waitcnt vmcnt(4)
L_w181:
    buffer_load_dwordx4 v[148:151], v2, s[52:55], s64 offen offset:1024 nt
    v_dot2c_f32_bf16_dpp v12, v42, v112 row_newbcast:12 row_mask:0xf bank_mask:0xf
    v_dot2c_f32_bf16_dpp v13, v24, v112 row_newbcast:12 row_mask:0xf bank_mask:0xf
    v_dot2c_f32_bf16_dpp v14, v42, v113 row_newbcast:12 row_mask:0xf bank_mask:0xf
    v_dot2c_f32_bf16_dpp v15, v24, v113 row_newbcast:12 row_mask:0xf bank_mask:0xf
    v_dot2c_f32_bf16_dpp v16, v42, v114 row_newbcast:12 row_mask:0xf bank_mask:0xf
    v_dot2c_f32_bf16_dpp v17, v24, v114 row_newbcast:12 row_mask:0xf bank_mask:0xf
    v_dot2c_f32_bf16_dpp v18, v42, v115 row_newbcast:12 row_mask:0xf bank_mask:0xf
    v_dot2c_f32_bf16_dpp v19, v24, v115 row_newbcast:12 row_mask:0xf bank_mask:0xf
    s_waitcnt vmcnt(8)
    s_bitcmp1_b64 s[18:19], 54
    s_cbranch_scc1 L_w182
    s_waitcnt vmcnt(7)
    s_bitcmp1_b64 s[18:19], 38
    s_cbranch_scc1 L_w182
    s_waitcnt vmcnt(6)
    s_bitcmp1_b64 s[18:19], 22
    s_cbranch_scc1 L_w182
    s_waitcnt vmcnt(5)
    s_bitcmp1_b64 s[18:19], 6
    s_cbranch_scc1 L_w182
    s_waitcnt vmcnt(4)
L_w182:
    buffer_load_dwordx4 v[152:155], v2, s[52:55], s64 offen offset:2048 nt
    ds_read_b32 v3, v31 offset:676
    s_memrealtime s[16:17]
    v_dot2c_f32_bf16_dpp v12, v42, v116 row_newbcast:13 row_mask:0xf bank_mask:0xf
    v_dot2c_f32_bf16_dpp v13, v24, v116 row_newbcast:13 row_mask:0xf bank_mask:0xf
    v_dot2c_f32_bf16_dpp v14, v42, v117 row_newbcast:13 row_mask:0xf bank_mask:0xf
    v_dot2c_f32_bf16_dpp v15, v24, v117 row_newbcast:13 row_mask:0xf bank_mask:0xf
    v_dot2c_f32_bf16_dpp v16, v42, v118 row_newbcast:13 row_mask:0xf bank_mask:0xf
    v_dot2c_f32_bf16_dpp v17, v24, v118 row_newbcast:13 row_mask:0xf bank_mask:0xf
    v_dot2c_f32_bf16_dpp v18, v42, v119 row_newbcast:13 row_mask:0xf bank_mask:0xf
    v_dot2c_f32_bf16_dpp v19, v24, v119 row_newbcast:13 row_mask:0xf bank_mask:0xf
    s_waitcnt vmcnt(8)
    s_waitcnt lgkmcnt(0)
    v_readfirstlane_b32 s15, v3
    s_sub_u32 s16, s16, s84
    s_sub_u32 s16, s16, s15
    s_sub_u32 s16, s16, 2829
    s_mul_i32 s16, s16, 61
    s_ashr_i32 s16, s16, 8
    s_max_i32 s16, s16, 0
    s_min_i32 s16, s16, 63
    s_bfm_b64 s[18:19], s16, 0
    s_bitcmp1_b64 s[18:19], 62
    s_cbranch_scc1 L_w183
    s_waitcnt vmcnt(7)
    s_bitcmp1_b64 s[18:19], 46
    s_cbranch_scc1 L_w183
    s_waitcnt vmcnt(6)
    s_bitcmp1_b64 s[18:19], 30
    s_cbranch_scc1 L_w183
    s_waitcnt vmcnt(5)
    s_bitcmp1_b64 s[18:19], 14
    s_cbranch_scc1 L_w183
    s_waitcnt vmcnt(4)
L_w183:
    buffer_load_dwordx4 v[156:159], v2, s[52:55], s64 offen offset:3072 nt
    v_dot2c_f32_bf16_dpp v12, v42, v120 row_newbcast:14 row_mask:0xf bank_mask:0xf
    v_dot2c_f32_bf16_dpp v13, v24, v120 row_newbcast:14 row_mask:0xf bank_mask:0xf
    v_dot2c_f32_bf16_dpp v14, v42, v121 row_newbcast:14 row_mask:0xf bank_mask:0xf
    v_dot2c_f32_bf16_dpp v15, v24, v121 row_newbcast:14 row_mask:0xf bank_mask:0xf
    v_dot2c_f32_bf16_dpp v16, v42, v122 row_newbcast:14 row_mask:0xf bank_mask:0xf
    v_dot2c_f32_bf16_dpp v17, v24, v122 row_newbcast:14 row_mask:0xf bank_mask:0xf
    v_dot2c_f32_bf16_dpp v18, v42, v123 row_newbcast:14 row_mask:0xf bank_mask:0xf
    v_dot2c_f32_bf16_dpp v19, v24, v123 row_newbcast:14 row_mask:0xf bank_mask:0xf
    s_waitcnt vmcnt(8)
    s_bitcmp1_b64 s[18:19], 49
    s_cbranch_scc1 L_w184
    s_waitcnt vmcnt(7)
    s_bitcmp1_b64 s[18:19], 33
    s_cbranch_scc1 L_w184
    s_waitcnt vmcnt(6)
    s_bitcmp1_b64 s[18:19], 17
    s_cbranch_scc1 L_w184
    s_waitcnt vmcnt(5)
    s_bitcmp1_b64 s[18:19], 1
    s_cbranch_scc1 L_w184
    s_waitcnt vmcnt(4)
L_w184:
    buffer_load_dwordx4 v[160:163], v1, s[52:55], s65 offen offset:0 nt
    buffer_load_dwordx4 v[164:167], v1, s[52:55], s65 offen offset:1024 nt
    v_dot2c_f32_bf16_dpp v12, v42, v124 row_newbcast:15 row_mask:0xf bank_mask:0xf
    v_dot2c_f32_bf16_dpp v13, v24, v124 row_newbcast:15 row_mask:0xf bank_mask:0xf
    v_dot2c_f32_bf16_dpp v14, v42, v125 row_newbcast:15 row_mask:0xf bank_mask:0xf
    v_dot2c_f32_bf16_dpp v15, v24, v125 row_newbcast:15 row_mask:0xf bank_mask:0xf
    v_dot2c_f32_bf16_dpp v16, v42, v126 row_newbcast:15 row_mask:0xf bank_mask:0xf
    v_dot2c_f32_bf16_dpp v17, v24, v126 row_newbcast:15 row_mask:0xf bank_mask:0xf
    v_dot2c_f32_bf16_dpp v18, v42, v127 row_newbcast:15 row_mask:0xf bank_mask:0xf
    v_dot2c_f32_bf16_dpp v19, v24, v127 row_newbcast:15 row_mask:0xf bank_mask:0xf
    v_permlane32_swap_b32 v12, v16
    v_permlane32_swap_b32 v13, v17
    v_permlane32_swap_b32 v14, v18
    v_permlane32_swap_b32 v15, v19
    v_add_f32 v12, v12, v16
    v_add_f32 v13, v13, v17
    v_add_f32 v14, v14, v18
    v_add_f32 v15, v15, v19
    v_mov_b32 v16, 0
    v_mov_b32 v17, 0
    v_mov_b32 v18, 0
    v_mov_b32 v19, 0
    v_permlane16_swap_b32 v12, v14
    v_permlane16_swap_b32 v13, v15
    v_add_f32 v38, v12, v14
    v_add_f32 v39, v13, v15
    v_mov_b32 v12, 0
    v_mov_b32 v13, 0
    v_mov_b32 v14, 0
    v_mov_b32 v15, 0
    ds_write_b64 v4, v[38:39] offset:2560
    s_mov_b64 exec, 1
    ds_write_b32 v21, v31 offset:608
    s_mov_b64 exec, -1
    s_waitcnt vmcnt(8)
    s_bitcmp1_b64 s[18:19], 53
    s_cbranch_scc1 L_w186
    s_waitcnt vmcnt(7)
    s_bitcmp1_b64 s[18:19], 37
    s_cbranch_scc1 L_w186
    s_waitcnt vmcnt(6)
    s_bitcmp1_b64 s[18:19], 21
    s_cbranch_scc1 L_w186
    s_waitcnt vmcnt(5)
    s_bitcmp1_b64 s[18:19], 5
    s_cbranch_scc1 L_w186
    s_waitcnt vmcnt(4)
L_w186:
    buffer_load_dwordx4 v[168:171], v1, s[52:55], s65 offen offset:2048 nt
    v_dot2c_f32_bf16_dpp v12, v45, v128 row_newbcast:0 row_mask:0xf bank_mask:0xf
    v_dot2c_f32_bf16_dpp v13, v28, v128 row_newbcast:0 row_mask:0xf bank_mask:0xf
    v_dot2c_f32_bf16_dpp v14, v45, v129 row_newbcast:0 row_mask:0xf bank_mask:0xf
    v_dot2c_f32_bf16_dpp v15, v28, v129 row_newbcast:0 row_mask:0xf bank_mask:0xf
    v_dot2c_f32_bf16_dpp v16, v45, v130 row_newbcast:0 row_mask:0xf bank_mask:0xf
    v_dot2c_f32_bf16_dpp v17, v28, v130 row_newbcast:0 row_mask:0xf bank_mask:0xf
    v_dot2c_f32_bf16_dpp v18, v45, v131 row_newbcast:0 row_mask:0xf bank_mask:0xf
    v_dot2c_f32_bf16_dpp v19, v28, v131 row_newbcast:0 row_mask:0xf bank_mask:0xf
    v_dot2c_f32_bf16_dpp v12, v45, v132 row_newbcast:1 row_mask:0xf bank_mask:0xf
    v_dot2c_f32_bf16_dpp v13, v28, v132 row_newbcast:1 row_mask:0xf bank_mask:0xf
    v_dot2c_f32_bf16_dpp v14, v45, v133 row_newbcast:1 row_mask:0xf bank_mask:0xf
    v_dot2c_f32_bf16_dpp v15, v28, v133 row_newbcast:1 row_mask:0xf bank_mask:0xf
    v_dot2c_f32_bf16_dpp v16, v45, v134 row_newbcast:1 row_mask:0xf bank_mask:0xf
    v_dot2c_f32_bf16_dpp v17, v28, v134 row_newbcast:1 row_mask:0xf bank_mask:0xf
    v_dot2c_f32_bf16_dpp v18, v45, v135 row_newbcast:1 row_mask:0xf bank_mask:0xf
    v_dot2c_f32_bf16_dpp v19, v28, v135 row_newbcast:1 row_mask:0xf bank_mask:0xf
    s_waitcnt vmcnt(8)
    s_bitcmp1_b64 s[18:19], 61
    s_cbranch_scc1 L_w187
    s_waitcnt vmcnt(7)
    s_bitcmp1_b64 s[18:19], 45
    s_cbranch_scc1 L_w187
    s_waitcnt vmcnt(6)
    s_bitcmp1_b64 s[18:19], 29
    s_cbranch_scc1 L_w187
    s_waitcnt vmcnt(5)
    s_bitcmp1_b64 s[18:19], 13
    s_cbranch_scc1 L_w187
    s_waitcnt vmcnt(4)
L_w187:
    buffer_load_dwordx4 v[172:175], v1, s[52:55], s65 offen offset:3072 nt
    v_dot2c_f32_bf16_dpp v12, v45, v136 row_newbcast:2 row_mask:0xf bank_mask:0xf
    v_dot2c_f32_bf16_dpp v13, v28, v136 row_newbcast:2 row_mask:0xf bank_mask:0xf
    v_dot2c_f32_bf16_dpp v14, v45, v137 row_newbcast:2 row_mask:0xf bank_mask:0xf
    v_dot2c_f32_bf16_dpp v15, v28, v137 row_newbcast:2 row_mask:0xf bank_mask:0xf
    v_dot2c_f32_bf16_dpp v16, v45, v138 row_newbcast:2 row_mask:0xf bank_mask:0xf
    v_dot2c_f32_bf16_dpp v17, v28, v138 row_newbcast:2 row_mask:0xf bank_mask:0xf
    v_dot2c_f32_bf16_dpp v18, v45, v139 row_newbcast:2 row_mask:0xf bank_mask:0xf
    v_dot2c_f32_bf16_dpp v19, v28, v139 row_newbcast:2 row_mask:0xf bank_mask:0xf
    s_waitcnt vmcnt(8)
    s_bitcmp1_b64 s[18:19], 51
    s_cbranch_scc1 L_w188
    s_waitcnt vmcnt(7)
    s_bitcmp1_b64 s[18:19], 35
    s_cbranch_scc1 L_w188
    s_waitcnt vmcnt(6)
    s_bitcmp1_b64 s[18:19], 19
    s_cbranch_scc1 L_w188
    s_waitcnt vmcnt(5)
    s_bitcmp1_b64 s[18:19], 3
    s_cbranch_scc1 L_w188
    s_waitcnt vmcnt(4)
L_w188:
    buffer_load_dwordx4 v[176:179], v2, s[52:55], s65 offen offset:0 nt
    ds_read_b32 v3, v31 offset:676
    s_memrealtime s[16:17]
    v_dot2c_f32_bf16_dpp v12, v45, v140 row_newbcast:3 row_mask:0xf bank_mask:0xf
    v_dot2c_f32_bf16_dpp v13, v28, v140 row_newbcast:3 row_mask:0xf bank_mask:0xf
    v_dot2c_f32_bf16_dpp v14, v45, v141 row_newbcast:3 row_mask:0xf bank_mask:0xf
    v_dot2c_f32_bf16_dpp v15, v28, v141 row_newbcast:3 row_mask:0xf bank_mask:0xf
    v_dot2c_f32_bf16_dpp v16, v45, v142 row_newbcast:3 row_mask:0xf bank_mask:0xf
    v_dot2c_f32_bf16_dpp v17, v28, v142 row_newbcast:3 row_mask:0xf bank_mask:0xf
    v_dot2c_f32_bf16_dpp v18, v45, v143 row_newbcast:3 row_mask:0xf bank_mask:0xf
    v_dot2c_f32_bf16_dpp v19, v28, v143 row_newbcast:3 row_mask:0xf bank_mask:0xf
    s_waitcnt vmcnt(8)
    s_waitcnt lgkmcnt(0)
    v_readfirstlane_b32 s15, v3
    s_sub_u32 s16, s16, s84
    s_sub_u32 s16, s16, s15
    s_sub_u32 s16, s16, 2907
    s_mul_i32 s16, s16, 61
    s_ashr_i32 s16, s16, 8
    s_max_i32 s16, s16, 0
    s_min_i32 s16, s16, 63
    s_bfm_b64 s[18:19], s16, 0
    s_bitcmp1_b64 s[18:19], 59
    s_cbranch_scc1 L_w189
    s_waitcnt vmcnt(7)
    s_bitcmp1_b64 s[18:19], 43
    s_cbranch_scc1 L_w189
    s_waitcnt vmcnt(6)
    s_bitcmp1_b64 s[18:19], 27
    s_cbranch_scc1 L_w189
    s_waitcnt vmcnt(5)
    s_bitcmp1_b64 s[18:19], 11
    s_cbranch_scc1 L_w189
    s_waitcnt vmcnt(4)
L_w189:
    buffer_load_dwordx4 v[180:183], v2, s[52:55], s65 offen offset:1024 nt
    v_dot2c_f32_bf16_dpp v12, v45, v144 row_newbcast:4 row_mask:0xf bank_mask:0xf
    v_dot2c_f32_bf16_dpp v13, v28, v144 row_newbcast:4 row_mask:0xf bank_mask:0xf
    v_dot2c_f32_bf16_dpp v14, v45, v145 row_newbcast:4 row_mask:0xf bank_mask:0xf
    v_dot2c_f32_bf16_dpp v15, v28, v145 row_newbcast:4 row_mask:0xf bank_mask:0xf
    v_dot2c_f32_bf16_dpp v16, v45, v146 row_newbcast:4 row_mask:0xf bank_mask:0xf
    v_dot2c_f32_bf16_dpp v17, v28, v146 row_newbcast:4 row_mask:0xf bank_mask:0xf
    v_dot2c_f32_bf16_dpp v18, v45, v147 row_newbcast:4 row_mask:0xf bank_mask:0xf
    v_dot2c_f32_bf16_dpp v19, v28, v147 row_newbcast:4 row_mask:0xf bank_mask:0xf
    s_waitcnt vmcnt(8)
    s_bitcmp1_b64 s[18:19], 55
    s_cbranch_scc1 L_w190
    s_waitcnt vmcnt(7)
    s_bitcmp1_b64 s[18:19], 39
    s_cbranch_scc1 L_w190
    s_waitcnt vmcnt(6)
    s_bitcmp1_b64 s[18:19], 23
    s_cbranch_scc1 L_w190
    s_waitcnt vmcnt(5)
    s_bitcmp1_b64 s[18:19], 7
    s_cbranch_scc1 L_w190
    s_waitcnt vmcnt(4)
L_w190:
    buffer_load_dwordx4 v[184:187], v2, s[52:55], s65 offen offset:2048 nt
    v_dot2c_f32_bf16_dpp v12, v45, v148 row_newbcast:5 row_mask:0xf bank_mask:0xf
    v_dot2c_f32_bf16_dpp v13, v28, v148 row_newbcast:5 row_mask:0xf bank_mask:0xf
    v_dot2c_f32_bf16_dpp v14, v45, v149 row_newbcast:5 row_mask:0xf bank_mask:0xf
    v_dot2c_f32_bf16_dpp v15, v28, v149 row_newbcast:5 row_mask:0xf bank_mask:0xf
    v_dot2c_f32_bf16_dpp v16, v45, v150 row_newbcast:5 row_mask:0xf bank_mask:0xf
    v_dot2c_f32_bf16_dpp v17, v28, v150 row_newbcast:5 row_mask:0xf bank_mask:0xf
    v_dot2c_f32_bf16_dpp v18, v45, v151 row_newbcast:5 row_mask:0xf bank_mask:0xf
    v_dot2c_f32_bf16_dpp v19, v28, v151 row_newbcast:5 row_mask:0xf bank_mask:0xf
    s_waitcnt vmcnt(8)
    s_bitcmp1_b64 s[18:19], 63
    s_cbranch_scc1 L_w191
    s_waitcnt vmcnt(7)
    s_bitcmp1_b64 s[18:19], 47
    s_cbranch_scc1 L_w191
    s_waitcnt vmcnt(6)
    s_bitcmp1_b64 s[18:19], 31
    s_cbranch_scc1 L_w191
    s_waitcnt vmcnt(5)
    s_bitcmp1_b64 s[18:19], 15
    s_cbranch_scc1 L_w191
    s_waitcnt vmcnt(4)
L_w191:
    buffer_load_dwordx4 v[188:191], v2, s[52:55], s65 offen offset:3072 nt
    v_dot2c_f32_bf16_dpp v12, v45, v152 row_newbcast:6 row_mask:0xf bank_mask:0xf
    v_dot2c_f32_bf16_dpp v13, v28, v152 row_newbcast:6 row_mask:0xf bank_mask:0xf
    v_dot2c_f32_bf16_dpp v14, v45, v153 row_newbcast:6 row_mask:0xf bank_mask:0xf
    v_dot2c_f32_bf16_dpp v15, v28, v153 row_newbcast:6 row_mask:0xf bank_mask:0xf
    v_dot2c_f32_bf16_dpp v16, v45, v154 row_newbcast:6 row_mask:0xf bank_mask:0xf
    v_dot2c_f32_bf16_dpp v17, v28, v154 row_newbcast:6 row_mask:0xf bank_mask:0xf
    v_dot2c_f32_bf16_dpp v18, v45, v155 row_newbcast:6 row_mask:0xf bank_mask:0xf
    v_dot2c_f32_bf16_dpp v19, v28, v155 row_newbcast:6 row_mask:0xf bank_mask:0xf
    s_waitcnt vmcnt(8)
    s_bitcmp1_b64 s[18:19], 48
    s_cbranch_scc1 L_w192
    s_waitcnt vmcnt(7)
    s_bitcmp1_b64 s[18:19], 32
    s_cbranch_scc1 L_w192
    s_waitcnt vmcnt(6)
    s_bitcmp1_b64 s[18:19], 16
    s_cbranch_scc1 L_w192
    s_waitcnt vmcnt(5)
    s_bitcmp1_b64 s[18:19], 0
    s_cbranch_scc1 L_w192
    s_waitcnt vmcnt(4)
L_w192:
    buffer_load_dwordx4 v[192:195], v1, s[52:55], s66 offen offset:0 nt
    v_dot2c_f32_bf16_dpp v12, v45, v156 row_newbcast:7 row_mask:0xf bank_mask:0xf
    v_dot2c_f32_bf16_dpp v13, v28, v156 row_newbcast:7 row_mask:0xf bank_mask:0xf
    v_dot2c_f32_bf16_dpp v14, v45, v157 row_newbcast:7 row_mask:0xf bank_mask:0xf
    v_dot2c_f32_bf16_dpp v15, v28, v157 row_newbcast:7 row_mask:0xf bank_mask:0xf
    v_dot2c_f32_bf16_dpp v16, v45, v158 row_newbcast:7 row_mask:0xf bank_mask:0xf
    v_dot2c_f32_bf16_dpp v17, v28, v158 row_newbcast:7 row_mask:0xf bank_mask:0xf
    v_dot2c_f32_bf16_dpp v18, v45, v159 row_newbcast:7 row_mask:0xf bank_mask:0xf
    v_dot2c_f32_bf16_dpp v19, v28, v159 row_newbcast:7 row_mask:0xf bank_mask:0xf
    s_waitcnt vmcnt(8)
    s_bitcmp1_b64 s[18:19], 56
    s_cbranch_scc1 L_w193
    s_waitcnt vmcnt(7)
    s_bitcmp1_b64 s[18:19], 40
    s_cbranch_scc1 L_w193
    s_waitcnt vmcnt(6)
    s_bitcmp1_b64 s[18:19], 24
    s_cbranch_scc1 L_w193
    s_waitcnt vmcnt(5)
    s_bitcmp1_b64 s[18:19], 8
    s_cbranch_scc1 L_w193
    s_waitcnt vmcnt(4)
L_w193:
    buffer_load_dwordx4 v[196:199], v1, s[52:55], s66 offen offset:1024 nt
    v_dot2c_f32_bf16_dpp v12, v45, v160 row_newbcast:8 row_mask:0xf bank_mask:0xf
    v_dot2c_f32_bf16_dpp v13, v28, v160 row_newbcast:8 row_mask:0xf bank_mask:0xf
    v_dot2c_f32_bf16_dpp v14, v45, v161 row_newbcast:8 row_mask:0xf bank_mask:0xf
    v_dot2c_f32_bf16_dpp v15, v28, v161 row_newbcast:8 row_mask:0xf bank_mask:0xf
    v_dot2c_f32_bf16_dpp v16, v45, v162 row_newbcast:8 row_mask:0xf bank_mask:0xf
    v_dot2c_f32_bf16_dpp v17, v28, v162 row_newbcast:8 row_mask:0xf bank_mask:0xf
    v_dot2c_f32_bf16_dpp v18, v45, v163 row_newbcast:8 row_mask:0xf bank_mask:0xf
    v_dot2c_f32_bf16_dpp v19, v28, v163 row_newbcast:8 row_mask:0xf bank_mask:0xf
    s_waitcnt vmcnt(8)
    s_bitcmp1_b64 s[18:19], 52
    s_cbranch_scc1 L_w194
    s_waitcnt vmcnt(7)
    s_bitcmp1_b64 s[18:19], 36
    s_cbranch_scc1 L_w194
    s_waitcnt vmcnt(6)
    s_bitcmp1_b64 s[18:19], 20
    s_cbranch_scc1 L_w194
    s_waitcnt vmcnt(5)
    s_bitcmp1_b64 s[18:19], 4
    s_cbranch_scc1 L_w194
    s_waitcnt vmcnt(4)
L_w194:
    buffer_load_dwordx4 v[200:203], v1, s[52:55], s66 offen offset:2048 nt
    ds_read_b32 v3, v31 offset:676
    s_memrealtime s[16:17]
    v_dot2c_f32_bf16_dpp v12, v45, v164 row_newbcast:9 row_mask:0xf bank_mask:0xf
    v_dot2c_f32_bf16_dpp v13, v28, v164 row_newbcast:9 row_mask:0xf bank_mask:0xf
    v_dot2c_f32_bf16_dpp v14, v45, v165 row_newbcast:9 row_mask:0xf bank_mask:0xf
    v_dot2c_f32_bf16_dpp v15, v28, v165 row_newbcast:9 row_mask:0xf bank_mask:0xf
    v_dot2c_f32_bf16_dpp v16, v45, v166 row_newbcast:9 row_mask:0xf bank_mask:0xf
    v_dot2c_f32_bf16_dpp v17, v28, v166 row_newbcast:9 row_mask:0xf bank_mask:0xf
    v_dot2c_f32_bf16_dpp v18, v45, v167 row_newbcast:9 row_mask:0xf bank_mask:0xf
    v_dot2c_f32_bf16_dpp v19, v28, v167 row_newbcast:9 row_mask:0xf bank_mask:0xf
    s_waitcnt vmcnt(8)
    s_waitcnt lgkmcnt(0)
    v_readfirstlane_b32 s15, v3
    s_sub_u32 s16, s16, s84
    s_sub_u32 s16, s16, s15
    s_sub_u32 s16, s16, 2986
    s_mul_i32 s16, s16, 61
    s_ashr_i32 s16, s16, 8
    s_max_i32 s16, s16, 0
    s_min_i32 s16, s16, 63
    s_bfm_b64 s[18:19], s16, 0
    s_bitcmp1_b64 s[18:19], 60
    s_cbranch_scc1 L_w195
    s_waitcnt vmcnt(7)
    s_bitcmp1_b64 s[18:19], 44
    s_cbranch_scc1 L_w195
    s_waitcnt vmcnt(6)
    s_bitcmp1_b64 s[18:19], 28
    s_cbranch_scc1 L_w195
    s_waitcnt vmcnt(5)
    s_bitcmp1_b64 s[18:19], 12
    s_cbranch_scc1 L_w195
    s_waitcnt vmcnt(4)
L_w195:
    buffer_load_dwordx4 v[204:207], v1, s[52:55], s66 offen offset:3072 nt
    v_dot2c_f32_bf16_dpp v12, v45, v168 row_newbcast:10 row_mask:0xf bank_mask:0xf
    v_dot2c_f32_bf16_dpp v13, v28, v168 row_newbcast:10 row_mask:0xf bank_mask:0xf
    v_dot2c_f32_bf16_dpp v14, v45, v169 row_newbcast:10 row_mask:0xf bank_mask:0xf
    v_dot2c_f32_bf16_dpp v15, v28, v169 row_newbcast:10 row_mask:0xf bank_mask:0xf
    v_dot2c_f32_bf16_dpp v16, v45, v170 row_newbcast:10 row_mask:0xf bank_mask:0xf
    v_dot2c_f32_bf16_dpp v17, v28, v170 row_newbcast:10 row_mask:0xf bank_mask:0xf
    v_dot2c_f32_bf16_dpp v18, v45, v171 row_newbcast:10 row_mask:0xf bank_mask:0xf
    v_dot2c_f32_bf16_dpp v19, v28, v171 row_newbcast:10 row_mask:0xf bank_mask:0xf
    s_waitcnt vmcnt(8)
    s_bitcmp1_b64 s[18:19], 50
    s_cbranch_scc1 L_w196
    s_waitcnt vmcnt(7)
    s_bitcmp1_b64 s[18:19], 34
    s_cbranch_scc1 L_w196
    s_waitcnt vmcnt(6)
    s_bitcmp1_b64 s[18:19], 18
    s_cbranch_scc1 L_w196
    s_waitcnt vmcnt(5)
    s_bitcmp1_b64 s[18:19], 2
    s_cbranch_scc1 L_w196
    s_waitcnt vmcnt(4)
L_w196:
    buffer_load_dwordx4 v[208:211], v2, s[52:55], s66 offen offset:0 nt
    v_dot2c_f32_bf16_dpp v12, v45, v172 row_newbcast:11 row_mask:0xf bank_mask:0xf
    v_dot2c_f32_bf16_dpp v13, v28, v172 row_newbcast:11 row_mask:0xf bank_mask:0xf
    v_dot2c_f32_bf16_dpp v14, v45, v173 row_newbcast:11 row_mask:0xf bank_mask:0xf
    v_dot2c_f32_bf16_dpp v15, v28, v173 row_newbcast:11 row_mask:0xf bank_mask:0xf
    v_dot2c_f32_bf16_dpp v16, v45, v174 row_newbcast:11 row_mask:0xf bank_mask:0xf
    v_dot2c_f32_bf16_dpp v17, v28, v174 row_newbcast:11 row_mask:0xf bank_mask:0xf
    v_dot2c_f32_bf16_dpp v18, v45, v175 row_newbcast:11 row_mask:0xf bank_mask:0xf
    v_dot2c_f32_bf16_dpp v19, v28, v175 row_newbcast:11 row_mask:0xf bank_mask:0xf
    s_waitcnt vmcnt(8)
    s_bitcmp1_b64 s[18:19], 58
    s_cbranch_scc1 L_w197
    s_waitcnt vmcnt(7)
    s_bitcmp1_b64 s[18:19], 42
    s_cbranch_scc1 L_w197
    s_waitcnt vmcnt(6)
    s_bitcmp1_b64 s[18:19], 26
    s_cbranch_scc1 L_w197
    s_waitcnt vmcnt(5)
    s_bitcmp1_b64 s[18:19], 10
    s_cbranch_scc1 L_w197
    s_waitcnt vmcnt(4)
L_w197:
    buffer_load_dwordx4 v[212:215], v2, s[52:55], s66 offen offset:1024 nt
    v_dot2c_f32_bf16_dpp v12, v45, v176 row_newbcast:12 row_mask:0xf bank_mask:0xf
    v_dot2c_f32_bf16_dpp v13, v28, v176 row_newbcast:12 row_mask:0xf bank_mask:0xf
    v_dot2c_f32_bf16_dpp v14, v45, v177 row_newbcast:12 row_mask:0xf bank_mask:0xf
    v_dot2c_f32_bf16_dpp v15, v28, v177 row_newbcast:12 row_mask:0xf bank_mask:0xf
    v_dot2c_f32_bf16_dpp v16, v45, v178 row_newbcast:12 row_mask:0xf bank_mask:0xf
    v_dot2c_f32_bf16_dpp v17, v28, v178 row_newbcast:12 row_mask:0xf bank_mask:0xf
    v_dot2c_f32_bf16_dpp v18, v45, v179 row_newbcast:12 row_mask:0xf bank_mask:0xf
    v_dot2c_f32_bf16_dpp v19, v28, v179 row_newbcast:12 row_mask:0xf bank_mask:0xf
    s_waitcnt vmcnt(8)
    s_bitcmp1_b64 s[18:19], 54
    s_cbranch_scc1 L_w198
    s_waitcnt vmcnt(7)
    s_bitcmp1_b64 s[18:19], 38
    s_cbranch_scc1 L_w198
    s_waitcnt vmcnt(6)
    s_bitcmp1_b64 s[18:19], 22
    s_cbranch_scc1 L_w198
    s_waitcnt vmcnt(5)
    s_bitcmp1_b64 s[18:19], 6
    s_cbranch_scc1 L_w198
    s_waitcnt vmcnt(4)
L_w198:
    buffer_load_dwordx4 v[216:219], v2, s[52:55], s66 offen offset:2048 nt
    v_dot2c_f32_bf16_dpp v12, v45, v180 row_newbcast:13 row_mask:0xf bank_mask:0xf
    v_dot2c_f32_bf16_dpp v13, v28, v180 row_newbcast:13 row_mask:0xf bank_mask:0xf
    v_dot2c_f32_bf16_dpp v14, v45, v181 row_newbcast:13 row_mask:0xf bank_mask:0xf
    v_dot2c_f32_bf16_dpp v15, v28, v181 row_newbcast:13 row_mask:0xf bank_mask:0xf
    v_dot2c_f32_bf16_dpp v16, v45, v182 row_newbcast:13 row_mask:0xf bank_mask:0xf
    v_dot2c_f32_bf16_dpp v17, v28, v182 row_newbcast:13 row_mask:0xf bank_mask:0xf
    v_dot2c_f32_bf16_dpp v18, v45, v183 row_newbcast:13 row_mask:0xf bank_mask:0xf
    v_dot2c_f32_bf16_dpp v19, v28, v183 row_newbcast:13 row_mask:0xf bank_mask:0xf
    s_waitcnt vmcnt(8)
    s_bitcmp1_b64 s[18:19], 62
    s_cbranch_scc1 L_w199
    s_waitcnt vmcnt(7)
    s_bitcmp1_b64 s[18:19], 46
    s_cbranch_scc1 L_w199
    s_waitcnt vmcnt(6)
    s_bitcmp1_b64 s[18:19], 30
    s_cbranch_scc1 L_w199
    s_waitcnt vmcnt(5)
    s_bitcmp1_b64 s[18:19], 14
    s_cbranch_scc1 L_w199
    s_waitcnt vmcnt(4)
L_w199:
    buffer_load_dwordx4 v[220:223], v2, s[52:55], s66 offen offset:3072 nt
    v_dot2c_f32_bf16_dpp v12, v45, v184 row_newbcast:14 row_mask:0xf bank_mask:0xf
    v_dot2c_f32_bf16_dpp v13, v28, v184 row_newbcast:14 row_mask:0xf bank_mask:0xf
    v_dot2c_f32_bf16_dpp v14, v45, v185 row_newbcast:14 row_mask:0xf bank_mask:0xf
    v_dot2c_f32_bf16_dpp v15, v28, v185 row_newbcast:14 row_mask:0xf bank_mask:0xf
    v_dot2c_f32_bf16_dpp v16, v45, v186 row_newbcast:14 row_mask:0xf bank_mask:0xf
    v_dot2c_f32_bf16_dpp v17, v28, v186 row_newbcast:14 row_mask:0xf bank_mask:0xf
    v_dot2c_f32_bf16_dpp v18, v45, v187 row_newbcast:14 row_mask:0xf bank_mask:0xf
    v_dot2c_f32_bf16_dpp v19, v28, v187 row_newbcast:14 row_mask:0xf bank_mask:0xf
    s_waitcnt vmcnt(8)
    s_bitcmp1_b64 s[18:19], 49
    s_cbranch_scc1 L_w200
    s_waitcnt vmcnt(7)
    s_bitcmp1_b64 s[18:19], 33
    s_cbranch_scc1 L_w200
    s_waitcnt vmcnt(6)
    s_bitcmp1_b64 s[18:19], 17
    s_cbranch_scc1 L_w200
    s_waitcnt vmcnt(5)
    s_bitcmp1_b64 s[18:19], 1
    s_cbranch_scc1 L_w200
    s_waitcnt vmcnt(4)
L_w200:
    buffer_load_dwordx4 v[224:227], v1, s[52:55], s67 offen offset:0 nt
    ds_read_b32 v3, v31 offset:676
    s_memrealtime s[16:17]
    v_dot2c_f32_bf16_dpp v12, v45, v188 row_newbcast:15 row_mask:0xf bank_mask:0xf
    v_dot2c_f32_bf16_dpp v13, v28, v188 row_newbcast:15 row_mask:0xf bank_mask:0xf
    v_dot2c_f32_bf16_dpp v14, v45, v189 row_newbcast:15 row_mask:0xf bank_mask:0xf
    v_dot2c_f32_bf16_dpp v15, v28, v189 row_newbcast:15 row_mask:0xf bank_mask:0xf
    v_dot2c_f32_bf16_dpp v16, v45, v190 row_newbcast:15 row_mask:0xf bank_mask:0xf
    v_dot2c_f32_bf16_dpp v17, v28, v190 row_newbcast:15 row_mask:0xf bank_mask:0xf
    v_dot2c_f32_bf16_dpp v18, v45, v191 row_newbcast:15 row_mask:0xf bank_mask:0xf
    v_dot2c_f32_bf16_dpp v19, v28, v191 row_newbcast:15 row_mask:0xf bank_mask:0xf
    s_waitcnt vmcnt(8)
    s_waitcnt lgkmcnt(0)
    v_readfirstlane_b32 s15, v3
    s_sub_u32 s16, s16, s84
    s_sub_u32 s16, s16, s15
    s_sub_u32 s16, s16, 3085
    s_mul_i32 s16, s16, 102
    s_ashr_i32 s16, s16, 8
    s_max_i32 s16, s16, 0
    s_min_i32 s16, s16, 63
    s_bfm_b64 s[18:19], s16, 0
    s_bitcmp1_b64 s[18:19], 57
    s_cbranch_scc1 L_w201
    s_waitcnt vmcnt(7)
    s_bitcmp1_b64 s[18:19], 41
    s_cbranch_scc1 L_w201
    s_waitcnt vmcnt(6)
    s_bitcmp1_b64 s[18:19], 25
    s_cbranch_scc1 L_w201
    s_waitcnt vmcnt(5)
    s_bitcmp1_b64 s[18:19], 9
    s_cbranch_scc1 L_w201
    s_waitcnt vmcnt(4)
L_w201:
    buffer_load_dwordx4 v[228:231], v1, s[52:55], s67 offen offset:1024 nt
    v_dot2c_f32_bf16_dpp v12, v46, v192 row_newbcast:0 row_mask:0xf bank_mask:0xf
    v_dot2c_f32_bf16_dpp v13, v29, v192 row_newbcast:0 row_mask:0xf bank_mask:0xf
    v_dot2c_f32_bf16_dpp v14, v46, v193 row_newbcast:0 row_mask:0xf bank_mask:0xf
    v_dot2c_f32_bf16_dpp v15, v29, v193 row_newbcast:0 row_mask:0xf bank_mask:0xf
    v_dot2c_f32_bf16_dpp v16, v46, v194 row_newbcast:0 row_mask:0xf bank_mask:0xf
    v_dot2c_f32_bf16_dpp v17, v29, v194 row_newbcast:0 row_mask:0xf bank_mask:0xf
    v_dot2c_f32_bf16_dpp v18, v46, v195 row_newbcast:0 row_mask:0xf bank_mask:0xf
    v_dot2c_f32_bf16_dpp v19, v29, v195 row_newbcast:0 row_mask:0xf bank_mask:0xf
    s_waitcnt vmcnt(8)
    s_bitcmp1_b64 s[18:19], 53
    s_cbranch_scc1 L_w202
    s_waitcnt vmcnt(7)
    s_bitcmp1_b64 s[18:19], 37
    s_cbranch_scc1 L_w202
    s_waitcnt vmcnt(6)
    s_bitcmp1_b64 s[18:19], 21
    s_cbranch_scc1 L_w202
    s_waitcnt vmcnt(5)
    s_bitcmp1_b64 s[18:19], 5
    s_cbranch_scc1 L_w202
    s_waitcnt vmcnt(4)
L_w202:
    buffer_load_dwordx4 v[232:235], v1, s[52:55], s67 offen offset:2048 nt
    v_dot2c_f32_bf16_dpp v12, v46, v196 row_newbcast:1 row_mask:0xf bank_mask:0xf
    v_dot2c_f32_bf16_dpp v13, v29, v196 row_newbcast:1 row_mask:0xf bank_mask:0xf
    v_dot2c_f32_bf16_dpp v14, v46, v197 row_newbcast:1 row_mask:0xf bank_mask:0xf
    v_dot2c_f32_bf16_dpp v15, v29, v197 row_newbcast:1 row_mask:0xf bank_mask:0xf
    v_dot2c_f32_bf16_dpp v16, v46, v198 row_newbcast:1 row_mask:0xf bank_mask:0xf
    v_dot2c_f32_bf16_dpp v17, v29, v198 row_newbcast:1 row_mask:0xf bank_mask:0xf
    v_dot2c_f32_bf16_dpp v18, v46, v199 row_newbcast:1 row_mask:0xf bank_mask:0xf
    v_dot2c_f32_bf16_dpp v19, v29, v199 row_newbcast:1 row_mask:0xf bank_mask:0xf
    s_waitcnt vmcnt(8)
    s_bitcmp1_b64 s[18:19], 61
    s_cbranch_scc1 L_w203
    s_waitcnt vmcnt(7)
    s_bitcmp1_b64 s[18:19], 45
    s_cbranch_scc1 L_w203
    s_waitcnt vmcnt(6)
    s_bitcmp1_b64 s[18:19], 29
    s_cbranch_scc1 L_w203
    s_waitcnt vmcnt(5)
    s_bitcmp1_b64 s[18:19], 13
    s_cbranch_scc1 L_w203
    s_waitcnt vmcnt(4)
L_w203:
    buffer_load_dwordx4 v[236:239], v1, s[52:55], s67 offen offset:3072 nt
    v_dot2c_f32_bf16_dpp v12, v46, v200 row_newbcast:2 row_mask:0xf bank_mask:0xf
    v_dot2c_f32_bf16_dpp v13, v29, v200 row_newbcast:2 row_mask:0xf bank_mask:0xf
    v_dot2c_f32_bf16_dpp v14, v46, v201 row_newbcast:2 row_mask:0xf bank_mask:0xf
    v_dot2c_f32_bf16_dpp v15, v29, v201 row_newbcast:2 row_mask:0xf bank_mask:0xf
    v_dot2c_f32_bf16_dpp v16, v46, v202 row_newbcast:2 row_mask:0xf bank_mask:0xf
    v_dot2c_f32_bf16_dpp v17, v29, v202 row_newbcast:2 row_mask:0xf bank_mask:0xf
    v_dot2c_f32_bf16_dpp v18, v46, v203 row_newbcast:2 row_mask:0xf bank_mask:0xf
    v_dot2c_f32_bf16_dpp v19, v29, v203 row_newbcast:2 row_mask:0xf bank_mask:0xf
    s_waitcnt vmcnt(8)
    s_bitcmp1_b64 s[18:19], 51
    s_cbranch_scc1 L_w204
    s_waitcnt vmcnt(7)
    s_bitcmp1_b64 s[18:19], 35
    s_cbranch_scc1 L_w204
    s_waitcnt vmcnt(6)
    s_bitcmp1_b64 s[18:19], 19
    s_cbranch_scc1 L_w204
    s_waitcnt vmcnt(5)
    s_bitcmp1_b64 s[18:19], 3
    s_cbranch_scc1 L_w204
    s_waitcnt vmcnt(4)
L_w204:
    buffer_load_dwordx4 v[240:243], v2, s[52:55], s67 offen offset:0 nt
    v_dot2c_f32_bf16_dpp v12, v46, v204 row_newbcast:3 row_mask:0xf bank_mask:0xf
    v_dot2c_f32_bf16_dpp v13, v29, v204 row_newbcast:3 row_mask:0xf bank_mask:0xf
    v_dot2c_f32_bf16_dpp v14, v46, v205 row_newbcast:3 row_mask:0xf bank_mask:0xf
    v_dot2c_f32_bf16_dpp v15, v29, v205 row_newbcast:3 row_mask:0xf bank_mask:0xf
    v_dot2c_f32_bf16_dpp v16, v46, v206 row_newbcast:3 row_mask:0xf bank_mask:0xf
    v_dot2c_f32_bf16_dpp v17, v29, v206 row_newbcast:3 row_mask:0xf bank_mask:0xf
    v_dot2c_f32_bf16_dpp v18, v46, v207 row_newbcast:3 row_mask:0xf bank_mask:0xf
    v_dot2c_f32_bf16_dpp v19, v29, v207 row_newbcast:3 row_mask:0xf bank_mask:0xf
    s_waitcnt vmcnt(8)
    s_bitcmp1_b64 s[18:19], 59
    s_cbranch_scc1 L_w205
    s_waitcnt vmcnt(7)
    s_bitcmp1_b64 s[18:19], 43
    s_cbranch_scc1 L_w205
    s_waitcnt vmcnt(6)
    s_bitcmp1_b64 s[18:19], 27
    s_cbranch_scc1 L_w205
    s_waitcnt vmcnt(5)
    s_bitcmp1_b64 s[18:19], 11
    s_cbranch_scc1 L_w205
    s_waitcnt vmcnt(4)
L_w205:
    buffer_load_dwordx4 v[244:247], v2, s[52:55], s67 offen offset:1024 nt
    v_dot2c_f32_bf16_dpp v12, v46, v208 row_newbcast:4 row_mask:0xf bank_mask:0xf
    v_dot2c_f32_bf16_dpp v13, v29, v208 row_newbcast:4 row_mask:0xf bank_mask:0xf
    v_dot2c_f32_bf16_dpp v14, v46, v209 row_newbcast:4 row_mask:0xf bank_mask:0xf
    v_dot2c_f32_bf16_dpp v15, v29, v209 row_newbcast:4 row_mask:0xf bank_mask:0xf
    v_dot2c_f32_bf16_dpp v16, v46, v210 row_newbcast:4 row_mask:0xf bank_mask:0xf
    v_dot2c_f32_bf16_dpp v17, v29, v210 row_newbcast:4 row_mask:0xf bank_mask:0xf
    v_dot2c_f32_bf16_dpp v18, v46, v211 row_newbcast:4 row_mask:0xf bank_mask:0xf
    v_dot2c_f32_bf16_dpp v19, v29, v211 row_newbcast:4 row_mask:0xf bank_mask:0xf
    s_waitcnt vmcnt(8)
    s_bitcmp1_b64 s[18:19], 55
    s_cbranch_scc1 L_w206
    s_waitcnt vmcnt(7)
    s_bitcmp1_b64 s[18:19], 39
    s_cbranch_scc1 L_w206
    s_waitcnt vmcnt(6)
    s_bitcmp1_b64 s[18:19], 23
    s_cbranch_scc1 L_w206
    s_waitcnt vmcnt(5)
    s_bitcmp1_b64 s[18:19], 7
    s_cbranch_scc1 L_w206
    s_waitcnt vmcnt(4)
L_w206:
    buffer_load_dwordx4 v[248:251], v2, s[52:55], s67 offen offset:2048 nt
    ds_read_b32 v3, v31 offset:676
    s_memrealtime s[16:17]
    v_dot2c_f32_bf16_dpp v12, v46, v212 row_newbcast:5 row_mask:0xf bank_mask:0xf
    v_dot2c_f32_bf16_dpp v13, v29, v212 row_newbcast:5 row_mask:0xf bank_mask:0xf
    v_dot2c_f32_bf16_dpp v14, v46, v213 row_newbcast:5 row_mask:0xf bank_mask:0xf
    v_dot2c_f32_bf16_dpp v15, v29, v213 row_newbcast:5 row_mask:0xf bank_mask:0xf
    v_dot2c_f32_bf16_dpp v16, v46, v214 row_newbcast:5 row_mask:0xf bank_mask:0xf
    v_dot2c_f32_bf16_dpp v17, v29, v214 row_newbcast:5 row_mask:0xf bank_mask:0xf
    v_dot2c_f32_bf16_dpp v18, v46, v215 row_newbcast:5 row_mask:0xf bank_mask:0xf
    v_dot2c_f32_bf16_dpp v19, v29, v215 row_newbcast:5 row_mask:0xf bank_mask:0xf
    s_waitcnt vmcnt(8)
    s_waitcnt lgkmcnt(0)
    v_readfirstlane_b32 s15, v3
    s_sub_u32 s16, s16, s84
    s_sub_u32 s16, s16, s15
    s_sub_u32 s16, s16, 3163
    s_mul_i32 s16, s16, 102
    s_ashr_i32 s16, s16, 8
    s_max_i32 s16, s16, 0
    s_min_i32 s16, s16, 63
    s_bfm_b64 s[18:19], s16, 0
    s_bitcmp1_b64 s[18:19], 63
    s_cbranch_scc1 L_w207
    s_waitcnt vmcnt(7)
    s_bitcmp1_b64 s[18:19], 47
    s_cbranch_scc1 L_w207
    s_waitcnt vmcnt(6)
    s_bitcmp1_b64 s[18:19], 31
    s_cbranch_scc1 L_w207
    s_waitcnt vmcnt(5)
    s_bitcmp1_b64 s[18:19], 15
    s_cbranch_scc1 L_w207
    s_waitcnt vmcnt(4)
L_w207:
    buffer_load_dwordx4 v[252:255], v2, s[52:55], s67 offen offset:3072 nt
    v_dot2c_f32_bf16_dpp v12, v46, v216 row_newbcast:6 row_mask:0xf bank_mask:0xf
    v_dot2c_f32_bf16_dpp v13, v29, v216 row_newbcast:6 row_mask:0xf bank_mask:0xf
    v_dot2c_f32_bf16_dpp v14, v46, v217 row_newbcast:6 row_mask:0xf bank_mask:0xf
    v_dot2c_f32_bf16_dpp v15, v29, v217 row_newbcast:6 row_mask:0xf bank_mask:0xf
    v_dot2c_f32_bf16_dpp v16, v46, v218 row_newbcast:6 row_mask:0xf bank_mask:0xf
    v_dot2c_f32_bf16_dpp v17, v29, v218 row_newbcast:6 row_mask:0xf bank_mask:0xf
    v_dot2c_f32_bf16_dpp v18, v46, v219 row_newbcast:6 row_mask:0xf bank_mask:0xf
    v_dot2c_f32_bf16_dpp v19, v29, v219 row_newbcast:6 row_mask:0xf bank_mask:0xf
    s_waitcnt vmcnt(8)
    s_bitcmp1_b64 s[18:19], 48
    s_cbranch_scc1 L_w208
    s_waitcnt vmcnt(7)
    s_bitcmp1_b64 s[18:19], 32
    s_cbranch_scc1 L_w208
    s_waitcnt vmcnt(6)
    s_bitcmp1_b64 s[18:19], 16
    s_cbranch_scc1 L_w208
    s_waitcnt vmcnt(5)
    s_bitcmp1_b64 s[18:19], 0
    s_cbranch_scc1 L_w208
    s_waitcnt vmcnt(4)
L_w208:
    buffer_load_dwordx4 v[48:51], v1, s[52:55], s68 offen offset:0 nt
    v_dot2c_f32_bf16_dpp v12, v46, v220 row_newbcast:7 row_mask:0xf bank_mask:0xf
    v_dot2c_f32_bf16_dpp v13, v29, v220 row_newbcast:7 row_mask:0xf bank_mask:0xf
    v_dot2c_f32_bf16_dpp v14, v46, v221 row_newbcast:7 row_mask:0xf bank_mask:0xf
    v_dot2c_f32_bf16_dpp v15, v29, v221 row_newbcast:7 row_mask:0xf bank_mask:0xf
    v_dot2c_f32_bf16_dpp v16, v46, v222 row_newbcast:7 row_mask:0xf bank_mask:0xf
    v_dot2c_f32_bf16_dpp v17, v29, v222 row_newbcast:7 row_mask:0xf bank_mask:0xf
    v_dot2c_f32_bf16_dpp v18, v46, v223 row_newbcast:7 row_mask:0xf bank_mask:0xf
    v_dot2c_f32_bf16_dpp v19, v29, v223 row_newbcast:7 row_mask:0xf bank_mask:0xf
    s_waitcnt vmcnt(8)
    s_bitcmp1_b64 s[18:19], 56
    s_cbranch_scc1 L_w209
    s_waitcnt vmcnt(7)
    s_bitcmp1_b64 s[18:19], 40
    s_cbranch_scc1 L_w209
    s_waitcnt vmcnt(6)
    s_bitcmp1_b64 s[18:19], 24
    s_cbranch_scc1 L_w209
    s_waitcnt vmcnt(5)
    s_bitcmp1_b64 s[18:19], 8
    s_cbranch_scc1 L_w209
    s_waitcnt vmcnt(4)
L_w209:
    buffer_load_dwordx4 v[52:55], v1, s[52:55], s68 offen offset:1024 nt
    v_dot2c_f32_bf16_dpp v12, v46, v224 row_newbcast:8 row_mask:0xf bank_mask:0xf
    v_dot2c_f32_bf16_dpp v13, v29, v224 row_newbcast:8 row_mask:0xf bank_mask:0xf
    v_dot2c_f32_bf16_dpp v14, v46, v225 row_newbcast:8 row_mask:0xf bank_mask:0xf
    v_dot2c_f32_bf16_dpp v15, v29, v225 row_newbcast:8 row_mask:0xf bank_mask:0xf
    v_dot2c_f32_bf16_dpp v16, v46, v226 row_newbcast:8 row_mask:0xf bank_mask:0xf
    v_dot2c_f32_bf16_dpp v17, v29, v226 row_newbcast:8 row_mask:0xf bank_mask:0xf
    v_dot2c_f32_bf16_dpp v18, v46, v227 row_newbcast:8 row_mask:0xf bank_mask:0xf
    v_dot2c_f32_bf16_dpp v19, v29, v227 row_newbcast:8 row_mask:0xf bank_mask:0xf
    s_waitcnt vmcnt(8)
    s_bitcmp1_b64 s[18:19], 52
    s_cbranch_scc1 L_w210
    s_waitcnt vmcnt(7)
    s_bitcmp1_b64 s[18:19], 36
    s_cbranch_scc1 L_w210
    s_waitcnt vmcnt(6)
    s_bitcmp1_b64 s[18:19], 20
    s_cbranch_scc1 L_w210
    s_waitcnt vmcnt(5)
    s_bitcmp1_b64 s[18:19], 4
    s_cbranch_scc1 L_w210
    s_waitcnt vmcnt(4)
L_w210:
    buffer_load_dwordx4 v[56:59], v1, s[52:55], s68 offen offset:2048 nt
    v_dot2c_f32_bf16_dpp v12, v46, v228 row_newbcast:9 row_mask:0xf bank_mask:0xf
    v_dot2c_f32_bf16_dpp v13, v29, v228 row_newbcast:9 row_mask:0xf bank_mask:0xf
    v_dot2c_f32_bf16_dpp v14, v46, v229 row_newbcast:9 row_mask:0xf bank_mask:0xf
    v_dot2c_f32_bf16_dpp v15, v29, v229 row_newbcast:9 row_mask:0xf bank_mask:0xf
    v_dot2c_f32_bf16_dpp v16, v46, v230 row_newbcast:9 row_mask:0xf bank_mask:0xf
    v_dot2c_f32_bf16_dpp v17, v29, v230 row_newbcast:9 row_mask:0xf bank_mask:0xf
    v_dot2c_f32_bf16_dpp v18, v46, v231 row_newbcast:9 row_mask:0xf bank_mask:0xf
    v_dot2c_f32_bf16_dpp v19, v29, v231 row_newbcast:9 row_mask:0xf bank_mask:0xf
    s_waitcnt vmcnt(8)
    s_bitcmp1_b64 s[18:19], 60
    s_cbranch_scc1 L_w211
    s_waitcnt vmcnt(7)
    s_bitcmp1_b64 s[18:19], 44
    s_cbranch_scc1 L_w211
    s_waitcnt vmcnt(6)
    s_bitcmp1_b64 s[18:19], 28
    s_cbranch_scc1 L_w211
    s_waitcnt vmcnt(5)
    s_bitcmp1_b64 s[18:19], 12
    s_cbranch_scc1 L_w211
    s_waitcnt vmcnt(4)
L_w211:
    buffer_load_dwordx4 v[60:63], v1, s[52:55], s68 offen offset:3072 nt
    v_dot2c_f32_bf16_dpp v12, v46, v232 row_newbcast:10 row_mask:0xf bank_mask:0xf
    v_dot2c_f32_bf16_dpp v13, v29, v232 row_newbcast:10 row_mask:0xf bank_mask:0xf
    v_dot2c_f32_bf16_dpp v14, v46, v233 row_newbcast:10 row_mask:0xf bank_mask:0xf
    v_dot2c_f32_bf16_dpp v15, v29, v233 row_newbcast:10 row_mask:0xf bank_mask:0xf
    v_dot2c_f32_bf16_dpp v16, v46, v234 row_newbcast:10 row_mask:0xf bank_mask:0xf
    v_dot2c_f32_bf16_dpp v17, v29, v234 row_newbcast:10 row_mask:0xf bank_mask:0xf
    v_dot2c_f32_bf16_dpp v18, v46, v235 row_newbcast:10 row_mask:0xf bank_mask:0xf
    v_dot2c_f32_bf16_dpp v19, v29, v235 row_newbcast:10 row_mask:0xf bank_mask:0xf
    s_waitcnt vmcnt(8)
    s_bitcmp1_b64 s[18:19], 50
    s_cbranch_scc1 L_w212
    s_waitcnt vmcnt(7)
    s_bitcmp1_b64 s[18:19], 34
    s_cbranch_scc1 L_w212
    s_waitcnt vmcnt(6)
    s_bitcmp1_b64 s[18:19], 18
    s_cbranch_scc1 L_w212
    s_waitcnt vmcnt(5)
    s_bitcmp1_b64 s[18:19], 2
    s_cbranch_scc1 L_w212
    s_waitcnt vmcnt(4)
L_w212:
    buffer_load_dwordx4 v[64:67], v2, s[52:55], s68 offen offset:0 nt
    ds_read_b32 v3, v31 offset:676
    s_memrealtime s[16:17]
    v_dot2c_f32_bf16_dpp v12, v46, v236 row_newbcast:11 row_mask:0xf bank_mask:0xf
    v_dot2c_f32_bf16_dpp v13, v29, v236 row_newbcast:11 row_mask:0xf bank_mask:0xf
    v_dot2c_f32_bf16_dpp v14, v46, v237 row_newbcast:11 row_mask:0xf bank_mask:0xf
    v_dot2c_f32_bf16_dpp v15, v29, v237 row_newbcast:11 row_mask:0xf bank_mask:0xf
    v_dot2c_f32_bf16_dpp v16, v46, v238 row_newbcast:11 row_mask:0xf bank_mask:0xf
    v_dot2c_f32_bf16_dpp v17, v29, v238 row_newbcast:11 row_mask:0xf bank_mask:0xf
    v_dot2c_f32_bf16_dpp v18, v46, v239 row_newbcast:11 row_mask:0xf bank_mask:0xf
    v_dot2c_f32_bf16_dpp v19, v29, v239 row_newbcast:11 row_mask:0xf bank_mask:0xf
    s_waitcnt vmcnt(8)
    s_waitcnt lgkmcnt(0)
    v_readfirstlane_b32 s15, v3
    s_sub_u32 s16, s16, s84
    s_sub_u32 s16, s16, s15
    s_sub_u32 s16, s16, 3242
    s_mul_i32 s16, s16, 102
    s_ashr_i32 s16, s16, 8
    s_max_i32 s16, s16, 0
    s_min_i32 s16, s16, 63
    s_bfm_b64 s[18:19], s16, 0
    s_bitcmp1_b64 s[18:19], 58
    s_cbranch_scc1 L_w213
    s_waitcnt vmcnt(7)
    s_bitcmp1_b64 s[18:19], 42
    s_cbranch_scc1 L_w213
    s_waitcnt vmcnt(6)
    s_bitcmp1_b64 s[18:19], 26
    s_cbranch_scc1 L_w213
    s_waitcnt vmcnt(5)
    s_bitcmp1_b64 s[18:19], 10
    s_cbranch_scc1 L_w213
    s_waitcnt vmcnt(4)
L_w213:
    buffer_load_dwordx4 v[68:71], v2, s[52:55], s68 offen offset:1024 nt
    v_dot2c_f32_bf16_dpp v12, v46, v240 row_newbcast:12 row_mask:0xf bank_mask:0xf
    v_dot2c_f32_bf16_dpp v13, v29, v240 row_newbcast:12 row_mask:0xf bank_mask:0xf
    v_dot2c_f32_bf16_dpp v14, v46, v241 row_newbcast:12 row_mask:0xf bank_mask:0xf
    v_dot2c_f32_bf16_dpp v15, v29, v241 row_newbcast:12 row_mask:0xf bank_mask:0xf
    v_dot2c_f32_bf16_dpp v16, v46, v242 row_newbcast:12 row_mask:0xf bank_mask:0xf
    v_dot2c_f32_bf16_dpp v17, v29, v242 row_newbcast:12 row_mask:0xf bank_mask:0xf
    v_dot2c_f32_bf16_dpp v18, v46, v243 row_newbcast:12 row_mask:0xf bank_mask:0xf
    v_dot2c_f32_bf16_dpp v19, v29, v243 row_newbcast:12 row_mask:0xf bank_mask:0xf
    s_waitcnt vmcnt(8)
    s_bitcmp1_b64 s[18:19], 54
    s_cbranch_scc1 L_w214
    s_waitcnt vmcnt(7)
    s_bitcmp1_b64 s[18:19], 38
    s_cbranch_scc1 L_w214
    s_waitcnt vmcnt(6)
    s_bitcmp1_b64 s[18:19], 22
    s_cbranch_scc1 L_w214
    s_waitcnt vmcnt(5)
    s_bitcmp1_b64 s[18:19], 6
    s_cbranch_scc1 L_w214
    s_waitcnt vmcnt(4)
L_w214:
    buffer_load_dwordx4 v[72:75], v2, s[52:55], s68 offen offset:2048 nt
    v_dot2c_f32_bf16_dpp v12, v46, v244 row_newbcast:13 row_mask:0xf bank_mask:0xf
    v_dot2c_f32_bf16_dpp v13, v29, v244 row_newbcast:13 row_mask:0xf bank_mask:0xf
    v_dot2c_f32_bf16_dpp v14, v46, v245 row_newbcast:13 row_mask:0xf bank_mask:0xf
    v_dot2c_f32_bf16_dpp v15, v29, v245 row_newbcast:13 row_mask:0xf bank_mask:0xf
    v_dot2c_f32_bf16_dpp v16, v46, v246 row_newbcast:13 row_mask:0xf bank_mask:0xf
    v_dot2c_f32_bf16_dpp v17, v29, v246 row_newbcast:13 row_mask:0xf bank_mask:0xf
    v_dot2c_f32_bf16_dpp v18, v46, v247 row_newbcast:13 row_mask:0xf bank_mask:0xf
    v_dot2c_f32_bf16_dpp v19, v29, v247 row_newbcast:13 row_mask:0xf bank_mask:0xf
    s_waitcnt vmcnt(8)
    s_bitcmp1_b64 s[18:19], 62
    s_cbranch_scc1 L_w215
    s_waitcnt vmcnt(7)
    s_bitcmp1_b64 s[18:19], 46
    s_cbranch_scc1 L_w215
    s_waitcnt vmcnt(6)
    s_bitcmp1_b64 s[18:19], 30
    s_cbranch_scc1 L_w215
    s_waitcnt vmcnt(5)
    s_bitcmp1_b64 s[18:19], 14
    s_cbranch_scc1 L_w215
    s_waitcnt vmcnt(4)
L_w215:
    buffer_load_dwordx4 v[76:79], v2, s[52:55], s68 offen offset:3072 nt
    v_dot2c_f32_bf16_dpp v12, v46, v248 row_newbcast:14 row_mask:0xf bank_mask:0xf
    v_dot2c_f32_bf16_dpp v13, v29, v248 row_newbcast:14 row_mask:0xf bank_mask:0xf
    v_dot2c_f32_bf16_dpp v14, v46, v249 row_newbcast:14 row_mask:0xf bank_mask:0xf
    v_dot2c_f32_bf16_dpp v15, v29, v249 row_newbcast:14 row_mask:0xf bank_mask:0xf
    v_dot2c_f32_bf16_dpp v16, v46, v250 row_newbcast:14 row_mask:0xf bank_mask:0xf
    v_dot2c_f32_bf16_dpp v17, v29, v250 row_newbcast:14 row_mask:0xf bank_mask:0xf
    v_dot2c_f32_bf16_dpp v18, v46, v251 row_newbcast:14 row_mask:0xf bank_mask:0xf
    v_dot2c_f32_bf16_dpp v19, v29, v251 row_newbcast:14 row_mask:0xf bank_mask:0xf
    s_waitcnt vmcnt(8)
    s_bitcmp1_b64 s[18:19], 49
    s_cbranch_scc1 L_w216
    s_waitcnt vmcnt(7)
    s_bitcmp1_b64 s[18:19], 33
    s_cbranch_scc1 L_w216
    s_waitcnt vmcnt(6)
    s_bitcmp1_b64 s[18:19], 17
    s_cbranch_scc1 L_w216
    s_waitcnt vmcnt(5)
    s_bitcmp1_b64 s[18:19], 1
    s_cbranch_scc1 L_w216
    s_waitcnt vmcnt(4)
L_w216:
    buffer_load_dwordx4 v[80:83], v1, s[52:55], s69 offen offset:0 nt
    v_dot2c_f32_bf16_dpp v12, v46, v252 row_newbcast:15 row_mask:0xf bank_mask:0xf
    v_dot2c_f32_bf16_dpp v13, v29, v252 row_newbcast:15 row_mask:0xf bank_mask:0xf
    v_dot2c_f32_bf16_dpp v14, v46, v253 row_newbcast:15 row_mask:0xf bank_mask:0xf
    v_dot2c_f32_bf16_dpp v15, v29, v253 row_newbcast:15 row_mask:0xf bank_mask:0xf
    v_dot2c_f32_bf16_dpp v16, v46, v254 row_newbcast:15 row_mask:0xf bank_mask:0xf
    v_dot2c_f32_bf16_dpp v17, v29, v254 row_newbcast:15 row_mask:0xf bank_mask:0xf
    v_dot2c_f32_bf16_dpp v18, v46, v255 row_newbcast:15 row_mask:0xf bank_mask:0xf
    v_dot2c_f32_bf16_dpp v19, v29, v255 row_newbcast:15 row_mask:0xf bank_mask:0xf
    s_waitcnt vmcnt(8)
    s_bitcmp1_b64 s[18:19], 57
    s_cbranch_scc1 L_w217
    s_waitcnt vmcnt(7)
    s_bitcmp1_b64 s[18:19], 41
    s_cbranch_scc1 L_w217
    s_waitcnt vmcnt(6)
    s_bitcmp1_b64 s[18:19], 25
    s_cbranch_scc1 L_w217
    s_waitcnt vmcnt(5)
    s_bitcmp1_b64 s[18:19], 9
    s_cbranch_scc1 L_w217
    s_waitcnt vmcnt(4)
L_w217:
    buffer_load_dwordx4 v[84:87], v1, s[52:55], s69 offen offset:1024 nt
    v_dot2c_f32_bf16_dpp v12, v47, v48 row_newbcast:0 row_mask:0xf bank_mask:0xf
    v_dot2c_f32_bf16_dpp v13, v30, v48 row_newbcast:0 row_mask:0xf bank_mask:0xf
    v_dot2c_f32_bf16_dpp v14, v47, v49 row_newbcast:0 row_mask:0xf bank_mask:0xf
    v_dot2c_f32_bf16_dpp v15, v30, v49 row_newbcast:0 row_mask:0xf bank_mask:0xf
    v_dot2c_f32_bf16_dpp v16, v47, v50 row_newbcast:0 row_mask:0xf bank_mask:0xf
    v_dot2c_f32_bf16_dpp v17, v30, v50 row_newbcast:0 row_mask:0xf bank_mask:0xf
    v_dot2c_f32_bf16_dpp v18, v47, v51 row_newbcast:0 row_mask:0xf bank_mask:0xf
    v_dot2c_f32_bf16_dpp v19, v30, v51 row_newbcast:0 row_mask:0xf bank_mask:0xf
    s_waitcnt vmcnt(8)
    s_bitcmp1_b64 s[18:19], 53
    s_cbranch_scc1 L_w218
    s_waitcnt vmcnt(7)
    s_bitcmp1_b64 s[18:19], 37
    s_cbranch_scc1 L_w218
    s_waitcnt vmcnt(6)
    s_bitcmp1_b64 s[18:19], 21
    s_cbranch_scc1 L_w218
    s_waitcnt vmcnt(5)
    s_bitcmp1_b64 s[18:19], 5
    s_cbranch_scc1 L_w218
    s_waitcnt vmcnt(4)
L_w218:
    buffer_load_dwordx4 v[88:91], v1, s[52:55], s69 offen offset:2048 nt
    ds_read_b32 v3, v31 offset:676
    s_memrealtime s[16:17]
    v_dot2c_f32_bf16_dpp v12, v47, v52 row_newbcast:1 row_mask:0xf bank_mask:0xf
    v_dot2c_f32_bf16_dpp v13, v30, v52 row_newbcast:1 row_mask:0xf bank_mask:0xf
    v_dot2c_f32_bf16_dpp v14, v47, v53 row_newbcast:1 row_mask:0xf bank_mask:0xf
    v_dot2c_f32_bf16_dpp v15, v30, v53 row_newbcast:1 row_mask:0xf bank_mask:0xf
    v_dot2c_f32_bf16_dpp v16, v47, v54 row_newbcast:1 row_mask:0xf bank_mask:0xf
    v_dot2c_f32_bf16_dpp v17, v30, v54 row_newbcast:1 row_mask:0xf bank_mask:0xf
    v_dot2c_f32_bf16_dpp v18, v47, v55 row_newbcast:1 row_mask:0xf bank_mask:0xf
    v_dot2c_f32_bf16_dpp v19, v30, v55 row_newbcast:1 row_mask:0xf bank_mask:0xf
    s_waitcnt vmcnt(8)
    s_waitcnt lgkmcnt(0)
    v_readfirstlane_b32 s15, v3
    s_sub_u32 s16, s16, s84
    s_sub_u32 s16, s16, s15
    s_sub_u32 s16, s16, 3320
    s_mul_i32 s16, s16, 102
    s_ashr_i32 s16, s16, 8
    s_max_i32 s16, s16, 0
    s_min_i32 s16, s16, 63
    s_bfm_b64 s[18:19], s16, 0
    s_bitcmp1_b64 s[18:19], 61
    s_cbranch_scc1 L_w219
    s_waitcnt vmcnt(7)
    s_bitcmp1_b64 s[18:19], 45
    s_cbranch_scc1 L_w219
    s_waitcnt vmcnt(6)
    s_bitcmp1_b64 s[18:19], 29
    s_cbranch_scc1 L_w219
    s_waitcnt vmcnt(5)
    s_bitcmp1_b64 s[18:19], 13
    s_cbranch_scc1 L_w219
    s_waitcnt vmcnt(4)
L_w219:
    buffer_load_dwordx4 v[92:95], v1, s[52:55], s69 offen offset:3072 nt
    v_dot2c_f32_bf16_dpp v12, v47, v56 row_newbcast:2 row_mask:0xf bank_mask:0xf
    v_dot2c_f32_bf16_dpp v13, v30, v56 row_newbcast:2 row_mask:0xf bank_mask:0xf
    v_dot2c_f32_bf16_dpp v14, v47, v57 row_newbcast:2 row_mask:0xf bank_mask:0xf
    v_dot2c_f32_bf16_dpp v15, v30, v57 row_newbcast:2 row_mask:0xf bank_mask:0xf
    v_dot2c_f32_bf16_dpp v16, v47, v58 row_newbcast:2 row_mask:0xf bank_mask:0xf
    v_dot2c_f32_bf16_dpp v17, v30, v58 row_newbcast:2 row_mask:0xf bank_mask:0xf
    v_dot2c_f32_bf16_dpp v18, v47, v59 row_newbcast:2 row_mask:0xf bank_mask:0xf
    v_dot2c_f32_bf16_dpp v19, v30, v59 row_newbcast:2 row_mask:0xf bank_mask:0xf
    s_waitcnt vmcnt(8)
    s_bitcmp1_b64 s[18:19], 51
    s_cbranch_scc1 L_w220
    s_waitcnt vmcnt(7)
    s_bitcmp1_b64 s[18:19], 35
    s_cbranch_scc1 L_w220
    s_waitcnt vmcnt(6)
    s_bitcmp1_b64 s[18:19], 19
    s_cbranch_scc1 L_w220
    s_waitcnt vmcnt(5)
    s_bitcmp1_b64 s[18:19], 3
    s_cbranch_scc1 L_w220
    s_waitcnt vmcnt(4)
L_w220:
    buffer_load_dwordx4 v[96:99], v2, s[52:55], s69 offen offset:0 nt
    v_dot2c_f32_bf16_dpp v12, v47, v60 row_newbcast:3 row_mask:0xf bank_mask:0xf
    v_dot2c_f32_bf16_dpp v13, v30, v60 row_newbcast:3 row_mask:0xf bank_mask:0xf
    v_dot2c_f32_bf16_dpp v14, v47, v61 row_newbcast:3 row_mask:0xf bank_mask:0xf
    v_dot2c_f32_bf16_dpp v15, v30, v61 row_newbcast:3 row_mask:0xf bank_mask:0xf
    v_dot2c_f32_bf16_dpp v16, v47, v62 row_newbcast:3 row_mask:0xf bank_mask:0xf
    v_dot2c_f32_bf16_dpp v17, v30, v62 row_newbcast:3 row_mask:0xf bank_mask:0xf
    v_dot2c_f32_bf16_dpp v18, v47, v63 row_newbcast:3 row_mask:0xf bank_mask:0xf
    v_dot2c_f32_bf16_dpp v19, v30, v63 row_newbcast:3 row_mask:0xf bank_mask:0xf
    s_waitcnt vmcnt(8)
    s_bitcmp1_b64 s[18:19], 59
    s_cbranch_scc1 L_w221
    s_waitcnt vmcnt(7)
    s_bitcmp1_b64 s[18:19], 43
    s_cbranch_scc1 L_w221
    s_waitcnt vmcnt(6)
    s_bitcmp1_b64 s[18:19], 27
    s_cbranch_scc1 L_w221
    s_waitcnt vmcnt(5)
    s_bitcmp1_b64 s[18:19], 11
    s_cbranch_scc1 L_w221
    s_waitcnt vmcnt(4)
L_w221:
    buffer_load_dwordx4 v[100:103], v2, s[52:55], s69 offen offset:1024 nt
    v_dot2c_f32_bf16_dpp v12, v47, v64 row_newbcast:4 row_mask:0xf bank_mask:0xf
    v_dot2c_f32_bf16_dpp v13, v30, v64 row_newbcast:4 row_mask:0xf bank_mask:0xf
    v_dot2c_f32_bf16_dpp v14, v47, v65 row_newbcast:4 row_mask:0xf bank_mask:0xf
    v_dot2c_f32_bf16_dpp v15, v30, v65 row_newbcast:4 row_mask:0xf bank_mask:0xf
    v_dot2c_f32_bf16_dpp v16, v47, v66 row_newbcast:4 row_mask:0xf bank_mask:0xf
    v_dot2c_f32_bf16_dpp v17, v30, v66 row_newbcast:4 row_mask:0xf bank_mask:0xf
    v_dot2c_f32_bf16_dpp v18, v47, v67 row_newbcast:4 row_mask:0xf bank_mask:0xf
    v_dot2c_f32_bf16_dpp v19, v30, v67 row_newbcast:4 row_mask:0xf bank_mask:0xf
    s_waitcnt vmcnt(8)
    s_bitcmp1_b64 s[18:19], 55
    s_cbranch_scc1 L_w222
    s_waitcnt vmcnt(7)
    s_bitcmp1_b64 s[18:19], 39
    s_cbranch_scc1 L_w222
    s_waitcnt vmcnt(6)
    s_bitcmp1_b64 s[18:19], 23
    s_cbranch_scc1 L_w222
    s_waitcnt vmcnt(5)
    s_bitcmp1_b64 s[18:19], 7
    s_cbranch_scc1 L_w222
    s_waitcnt vmcnt(4)
L_w222:
    buffer_load_dwordx4 v[104:107], v2, s[52:55], s69 offen offset:2048 nt
    v_dot2c_f32_bf16_dpp v12, v47, v68 row_newbcast:5 row_mask:0xf bank_mask:0xf
    v_dot2c_f32_bf16_dpp v13, v30, v68 row_newbcast:5 row_mask:0xf bank_mask:0xf
    v_dot2c_f32_bf16_dpp v14, v47, v69 row_newbcast:5 row_mask:0xf bank_mask:0xf
    v_dot2c_f32_bf16_dpp v15, v30, v69 row_newbcast:5 row_mask:0xf bank_mask:0xf
    v_dot2c_f32_bf16_dpp v16, v47, v70 row_newbcast:5 row_mask:0xf bank_mask:0xf
    v_dot2c_f32_bf16_dpp v17, v30, v70 row_newbcast:5 row_mask:0xf bank_mask:0xf
    v_dot2c_f32_bf16_dpp v18, v47, v71 row_newbcast:5 row_mask:0xf bank_mask:0xf
    v_dot2c_f32_bf16_dpp v19, v30, v71 row_newbcast:5 row_mask:0xf bank_mask:0xf
    s_waitcnt vmcnt(8)
    s_bitcmp1_b64 s[18:19], 63
    s_cbranch_scc1 L_w223
    s_waitcnt vmcnt(7)
    s_bitcmp1_b64 s[18:19], 47
    s_cbranch_scc1 L_w223
    s_waitcnt vmcnt(6)
    s_bitcmp1_b64 s[18:19], 31
    s_cbranch_scc1 L_w223
    s_waitcnt vmcnt(5)
    s_bitcmp1_b64 s[18:19], 15
    s_cbranch_scc1 L_w223
    s_waitcnt vmcnt(4)
L_w223:
    buffer_load_dwordx4 v[108:111], v2, s[52:55], s69 offen offset:3072 nt
    v_dot2c_f32_bf16_dpp v12, v47, v72 row_newbcast:6 row_mask:0xf bank_mask:0xf
    v_dot2c_f32_bf16_dpp v13, v30, v72 row_newbcast:6 row_mask:0xf bank_mask:0xf
    v_dot2c_f32_bf16_dpp v14, v47, v73 row_newbcast:6 row_mask:0xf bank_mask:0xf
    v_dot2c_f32_bf16_dpp v15, v30, v73 row_newbcast:6 row_mask:0xf bank_mask:0xf
    v_dot2c_f32_bf16_dpp v16, v47, v74 row_newbcast:6 row_mask:0xf bank_mask:0xf
    v_dot2c_f32_bf16_dpp v17, v30, v74 row_newbcast:6 row_mask:0xf bank_mask:0xf
    v_dot2c_f32_bf16_dpp v18, v47, v75 row_newbcast:6 row_mask:0xf bank_mask:0xf
    v_dot2c_f32_bf16_dpp v19, v30, v75 row_newbcast:6 row_mask:0xf bank_mask:0xf
    s_waitcnt vmcnt(8)
    s_bitcmp1_b64 s[18:19], 48
    s_cbranch_scc1 L_w224
    s_waitcnt vmcnt(7)
    s_bitcmp1_b64 s[18:19], 32
    s_cbranch_scc1 L_w224
    s_waitcnt vmcnt(6)
    s_bitcmp1_b64 s[18:19], 16
    s_cbranch_scc1 L_w224
    s_waitcnt vmcnt(5)
    s_bitcmp1_b64 s[18:19], 0
    s_cbranch_scc1 L_w224
    s_waitcnt vmcnt(4)
L_w224:
    s_cmp_eq_u32 s35, 0
    s_cselect_b64 s[40:41], s[40:41], s[52:53]
    buffer_load_dwordx4 v[112:115], v1, s[40:43], s70 offen offset:0 nt
    ds_read_b32 v3, v31 offset:676
    s_memrealtime s[16:17]
    v_dot2c_f32_bf16_dpp v12, v47, v76 row_newbcast:7 row_mask:0xf bank_mask:0xf
    v_dot2c_f32_bf16_dpp v13, v30, v76 row_newbcast:7 row_mask:0xf bank_mask:0xf
    v_dot2c_f32_bf16_dpp v14, v47, v77 row_newbcast:7 row_mask:0xf bank_mask:0xf
    v_dot2c_f32_bf16_dpp v15, v30, v77 row_newbcast:7 row_mask:0xf bank_mask:0xf
    v_dot2c_f32_bf16_dpp v16, v47, v78 row_newbcast:7 row_mask:0xf bank_mask:0xf
    v_dot2c_f32_bf16_dpp v17, v30, v78 row_newbcast:7 row_mask:0xf bank_mask:0xf
    v_dot2c_f32_bf16_dpp v18, v47, v79 row_newbcast:7 row_mask:0xf bank_mask:0xf
    v_dot2c_f32_bf16_dpp v19, v30, v79 row_newbcast:7 row_mask:0xf bank_mask:0xf
    s_waitcnt vmcnt(8)
    s_waitcnt lgkmcnt(0)
    v_readfirstlane_b32 s15, v3
    s_sub_u32 s16, s16, s84
    s_sub_u32 s16, s16, s15
    s_sub_u32 s16, s16, 3399
    s_mul_i32 s16, s16, 102
    s_ashr_i32 s16, s16, 8
    s_max_i32 s16, s16, 0
    s_min_i32 s16, s16, 63
    s_bfm_b64 s[18:19], s16, 0
    s_bitcmp1_b64 s[18:19], 56
    s_cbranch_scc1 L_w225
    s_waitcnt vmcnt(7)
    s_bitcmp1_b64 s[18:19], 40
    s_cbranch_scc1 L_w225
    s_waitcnt vmcnt(6)
    s_bitcmp1_b64 s[18:19], 24
    s_cbranch_scc1 L_w225
    s_waitcnt vmcnt(5)
    s_bitcmp1_b64 s[18:19], 8
    s_cbranch_scc1 L_w225
    s_waitcnt vmcnt(4)
L_w225:
    buffer_load_dwordx4 v[116:119], v1, s[40:43], s70 offen offset:1024 nt
    v_dot2c_f32_bf16_dpp v12, v47, v80 row_newbcast:8 row_mask:0xf bank_mask:0xf
    v_dot2c_f32_bf16_dpp v13, v30, v80 row_newbcast:8 row_mask:0xf bank_mask:0xf
    v_dot2c_f32_bf16_dpp v14, v47, v81 row_newbcast:8 row_mask:0xf bank_mask:0xf
    v_dot2c_f32_bf16_dpp v15, v30, v81 row_newbcast:8 row_mask:0xf bank_mask:0xf
    v_dot2c_f32_bf16_dpp v16, v47, v82 row_newbcast:8 row_mask:0xf bank_mask:0xf
    v_dot2c_f32_bf16_dpp v17, v30, v82 row_newbcast:8 row_mask:0xf bank_mask:0xf
    v_dot2c_f32_bf16_dpp v18, v47, v83 row_newbcast:8 row_mask:0xf bank_mask:0xf
    v_dot2c_f32_bf16_dpp v19, v30, v83 row_newbcast:8 row_mask:0xf bank_mask:0xf
    s_waitcnt vmcnt(8)
    s_bitcmp1_b64 s[18:19], 52
    s_cbranch_scc1 L_w226
    s_waitcnt vmcnt(7)
    s_bitcmp1_b64 s[18:19], 36
    s_cbranch_scc1 L_w226
    s_waitcnt vmcnt(6)
    s_bitcmp1_b64 s[18:19], 20
    s_cbranch_scc1 L_w226
    s_waitcnt vmcnt(5)
    s_bitcmp1_b64 s[18:19], 4
    s_cbranch_scc1 L_w226
    s_waitcnt vmcnt(4)
L_w226:
    buffer_load_dwordx4 v[120:123], v1, s[40:43], s70 offen offset:2048 nt
    v_dot2c_f32_bf16_dpp v12, v47, v84 row_newbcast:9 row_mask:0xf bank_mask:0xf
    v_dot2c_f32_bf16_dpp v13, v30, v84 row_newbcast:9 row_mask:0xf bank_mask:0xf
    v_dot2c_f32_bf16_dpp v14, v47, v85 row_newbcast:9 row_mask:0xf bank_mask:0xf
    v_dot2c_f32_bf16_dpp v15, v30, v85 row_newbcast:9 row_mask:0xf bank_mask:0xf
    v_dot2c_f32_bf16_dpp v16, v47, v86 row_newbcast:9 row_mask:0xf bank_mask:0xf
    v_dot2c_f32_bf16_dpp v17, v30, v86 row_newbcast:9 row_mask:0xf bank_mask:0xf
    v_dot2c_f32_bf16_dpp v18, v47, v87 row_newbcast:9 row_mask:0xf bank_mask:0xf
    v_dot2c_f32_bf16_dpp v19, v30, v87 row_newbcast:9 row_mask:0xf bank_mask:0xf
    s_waitcnt vmcnt(8)
    s_bitcmp1_b64 s[18:19], 60
    s_cbranch_scc1 L_w227
    s_waitcnt vmcnt(7)
    s_bitcmp1_b64 s[18:19], 44
    s_cbranch_scc1 L_w227
    s_waitcnt vmcnt(6)
    s_bitcmp1_b64 s[18:19], 28
    s_cbranch_scc1 L_w227
    s_waitcnt vmcnt(5)
    s_bitcmp1_b64 s[18:19], 12
    s_cbranch_scc1 L_w227
    s_waitcnt vmcnt(4)
L_w227:
    buffer_load_dwordx4 v[124:127], v1, s[40:43], s70 offen offset:3072 nt
    v_dot2c_f32_bf16_dpp v12, v47, v88 row_newbcast:10 row_mask:0xf bank_mask:0xf
    v_dot2c_f32_bf16_dpp v13, v30, v88 row_newbcast:10 row_mask:0xf bank_mask:0xf
    v_dot2c_f32_bf16_dpp v14, v47, v89 row_newbcast:10 row_mask:0xf bank_mask:0xf
    v_dot2c_f32_bf16_dpp v15, v30, v89 row_newbcast:10 row_mask:0xf bank_mask:0xf
    v_dot2c_f32_bf16_dpp v16, v47, v90 row_newbcast:10 row_mask:0xf bank_mask:0xf
    v_dot2c_f32_bf16_dpp v17, v30, v90 row_newbcast:10 row_mask:0xf bank_mask:0xf
    v_dot2c_f32_bf16_dpp v18, v47, v91 row_newbcast:10 row_mask:0xf bank_mask:0xf
    v_dot2c_f32_bf16_dpp v19, v30, v91 row_newbcast:10 row_mask:0xf bank_mask:0xf
    s_waitcnt vmcnt(8)
    s_bitcmp1_b64 s[18:19], 50
    s_cbranch_scc1 L_w228
    s_waitcnt vmcnt(7)
    s_bitcmp1_b64 s[18:19], 34
    s_cbranch_scc1 L_w228
    s_waitcnt vmcnt(6)
    s_bitcmp1_b64 s[18:19], 18
    s_cbranch_scc1 L_w228
    s_waitcnt vmcnt(5)
    s_bitcmp1_b64 s[18:19], 2
    s_cbranch_scc1 L_w228
    s_waitcnt vmcnt(4)
L_w228:
    buffer_load_dwordx4 v[128:131], v2, s[40:43], s70 offen offset:0 nt
    v_dot2c_f32_bf16_dpp v12, v47, v92 row_newbcast:11 row_mask:0xf bank_mask:0xf
    v_dot2c_f32_bf16_dpp v13, v30, v92 row_newbcast:11 row_mask:0xf bank_mask:0xf
    v_dot2c_f32_bf16_dpp v14, v47, v93 row_newbcast:11 row_mask:0xf bank_mask:0xf
    v_dot2c_f32_bf16_dpp v15, v30, v93 row_newbcast:11 row_mask:0xf bank_mask:0xf
    v_dot2c_f32_bf16_dpp v16, v47, v94 row_newbcast:11 row_mask:0xf bank_mask:0xf
    v_dot2c_f32_bf16_dpp v17, v30, v94 row_newbcast:11 row_mask:0xf bank_mask:0xf
    v_dot2c_f32_bf16_dpp v18, v47, v95 row_newbcast:11 row_mask:0xf bank_mask:0xf
    v_dot2c_f32_bf16_dpp v19, v30, v95 row_newbcast:11 row_mask:0xf bank_mask:0xf
    s_waitcnt vmcnt(8)
    s_bitcmp1_b64 s[18:19], 58
    s_cbranch_scc1 L_w229
    s_waitcnt vmcnt(7)
    s_bitcmp1_b64 s[18:19], 42
    s_cbranch_scc1 L_w229
    s_waitcnt vmcnt(6)
    s_bitcmp1_b64 s[18:19], 26
    s_cbranch_scc1 L_w229
    s_waitcnt vmcnt(5)
    s_bitcmp1_b64 s[18:19], 10
    s_cbranch_scc1 L_w229
    s_waitcnt vmcnt(4)
L_w229:
    buffer_load_dwordx4 v[132:135], v2, s[40:43], s70 offen offset:1024 nt
    v_dot2c_f32_bf16_dpp v12, v47, v96 row_newbcast:12 row_mask:0xf bank_mask:0xf
    v_dot2c_f32_bf16_dpp v13, v30, v96 row_newbcast:12 row_mask:0xf bank_mask:0xf
    v_dot2c_f32_bf16_dpp v14, v47, v97 row_newbcast:12 row_mask:0xf bank_mask:0xf
    v_dot2c_f32_bf16_dpp v15, v30, v97 row_newbcast:12 row_mask:0xf bank_mask:0xf
    v_dot2c_f32_bf16_dpp v16, v47, v98 row_newbcast:12 row_mask:0xf bank_mask:0xf
    v_dot2c_f32_bf16_dpp v17, v30, v98 row_newbcast:12 row_mask:0xf bank_mask:0xf
    v_dot2c_f32_bf16_dpp v18, v47, v99 row_newbcast:12 row_mask:0xf bank_mask:0xf
    v_dot2c_f32_bf16_dpp v19, v30, v99 row_newbcast:12 row_mask:0xf bank_mask:0xf
    s_waitcnt vmcnt(8)
    s_bitcmp1_b64 s[18:19], 54
    s_cbranch_scc1 L_w230
    s_waitcnt vmcnt(7)
    s_bitcmp1_b64 s[18:19], 38
    s_cbranch_scc1 L_w230
    s_waitcnt vmcnt(6)
    s_bitcmp1_b64 s[18:19], 22
    s_cbranch_scc1 L_w230
    s_waitcnt vmcnt(5)
    s_bitcmp1_b64 s[18:19], 6
    s_cbranch_scc1 L_w230
    s_waitcnt vmcnt(4)
L_w230:
    buffer_load_dwordx4 v[136:139], v2, s[40:43], s70 offen offset:2048 nt
    ds_read_b32 v3, v31 offset:676
    s_memrealtime s[16:17]
    v_dot2c_f32_bf16_dpp v12, v47, v100 row_newbcast:13 row_mask:0xf bank_mask:0xf
    v_dot2c_f32_bf16_dpp v13, v30, v100 row_newbcast:13 row_mask:0xf bank_mask:0xf
    v_dot2c_f32_bf16_dpp v14, v47, v101 row_newbcast:13 row_mask:0xf bank_mask:0xf
    v_dot2c_f32_bf16_dpp v15, v30, v101 row_newbcast:13 row_mask:0xf bank_mask:0xf
    v_dot2c_f32_bf16_dpp v16, v47, v102 row_newbcast:13 row_mask:0xf bank_mask:0xf
    v_dot2c_f32_bf16_dpp v17, v30, v102 row_newbcast:13 row_mask:0xf bank_mask:0xf
    v_dot2c_f32_bf16_dpp v18, v47, v103 row_newbcast:13 row_mask:0xf bank_mask:0xf
    v_dot2c_f32_bf16_dpp v19, v30, v103 row_newbcast:13 row_mask:0xf bank_mask:0xf
    s_waitcnt vmcnt(8)
    s_waitcnt lgkmcnt(0)
    v_readfirstlane_b32 s15, v3
    s_sub_u32 s16, s16, s84
    s_sub_u32 s16, s16, s15
    s_sub_u32 s16, s16, 3478
    s_mul_i32 s16, s16, 102
    s_ashr_i32 s16, s16, 8
    s_max_i32 s16, s16, 0
    s_min_i32 s16, s16, 63
    s_bfm_b64 s[18:19], s16, 0
    s_bitcmp1_b64 s[18:19], 62
    s_cbranch_scc1 L_w231
    s_waitcnt vmcnt(7)
    s_bitcmp1_b64 s[18:19], 46
    s_cbranch_scc1 L_w231
    s_waitcnt vmcnt(6)
    s_bitcmp1_b64 s[18:19], 30
    s_cbranch_scc1 L_w231
    s_waitcnt vmcnt(5)
    s_bitcmp1_b64 s[18:19], 14
    s_cbranch_scc1 L_w231
    s_waitcnt vmcnt(4)
L_w231:
    buffer_load_dwordx4 v[140:143], v2, s[40:43], s70 offen offset:3072 nt
    v_dot2c_f32_bf16_dpp v12, v47, v104 row_newbcast:14 row_mask:0xf bank_mask:0xf
    v_dot2c_f32_bf16_dpp v13, v30, v104 row_newbcast:14 row_mask:0xf bank_mask:0xf
    v_dot2c_f32_bf16_dpp v14, v47, v105 row_newbcast:14 row_mask:0xf bank_mask:0xf
    v_dot2c_f32_bf16_dpp v15, v30, v105 row_newbcast:14 row_mask:0xf bank_mask:0xf
    v_dot2c_f32_bf16_dpp v16, v47, v106 row_newbcast:14 row_mask:0xf bank_mask:0xf
    v_dot2c_f32_bf16_dpp v17, v30, v106 row_newbcast:14 row_mask:0xf bank_mask:0xf
    v_dot2c_f32_bf16_dpp v18, v47, v107 row_newbcast:14 row_mask:0xf bank_mask:0xf
    v_dot2c_f32_bf16_dpp v19, v30, v107 row_newbcast:14 row_mask:0xf bank_mask:0xf
    s_waitcnt vmcnt(8)
    s_bitcmp1_b64 s[18:19], 49
    s_cbranch_scc1 L_w232
    s_waitcnt vmcnt(7)
    s_bitcmp1_b64 s[18:19], 33
    s_cbranch_scc1 L_w232
    s_waitcnt vmcnt(6)
    s_bitcmp1_b64 s[18:19], 17
    s_cbranch_scc1 L_w232
    s_waitcnt vmcnt(5)
    s_bitcmp1_b64 s[18:19], 1
    s_cbranch_scc1 L_w232
    s_waitcnt vmcnt(4)
L_w232:
    buffer_load_dwordx4 v[144:147], v1, s[40:43], s71 offen offset:0 nt
    buffer_load_dwordx4 v[148:151], v1, s[40:43], s71 offen offset:1024 nt
    v_dot2c_f32_bf16_dpp v12, v47, v108 row_newbcast:15 row_mask:0xf bank_mask:0xf
    v_dot2c_f32_bf16_dpp v13, v30, v108 row_newbcast:15 row_mask:0xf bank_mask:0xf
    v_dot2c_f32_bf16_dpp v14, v47, v109 row_newbcast:15 row_mask:0xf bank_mask:0xf
    v_dot2c_f32_bf16_dpp v15, v30, v109 row_newbcast:15 row_mask:0xf bank_mask:0xf
    v_dot2c_f32_bf16_dpp v16, v47, v110 row_newbcast:15 row_mask:0xf bank_mask:0xf
    v_dot2c_f32_bf16_dpp v17, v30, v110 row_newbcast:15 row_mask:0xf bank_mask:0xf
    v_dot2c_f32_bf16_dpp v18, v47, v111 row_newbcast:15 row_mask:0xf bank_mask:0xf
    v_dot2c_f32_bf16_dpp v19, v30, v111 row_newbcast:15 row_mask:0xf bank_mask:0xf
    v_permlane32_swap_b32 v12, v16
    v_permlane32_swap_b32 v13, v17
    v_permlane32_swap_b32 v14, v18
    v_permlane32_swap_b32 v15, v19
    v_add_f32 v12, v12, v16
    v_add_f32 v13, v13, v17
    v_add_f32 v14, v14, v18
    v_add_f32 v15, v15, v19
    v_mov_b32 v16, 0
    v_mov_b32 v17, 0
    v_mov_b32 v18, 0
    v_mov_b32 v19, 0
    v_permlane16_swap_b32 v12, v14
    v_permlane16_swap_b32 v13, v15
    v_add_f32 v38, v12, v14
    v_add_f32 v39, v13, v15
    v_mov_b32 v12, 0
    v_mov_b32 v13, 0
    v_mov_b32 v14, 0
    v_mov_b32 v15, 0
    ds_write_b64 v4, v[38:39] offset:4608
    s_mov_b64 exec, 1
    ds_write_b32 v21, v31 offset:624
    s_mov_b64 exec, -1
    s_waitcnt vmcnt(8)
    s_bitcmp1_b64 s[18:19], 53
    s_cbranch_scc1 L_w234
    s_waitcnt vmcnt(7)
    s_bitcmp1_b64 s[18:19], 37
    s_cbranch_scc1 L_w234
    s_waitcnt vmcnt(6)
    s_bitcmp1_b64 s[18:19], 21
    s_cbranch_scc1 L_w234
    s_waitcnt vmcnt(5)
    s_bitcmp1_b64 s[18:19], 5
    s_cbranch_scc1 L_w234
    s_waitcnt vmcnt(4)
L_w234:
    buffer_load_dwordx4 v[152:155], v1, s[40:43], s71 offen offset:2048 nt
    v_dot2c_f32_bf16_dpp v12, v43, v112 row_newbcast:0 row_mask:0xf bank_mask:0xf
    v_dot2c_f32_bf16_dpp v13, v25, v112 row_newbcast:0 row_mask:0xf bank_mask:0xf
    v_dot2c_f32_bf16_dpp v14, v43, v113 row_newbcast:0 row_mask:0xf bank_mask:0xf
    v_dot2c_f32_bf16_dpp v15, v25, v113 row_newbcast:0 row_mask:0xf bank_mask:0xf
    v_dot2c_f32_bf16_dpp v16, v43, v114 row_newbcast:0 row_mask:0xf bank_mask:0xf
    v_dot2c_f32_bf16_dpp v17, v25, v114 row_newbcast:0 row_mask:0xf bank_mask:0xf
    v_dot2c_f32_bf16_dpp v18, v43, v115 row_newbcast:0 row_mask:0xf bank_mask:0xf
    v_dot2c_f32_bf16_dpp v19, v25, v115 row_newbcast:0 row_mask:0xf bank_mask:0xf
    v_dot2c_f32_bf16_dpp v12, v43, v116 row_newbcast:1 row_mask:0xf bank_mask:0xf
    v_dot2c_f32_bf16_dpp v13, v25, v116 row_newbcast:1 row_mask:0xf bank_mask:0xf
    v_dot2c_f32_bf16_dpp v14, v43, v117 row_newbcast:1 row_mask:0xf bank_mask:0xf
    v_dot2c_f32_bf16_dpp v15, v25, v117 row_newbcast:1 row_mask:0xf bank_mask:0xf
    v_dot2c_f32_bf16_dpp v16, v43, v118 row_newbcast:1 row_mask:0xf bank_mask:0xf
    v_dot2c_f32_bf16_dpp v17, v25, v118 row_newbcast:1 row_mask:0xf bank_mask:0xf
    v_dot2c_f32_bf16_dpp v18, v43, v119 row_newbcast:1 row_mask:0xf bank_mask:0xf
    v_dot2c_f32_bf16_dpp v19, v25, v119 row_newbcast:1 row_mask:0xf bank_mask:0xf
    s_waitcnt vmcnt(8)
    s_bitcmp1_b64 s[18:19], 61
    s_cbranch_scc1 L_w235
    s_waitcnt vmcnt(7)
    s_bitcmp1_b64 s[18:19], 45
    s_cbranch_scc1 L_w235
    s_waitcnt vmcnt(6)
    s_bitcmp1_b64 s[18:19], 29
    s_cbranch_scc1 L_w235
    s_waitcnt vmcnt(5)
    s_bitcmp1_b64 s[18:19], 13
    s_cbranch_scc1 L_w235
    s_waitcnt vmcnt(4)
L_w235:
    buffer_load_dwordx4 v[156:159], v1, s[40:43], s71 offen offset:3072 nt
    v_dot2c_f32_bf16_dpp v12, v43, v120 row_newbcast:2 row_mask:0xf bank_mask:0xf
    v_dot2c_f32_bf16_dpp v13, v25, v120 row_newbcast:2 row_mask:0xf bank_mask:0xf
    v_dot2c_f32_bf16_dpp v14, v43, v121 row_newbcast:2 row_mask:0xf bank_mask:0xf
    v_dot2c_f32_bf16_dpp v15, v25, v121 row_newbcast:2 row_mask:0xf bank_mask:0xf
    v_dot2c_f32_bf16_dpp v16, v43, v122 row_newbcast:2 row_mask:0xf bank_mask:0xf
    v_dot2c_f32_bf16_dpp v17, v25, v122 row_newbcast:2 row_mask:0xf bank_mask:0xf
    v_dot2c_f32_bf16_dpp v18, v43, v123 row_newbcast:2 row_mask:0xf bank_mask:0xf
    v_dot2c_f32_bf16_dpp v19, v25, v123 row_newbcast:2 row_mask:0xf bank_mask:0xf
    s_waitcnt vmcnt(8)
    s_bitcmp1_b64 s[18:19], 51
    s_cbranch_scc1 L_w236
    s_waitcnt vmcnt(7)
    s_bitcmp1_b64 s[18:19], 35
    s_cbranch_scc1 L_w236
    s_waitcnt vmcnt(6)
    s_bitcmp1_b64 s[18:19], 19
    s_cbranch_scc1 L_w236
    s_waitcnt vmcnt(5)
    s_bitcmp1_b64 s[18:19], 3
    s_cbranch_scc1 L_w236
    s_waitcnt vmcnt(4)
L_w236:
    buffer_load_dwordx4 v[160:163], v2, s[40:43], s71 offen offset:0 nt
    ds_read_b32 v3, v31 offset:676
    s_memrealtime s[16:17]
    v_dot2c_f32_bf16_dpp v12, v43, v124 row_newbcast:3 row_mask:0xf bank_mask:0xf
    v_dot2c_f32_bf16_dpp v13, v25, v124 row_newbcast:3 row_mask:0xf bank_mask:0xf
    v_dot2c_f32_bf16_dpp v14, v43, v125 row_newbcast:3 row_mask:0xf bank_mask:0xf
    v_dot2c_f32_bf16_dpp v15, v25, v125 row_newbcast:3 row_mask:0xf bank_mask:0xf
    v_dot2c_f32_bf16_dpp v16, v43, v126 row_newbcast:3 row_mask:0xf bank_mask:0xf
    v_dot2c_f32_bf16_dpp v17, v25, v126 row_newbcast:3 row_mask:0xf bank_mask:0xf
    v_dot2c_f32_bf16_dpp v18, v43, v127 row_newbcast:3 row_mask:0xf bank_mask:0xf
    v_dot2c_f32_bf16_dpp v19, v25, v127 row_newbcast:3 row_mask:0xf bank_mask:0xf
    s_waitcnt vmcnt(8)
    s_waitcnt lgkmcnt(0)
    v_readfirstlane_b32 s15, v3
    s_sub_u32 s16, s16, s84
    s_sub_u32 s16, s16, s15
    s_sub_u32 s16, s16, 3556
    s_mul_i32 s16, s16, 102
    s_ashr_i32 s16, s16, 8
    s_max_i32 s16, s16, 0
    s_min_i32 s16, s16, 63
    s_bfm_b64 s[18:19], s16, 0
    s_bitcmp1_b64 s[18:19], 59
    s_cbranch_scc1 L_w237
    s_waitcnt vmcnt(7)
    s_bitcmp1_b64 s[18:19], 43
    s_cbranch_scc1 L_w237
    s_waitcnt vmcnt(6)
    s_bitcmp1_b64 s[18:19], 27
    s_cbranch_scc1 L_w237
    s_waitcnt vmcnt(5)
    s_bitcmp1_b64 s[18:19], 11
    s_cbranch_scc1 L_w237
    s_waitcnt vmcnt(4)
L_w237:
    buffer_load_dwordx4 v[164:167], v2, s[40:43], s71 offen offset:1024 nt
    v_dot2c_f32_bf16_dpp v12, v43, v128 row_newbcast:4 row_mask:0xf bank_mask:0xf
    v_dot2c_f32_bf16_dpp v13, v25, v128 row_newbcast:4 row_mask:0xf bank_mask:0xf
    v_dot2c_f32_bf16_dpp v14, v43, v129 row_newbcast:4 row_mask:0xf bank_mask:0xf
    v_dot2c_f32_bf16_dpp v15, v25, v129 row_newbcast:4 row_mask:0xf bank_mask:0xf
    v_dot2c_f32_bf16_dpp v16, v43, v130 row_newbcast:4 row_mask:0xf bank_mask:0xf
    v_dot2c_f32_bf16_dpp v17, v25, v130 row_newbcast:4 row_mask:0xf bank_mask:0xf
    v_dot2c_f32_bf16_dpp v18, v43, v131 row_newbcast:4 row_mask:0xf bank_mask:0xf
    v_dot2c_f32_bf16_dpp v19, v25, v131 row_newbcast:4 row_mask:0xf bank_mask:0xf
    s_waitcnt vmcnt(8)
    s_bitcmp1_b64 s[18:19], 55
    s_cbranch_scc1 L_w238
    s_waitcnt vmcnt(7)
    s_bitcmp1_b64 s[18:19], 39
    s_cbranch_scc1 L_w238
    s_waitcnt vmcnt(6)
    s_bitcmp1_b64 s[18:19], 23
    s_cbranch_scc1 L_w238
    s_waitcnt vmcnt(5)
    s_bitcmp1_b64 s[18:19], 7
    s_cbranch_scc1 L_w238
    s_waitcnt vmcnt(4)
L_w238:
    buffer_load_dwordx4 v[168:171], v2, s[40:43], s71 offen offset:2048 nt
    v_dot2c_f32_bf16_dpp v12, v43, v132 row_newbcast:5 row_mask:0xf bank_mask:0xf
    v_dot2c_f32_bf16_dpp v13, v25, v132 row_newbcast:5 row_mask:0xf bank_mask:0xf
    v_dot2c_f32_bf16_dpp v14, v43, v133 row_newbcast:5 row_mask:0xf bank_mask:0xf
    v_dot2c_f32_bf16_dpp v15, v25, v133 row_newbcast:5 row_mask:0xf bank_mask:0xf
    v_dot2c_f32_bf16_dpp v16, v43, v134 row_newbcast:5 row_mask:0xf bank_mask:0xf
    v_dot2c_f32_bf16_dpp v17, v25, v134 row_newbcast:5 row_mask:0xf bank_mask:0xf
    v_dot2c_f32_bf16_dpp v18, v43, v135 row_newbcast:5 row_mask:0xf bank_mask:0xf
    v_dot2c_f32_bf16_dpp v19, v25, v135 row_newbcast:5 row_mask:0xf bank_mask:0xf
    s_waitcnt vmcnt(8)
    s_bitcmp1_b64 s[18:19], 63
    s_cbranch_scc1 L_w239
    s_waitcnt vmcnt(7)
    s_bitcmp1_b64 s[18:19], 47
    s_cbranch_scc1 L_w239
    s_waitcnt vmcnt(6)
    s_bitcmp1_b64 s[18:19], 31
    s_cbranch_scc1 L_w239
    s_waitcnt vmcnt(5)
    s_bitcmp1_b64 s[18:19], 15
    s_cbranch_scc1 L_w239
    s_waitcnt vmcnt(4)
L_w239:
    buffer_load_dwordx4 v[172:175], v2, s[40:43], s71 offen offset:3072 nt
    v_dot2c_f32_bf16_dpp v12, v43, v136 row_newbcast:6 row_mask:0xf bank_mask:0xf
    v_dot2c_f32_bf16_dpp v13, v25, v136 row_newbcast:6 row_mask:0xf bank_mask:0xf
    v_dot2c_f32_bf16_dpp v14, v43, v137 row_newbcast:6 row_mask:0xf bank_mask:0xf
    v_dot2c_f32_bf16_dpp v15, v25, v137 row_newbcast:6 row_mask:0xf bank_mask:0xf
    v_dot2c_f32_bf16_dpp v16, v43, v138 row_newbcast:6 row_mask:0xf bank_mask:0xf
    v_dot2c_f32_bf16_dpp v17, v25, v138 row_newbcast:6 row_mask:0xf bank_mask:0xf
    v_dot2c_f32_bf16_dpp v18, v43, v139 row_newbcast:6 row_mask:0xf bank_mask:0xf
    v_dot2c_f32_bf16_dpp v19, v25, v139 row_newbcast:6 row_mask:0xf bank_mask:0xf
    s_waitcnt vmcnt(8)
    s_bitcmp1_b64 s[18:19], 48
    s_cbranch_scc1 L_w240
    s_waitcnt vmcnt(7)
    s_bitcmp1_b64 s[18:19], 32
    s_cbranch_scc1 L_w240
    s_waitcnt vmcnt(6)
    s_bitcmp1_b64 s[18:19], 16
    s_cbranch_scc1 L_w240
    s_waitcnt vmcnt(5)
    s_bitcmp1_b64 s[18:19], 0
    s_cbranch_scc1 L_w240
    s_waitcnt vmcnt(4)
L_w240:
    buffer_load_dwordx4 v[176:179], v1, s[40:43], s72 offen offset:0 nt
    v_dot2c_f32_bf16_dpp v12, v43, v140 row_newbcast:7 row_mask:0xf bank_mask:0xf
    v_dot2c_f32_bf16_dpp v13, v25, v140 row_newbcast:7 row_mask:0xf bank_mask:0xf
    v_dot2c_f32_bf16_dpp v14, v43, v141 row_newbcast:7 row_mask:0xf bank_mask:0xf
    v_dot2c_f32_bf16_dpp v15, v25, v141 row_newbcast:7 row_mask:0xf bank_mask:0xf
    v_dot2c_f32_bf16_dpp v16, v43, v142 row_newbcast:7 row_mask:0xf bank_mask:0xf
    v_dot2c_f32_bf16_dpp v17, v25, v142 row_newbcast:7 row_mask:0xf bank_mask:0xf
    v_dot2c_f32_bf16_dpp v18, v43, v143 row_newbcast:7 row_mask:0xf bank_mask:0xf
    v_dot2c_f32_bf16_dpp v19, v25, v143 row_newbcast:7 row_mask:0xf bank_mask:0xf
    s_waitcnt vmcnt(8)
    s_bitcmp1_b64 s[18:19], 56
    s_cbranch_scc1 L_w241
    s_waitcnt vmcnt(7)
    s_bitcmp1_b64 s[18:19], 40
    s_cbranch_scc1 L_w241
    s_waitcnt vmcnt(6)
    s_bitcmp1_b64 s[18:19], 24
    s_cbranch_scc1 L_w241
    s_waitcnt vmcnt(5)
    s_bitcmp1_b64 s[18:19], 8
    s_cbranch_scc1 L_w241
    s_waitcnt vmcnt(4)
L_w241:
    buffer_load_dwordx4 v[180:183], v1, s[40:43], s72 offen offset:1024 nt
    v_dot2c_f32_bf16_dpp v12, v43, v144 row_newbcast:8 row_mask:0xf bank_mask:0xf
    v_dot2c_f32_bf16_dpp v13, v25, v144 row_newbcast:8 row_mask:0xf bank_mask:0xf
    v_dot2c_f32_bf16_dpp v14, v43, v145 row_newbcast:8 row_mask:0xf bank_mask:0xf
    v_dot2c_f32_bf16_dpp v15, v25, v145 row_newbcast:8 row_mask:0xf bank_mask:0xf
    v_dot2c_f32_bf16_dpp v16, v43, v146 row_newbcast:8 row_mask:0xf bank_mask:0xf
    v_dot2c_f32_bf16_dpp v17, v25, v146 row_newbcast:8 row_mask:0xf bank_mask:0xf
    v_dot2c_f32_bf16_dpp v18, v43, v147 row_newbcast:8 row_mask:0xf bank_mask:0xf
    v_dot2c_f32_bf16_dpp v19, v25, v147 row_newbcast:8 row_mask:0xf bank_mask:0xf
    s_waitcnt vmcnt(8)
    s_bitcmp1_b64 s[18:19], 52
    s_cbranch_scc1 L_w242
    s_waitcnt vmcnt(7)
    s_bitcmp1_b64 s[18:19], 36
    s_cbranch_scc1 L_w242
    s_waitcnt vmcnt(6)
    s_bitcmp1_b64 s[18:19], 20
    s_cbranch_scc1 L_w242
    s_waitcnt vmcnt(5)
    s_bitcmp1_b64 s[18:19], 4
    s_cbranch_scc1 L_w242
    s_waitcnt vmcnt(4)
L_w242:
    buffer_load_dwordx4 v[184:187], v1, s[40:43], s72 offen offset:2048 nt
    ds_read_b32 v3, v31 offset:676
    s_memrealtime s[16:17]
    v_dot2c_f32_bf16_dpp v12, v43, v148 row_newbcast:9 row_mask:0xf bank_mask:0xf
    v_dot2c_f32_bf16_dpp v13, v25, v148 row_newbcast:9 row_mask:0xf bank_mask:0xf
    v_dot2c_f32_bf16_dpp v14, v43, v149 row_newbcast:9 row_mask:0xf bank_mask:0xf
    v_dot2c_f32_bf16_dpp v15, v25, v149 row_newbcast:9 row_mask:0xf bank_mask:0xf
    v_dot2c_f32_bf16_dpp v16, v43, v150 row_newbcast:9 row_mask:0xf bank_mask:0xf
    v_dot2c_f32_bf16_dpp v17, v25, v150 row_newbcast:9 row_mask:0xf bank_mask:0xf
    v_dot2c_f32_bf16_dpp v18, v43, v151 row_newbcast:9 row_mask:0xf bank_mask:0xf
    v_dot2c_f32_bf16_dpp v19, v25, v151 row_newbcast:9 row_mask:0xf bank_mask:0xf
    s_waitcnt vmcnt(8)
    s_waitcnt lgkmcnt(0)
    v_readfirstlane_b32 s15, v3
    s_sub_u32 s16, s16, s84
    s_sub_u32 s16, s16, s15
    s_sub_u32 s16, s16, 3635
    s_mul_i32 s16, s16, 102
    s_ashr_i32 s16, s16, 8
    s_max_i32 s16, s16, 0
    s_min_i32 s16, s16, 63
    s_bfm_b64 s[18:19], s16, 0
    s_bitcmp1_b64 s[18:19], 60
    s_cbranch_scc1 L_w243
    s_waitcnt vmcnt(7)
    s_bitcmp1_b64 s[18:19], 44
    s_cbranch_scc1 L_w243
    s_waitcnt vmcnt(6)
    s_bitcmp1_b64 s[18:19], 28
    s_cbranch_scc1 L_w243
    s_waitcnt vmcnt(5)
    s_bitcmp1_b64 s[18:19], 12
    s_cbranch_scc1 L_w243
    s_waitcnt vmcnt(4)
L_w243:
    buffer_load_dwordx4 v[188:191], v1, s[40:43], s72 offen offset:3072 nt
    v_dot2c_f32_bf16_dpp v12, v43, v152 row_newbcast:10 row_mask:0xf bank_mask:0xf
    v_dot2c_f32_bf16_dpp v13, v25, v152 row_newbcast:10 row_mask:0xf bank_mask:0xf
    v_dot2c_f32_bf16_dpp v14, v43, v153 row_newbcast:10 row_mask:0xf bank_mask:0xf
    v_dot2c_f32_bf16_dpp v15, v25, v153 row_newbcast:10 row_mask:0xf bank_mask:0xf
    v_dot2c_f32_bf16_dpp v16, v43, v154 row_newbcast:10 row_mask:0xf bank_mask:0xf
    v_dot2c_f32_bf16_dpp v17, v25, v154 row_newbcast:10 row_mask:0xf bank_mask:0xf
    v_dot2c_f32_bf16_dpp v18, v43, v155 row_newbcast:10 row_mask:0xf bank_mask:0xf
    v_dot2c_f32_bf16_dpp v19, v25, v155 row_newbcast:10 row_mask:0xf bank_mask:0xf
    s_waitcnt vmcnt(8)
    s_bitcmp1_b64 s[18:19], 50
    s_cbranch_scc1 L_w244
    s_waitcnt vmcnt(7)
    s_bitcmp1_b64 s[18:19], 34
    s_cbranch_scc1 L_w244
    s_waitcnt vmcnt(6)
    s_bitcmp1_b64 s[18:19], 18
    s_cbranch_scc1 L_w244
    s_waitcnt vmcnt(5)
    s_bitcmp1_b64 s[18:19], 2
    s_cbranch_scc1 L_w244
    s_waitcnt vmcnt(4)
L_w244:
    buffer_load_dwordx4 v[192:195], v2, s[40:43], s72 offen offset:0 nt
    v_dot2c_f32_bf16_dpp v12, v43, v156 row_newbcast:11 row_mask:0xf bank_mask:0xf
    v_dot2c_f32_bf16_dpp v13, v25, v156 row_newbcast:11 row_mask:0xf bank_mask:0xf
    v_dot2c_f32_bf16_dpp v14, v43, v157 row_newbcast:11 row_mask:0xf bank_mask:0xf
    v_dot2c_f32_bf16_dpp v15, v25, v157 row_newbcast:11 row_mask:0xf bank_mask:0xf
    v_dot2c_f32_bf16_dpp v16, v43, v158 row_newbcast:11 row_mask:0xf bank_mask:0xf
    v_dot2c_f32_bf16_dpp v17, v25, v158 row_newbcast:11 row_mask:0xf bank_mask:0xf
    v_dot2c_f32_bf16_dpp v18, v43, v159 row_newbcast:11 row_mask:0xf bank_mask:0xf
    v_dot2c_f32_bf16_dpp v19, v25, v159 row_newbcast:11 row_mask:0xf bank_mask:0xf
    s_waitcnt vmcnt(8)
    s_bitcmp1_b64 s[18:19], 58
    s_cbranch_scc1 L_w245
    s_waitcnt vmcnt(7)
    s_bitcmp1_b64 s[18:19], 42
    s_cbranch_scc1 L_w245
    s_waitcnt vmcnt(6)
    s_bitcmp1_b64 s[18:19], 26
    s_cbranch_scc1 L_w245
    s_waitcnt vmcnt(5)
    s_bitcmp1_b64 s[18:19], 10
    s_cbranch_scc1 L_w245
    s_waitcnt vmcnt(4)
L_w245:
    buffer_load_dwordx4 v[196:199], v2, s[40:43], s72 offen offset:1024 nt
    v_dot2c_f32_bf16_dpp v12, v43, v160 row_newbcast:12 row_mask:0xf bank_mask:0xf
    v_dot2c_f32_bf16_dpp v13, v25, v160 row_newbcast:12 row_mask:0xf bank_mask:0xf
    v_dot2c_f32_bf16_dpp v14, v43, v161 row_newbcast:12 row_mask:0xf bank_mask:0xf
    v_dot2c_f32_bf16_dpp v15, v25, v161 row_newbcast:12 row_mask:0xf bank_mask:0xf
    v_dot2c_f32_bf16_dpp v16, v43, v162 row_newbcast:12 row_mask:0xf bank_mask:0xf
    v_dot2c_f32_bf16_dpp v17, v25, v162 row_newbcast:12 row_mask:0xf bank_mask:0xf
    v_dot2c_f32_bf16_dpp v18, v43, v163 row_newbcast:12 row_mask:0xf bank_mask:0xf
    v_dot2c_f32_bf16_dpp v19, v25, v163 row_newbcast:12 row_mask:0xf bank_mask:0xf
    s_waitcnt vmcnt(8)
    s_bitcmp1_b64 s[18:19], 54
    s_cbranch_scc1 L_w246
    s_waitcnt vmcnt(7)
    s_bitcmp1_b64 s[18:19], 38
    s_cbranch_scc1 L_w246
    s_waitcnt vmcnt(6)
    s_bitcmp1_b64 s[18:19], 22
    s_cbranch_scc1 L_w246
    s_waitcnt vmcnt(5)
    s_bitcmp1_b64 s[18:19], 6
    s_cbranch_scc1 L_w246
    s_waitcnt vmcnt(4)
L_w246:
    buffer_load_dwordx4 v[200:203], v2, s[40:43], s72 offen offset:2048 nt
    v_dot2c_f32_bf16_dpp v12, v43, v164 row_newbcast:13 row_mask:0xf bank_mask:0xf
    v_dot2c_f32_bf16_dpp v13, v25, v164 row_newbcast:13 row_mask:0xf bank_mask:0xf
    v_dot2c_f32_bf16_dpp v14, v43, v165 row_newbcast:13 row_mask:0xf bank_mask:0xf
    v_dot2c_f32_bf16_dpp v15, v25, v165 row_newbcast:13 row_mask:0xf bank_mask:0xf
    v_dot2c_f32_bf16_dpp v16, v43, v166 row_newbcast:13 row_mask:0xf bank_mask:0xf
    v_dot2c_f32_bf16_dpp v17, v25, v166 row_newbcast:13 row_mask:0xf bank_mask:0xf
    v_dot2c_f32_bf16_dpp v18, v43, v167 row_newbcast:13 row_mask:0xf bank_mask:0xf
    v_dot2c_f32_bf16_dpp v19, v25, v167 row_newbcast:13 row_mask:0xf bank_mask:0xf
    s_waitcnt vmcnt(8)
    s_bitcmp1_b64 s[18:19], 62
    s_cbranch_scc1 L_w247
    s_waitcnt vmcnt(7)
    s_bitcmp1_b64 s[18:19], 46
    s_cbranch_scc1 L_w247
    s_waitcnt vmcnt(6)
    s_bitcmp1_b64 s[18:19], 30
    s_cbranch_scc1 L_w247
    s_waitcnt vmcnt(5)
    s_bitcmp1_b64 s[18:19], 14
    s_cbranch_scc1 L_w247
    s_waitcnt vmcnt(4)
L_w247:
    buffer_load_dwordx4 v[204:207], v2, s[40:43], s72 offen offset:3072 nt
    v_dot2c_f32_bf16_dpp v12, v43, v168 row_newbcast:14 row_mask:0xf bank_mask:0xf
    v_dot2c_f32_bf16_dpp v13, v25, v168 row_newbcast:14 row_mask:0xf bank_mask:0xf
    v_dot2c_f32_bf16_dpp v14, v43, v169 row_newbcast:14 row_mask:0xf bank_mask:0xf
    v_dot2c_f32_bf16_dpp v15, v25, v169 row_newbcast:14 row_mask:0xf bank_mask:0xf
    v_dot2c_f32_bf16_dpp v16, v43, v170 row_newbcast:14 row_mask:0xf bank_mask:0xf
    v_dot2c_f32_bf16_dpp v17, v25, v170 row_newbcast:14 row_mask:0xf bank_mask:0xf
    v_dot2c_f32_bf16_dpp v18, v43, v171 row_newbcast:14 row_mask:0xf bank_mask:0xf
    v_dot2c_f32_bf16_dpp v19, v25, v171 row_newbcast:14 row_mask:0xf bank_mask:0xf
    s_waitcnt vmcnt(8)
    s_bitcmp1_b64 s[18:19], 49
    s_cbranch_scc1 L_w248
    s_waitcnt vmcnt(7)
    s_bitcmp1_b64 s[18:19], 33
    s_cbranch_scc1 L_w248
    s_waitcnt vmcnt(6)
    s_bitcmp1_b64 s[18:19], 17
    s_cbranch_scc1 L_w248
    s_waitcnt vmcnt(5)
    s_bitcmp1_b64 s[18:19], 1
    s_cbranch_scc1 L_w248
    s_waitcnt vmcnt(4)
L_w248:
    buffer_load_dwordx4 v[208:211], v1, s[40:43], s73 offen offset:0 nt
    ds_read_b32 v3, v31 offset:676
    s_memrealtime s[16:17]
    v_dot2c_f32_bf16_dpp v12, v43, v172 row_newbcast:15 row_mask:0xf bank_mask:0xf
    v_dot2c_f32_bf16_dpp v13, v25, v172 row_newbcast:15 row_mask:0xf bank_mask:0xf
    v_dot2c_f32_bf16_dpp v14, v43, v173 row_newbcast:15 row_mask:0xf bank_mask:0xf
    v_dot2c_f32_bf16_dpp v15, v25, v173 row_newbcast:15 row_mask:0xf bank_mask:0xf
    v_dot2c_f32_bf16_dpp v16, v43, v174 row_newbcast:15 row_mask:0xf bank_mask:0xf
    v_dot2c_f32_bf16_dpp v17, v25, v174 row_newbcast:15 row_mask:0xf bank_mask:0xf
    v_dot2c_f32_bf16_dpp v18, v43, v175 row_newbcast:15 row_mask:0xf bank_mask:0xf
    v_dot2c_f32_bf16_dpp v19, v25, v175 row_newbcast:15 row_mask:0xf bank_mask:0xf
    s_waitcnt vmcnt(8)
    s_waitcnt lgkmcnt(0)
    v_readfirstlane_b32 s15, v3
    s_sub_u32 s16, s16, s84
    s_sub_u32 s16, s16, s15
    s_sub_u32 s16, s16, 3713
    s_mul_i32 s16, s16, 102
    s_ashr_i32 s16, s16, 8
    s_max_i32 s16, s16, 0
    s_min_i32 s16, s16, 63
    s_bfm_b64 s[18:19], s16, 0
    s_bitcmp1_b64 s[18:19], 57
    s_cbranch_scc1 L_w249
    s_waitcnt vmcnt(7)
    s_bitcmp1_b64 s[18:19], 41
    s_cbranch_scc1 L_w249
    s_waitcnt vmcnt(6)
    s_bitcmp1_b64 s[18:19], 25
    s_cbranch_scc1 L_w249
    s_waitcnt vmcnt(5)
    s_bitcmp1_b64 s[18:19], 9
    s_cbranch_scc1 L_w249
    s_waitcnt vmcnt(4)
L_w249:
    buffer_load_dwordx4 v[212:215], v1, s[40:43], s73 offen offset:1024 nt
    v_dot2c_f32_bf16_dpp v12, v44, v176 row_newbcast:0 row_mask:0xf bank_mask:0xf
    v_dot2c_f32_bf16_dpp v13, v26, v176 row_newbcast:0 row_mask:0xf bank_mask:0xf
    v_dot2c_f32_bf16_dpp v14, v44, v177 row_newbcast:0 row_mask:0xf bank_mask:0xf
    v_dot2c_f32_bf16_dpp v15, v26, v177 row_newbcast:0 row_mask:0xf bank_mask:0xf
    v_dot2c_f32_bf16_dpp v16, v44, v178 row_newbcast:0 row_mask:0xf bank_mask:0xf
    v_dot2c_f32_bf16_dpp v17, v26, v178 row_newbcast:0 row_mask:0xf bank_mask:0xf
    v_dot2c_f32_bf16_dpp v18, v44, v179 row_newbcast:0 row_mask:0xf bank_mask:0xf
    v_dot2c_f32_bf16_dpp v19, v26, v179 row_newbcast:0 row_mask:0xf bank_mask:0xf
    s_waitcnt vmcnt(8)
    s_bitcmp1_b64 s[18:19], 53
    s_cbranch_scc1 L_w250
    s_waitcnt vmcnt(7)
    s_bitcmp1_b64 s[18:19], 37
    s_cbranch_scc1 L_w250
    s_waitcnt vmcnt(6)
    s_bitcmp1_b64 s[18:19], 21
    s_cbranch_scc1 L_w250
    s_waitcnt vmcnt(5)
    s_bitcmp1_b64 s[18:19], 5
    s_cbranch_scc1 L_w250
    s_waitcnt vmcnt(4)
L_w250:
    buffer_load_dwordx4 v[216:219], v1, s[40:43], s73 offen offset:2048 nt
    v_dot2c_f32_bf16_dpp v12, v44, v180 row_newbcast:1 row_mask:0xf bank_mask:0xf
    v_dot2c_f32_bf16_dpp v13, v26, v180 row_newbcast:1 row_mask:0xf bank_mask:0xf
    v_dot2c_f32_bf16_dpp v14, v44, v181 row_newbcast:1 row_mask:0xf bank_mask:0xf
    v_dot2c_f32_bf16_dpp v15, v26, v181 row_newbcast:1 row_mask:0xf bank_mask:0xf
    v_dot2c_f32_bf16_dpp v16, v44, v182 row_newbcast:1 row_mask:0xf bank_mask:0xf
    v_dot2c_f32_bf16_dpp v17, v26, v182 row_newbcast:1 row_mask:0xf bank_mask:0xf
    v_dot2c_f32_bf16_dpp v18, v44, v183 row_newbcast:1 row_mask:0xf bank_mask:0xf
    v_dot2c_f32_bf16_dpp v19, v26, v183 row_newbcast:1 row_mask:0xf bank_mask:0xf
    s_waitcnt vmcnt(8)
    s_bitcmp1_b64 s[18:19], 61
    s_cbranch_scc1 L_w251
    s_waitcnt vmcnt(7)
    s_bitcmp1_b64 s[18:19], 45
    s_cbranch_scc1 L_w251
    s_waitcnt vmcnt(6)
    s_bitcmp1_b64 s[18:19], 29
    s_cbranch_scc1 L_w251
    s_waitcnt vmcnt(5)
    s_bitcmp1_b64 s[18:19], 13
    s_cbranch_scc1 L_w251
    s_waitcnt vmcnt(4)
L_w251:
    buffer_load_dwordx4 v[220:223], v1, s[40:43], s73 offen offset:3072 nt
    v_dot2c_f32_bf16_dpp v12, v44, v184 row_newbcast:2 row_mask:0xf bank_mask:0xf
    v_dot2c_f32_bf16_dpp v13, v26, v184 row_newbcast:2 row_mask:0xf bank_mask:0xf
    v_dot2c_f32_bf16_dpp v14, v44, v185 row_newbcast:2 row_mask:0xf bank_mask:0xf
    v_dot2c_f32_bf16_dpp v15, v26, v185 row_newbcast:2 row_mask:0xf bank_mask:0xf
    v_dot2c_f32_bf16_dpp v16, v44, v186 row_newbcast:2 row_mask:0xf bank_mask:0xf
    v_dot2c_f32_bf16_dpp v17, v26, v186 row_newbcast:2 row_mask:0xf bank_mask:0xf
    v_dot2c_f32_bf16_dpp v18, v44, v187 row_newbcast:2 row_mask:0xf bank_mask:0xf
    v_dot2c_f32_bf16_dpp v19, v26, v187 row_newbcast:2 row_mask:0xf bank_mask:0xf
    s_waitcnt vmcnt(8)
    s_bitcmp1_b64 s[18:19], 51
    s_cbranch_scc1 L_w252
    s_waitcnt vmcnt(7)
    s_bitcmp1_b64 s[18:19], 35
    s_cbranch_scc1 L_w252
    s_waitcnt vmcnt(6)
    s_bitcmp1_b64 s[18:19], 19
    s_cbranch_scc1 L_w252
    s_waitcnt vmcnt(5)
    s_bitcmp1_b64 s[18:19], 3
    s_cbranch_scc1 L_w252
    s_waitcnt vmcnt(4)
L_w252:
    buffer_load_dwordx4 v[224:227], v2, s[40:43], s73 offen offset:0 nt
    v_dot2c_f32_bf16_dpp v12, v44, v188 row_newbcast:3 row_mask:0xf bank_mask:0xf
    v_dot2c_f32_bf16_dpp v13, v26, v188 row_newbcast:3 row_mask:0xf bank_mask:0xf
    v_dot2c_f32_bf16_dpp v14, v44, v189 row_newbcast:3 row_mask:0xf bank_mask:0xf
    v_dot2c_f32_bf16_dpp v15, v26, v189 row_newbcast:3 row_mask:0xf bank_mask:0xf
    v_dot2c_f32_bf16_dpp v16, v44, v190 row_newbcast:3 row_mask:0xf bank_mask:0xf
    v_dot2c_f32_bf16_dpp v17, v26, v190 row_newbcast:3 row_mask:0xf bank_mask:0xf
    v_dot2c_f32_bf16_dpp v18, v44, v191 row_newbcast:3 row_mask:0xf bank_mask:0xf
    v_dot2c_f32_bf16_dpp v19, v26, v191 row_newbcast:3 row_mask:0xf bank_mask:0xf
    s_waitcnt vmcnt(8)
    s_bitcmp1_b64 s[18:19], 59
    s_cbranch_scc1 L_w253
    s_waitcnt vmcnt(7)
    s_bitcmp1_b64 s[18:19], 43
    s_cbranch_scc1 L_w253
    s_waitcnt vmcnt(6)
    s_bitcmp1_b64 s[18:19], 27
    s_cbranch_scc1 L_w253
    s_waitcnt vmcnt(5)
    s_bitcmp1_b64 s[18:19], 11
    s_cbranch_scc1 L_w253
    s_waitcnt vmcnt(4)
L_w253:
    buffer_load_dwordx4 v[228:231], v2, s[40:43], s73 offen offset:1024 nt
    v_dot2c_f32_bf16_dpp v12, v44, v192 row_newbcast:4 row_mask:0xf bank_mask:0xf
    v_dot2c_f32_bf16_dpp v13, v26, v192 row_newbcast:4 row_mask:0xf bank_mask:0xf
    v_dot2c_f32_bf16_dpp v14, v44, v193 row_newbcast:4 row_mask:0xf bank_mask:0xf
    v_dot2c_f32_bf16_dpp v15, v26, v193 row_newbcast:4 row_mask:0xf bank_mask:0xf
    v_dot2c_f32_bf16_dpp v16, v44, v194 row_newbcast:4 row_mask:0xf bank_mask:0xf
    v_dot2c_f32_bf16_dpp v17, v26, v194 row_newbcast:4 row_mask:0xf bank_mask:0xf
    v_dot2c_f32_bf16_dpp v18, v44, v195 row_newbcast:4 row_mask:0xf bank_mask:0xf
    v_dot2c_f32_bf16_dpp v19, v26, v195 row_newbcast:4 row_mask:0xf bank_mask:0xf
    s_waitcnt vmcnt(8)
    s_bitcmp1_b64 s[18:19], 55
    s_cbranch_scc1 L_w254
    s_waitcnt vmcnt(7)
    s_bitcmp1_b64 s[18:19], 39
    s_cbranch_scc1 L_w254
    s_waitcnt vmcnt(6)
    s_bitcmp1_b64 s[18:19], 23
    s_cbranch_scc1 L_w254
    s_waitcnt vmcnt(5)
    s_bitcmp1_b64 s[18:19], 7
    s_cbranch_scc1 L_w254
    s_waitcnt vmcnt(4)
L_w254:
    buffer_load_dwordx4 v[232:235], v2, s[40:43], s73 offen offset:2048 nt
    v_dot2c_f32_bf16_dpp v12, v44, v196 row_newbcast:5 row_mask:0xf bank_mask:0xf
    v_dot2c_f32_bf16_dpp v13, v26, v196 row_newbcast:5 row_mask:0xf bank_mask:0xf
    v_dot2c_f32_bf16_dpp v14, v44, v197 row_newbcast:5 row_mask:0xf bank_mask:0xf
    v_dot2c_f32_bf16_dpp v15, v26, v197 row_newbcast:5 row_mask:0xf bank_mask:0xf
    v_dot2c_f32_bf16_dpp v16, v44, v198 row_newbcast:5 row_mask:0xf bank_mask:0xf
    v_dot2c_f32_bf16_dpp v17, v26, v198 row_newbcast:5 row_mask:0xf bank_mask:0xf
    v_dot2c_f32_bf16_dpp v18, v44, v199 row_newbcast:5 row_mask:0xf bank_mask:0xf
    v_dot2c_f32_bf16_dpp v19, v26, v199 row_newbcast:5 row_mask:0xf bank_mask:0xf
    s_waitcnt vmcnt(8)
    s_bitcmp1_b64 s[18:19], 63
    s_cbranch_scc1 L_w255
    s_waitcnt vmcnt(7)
    s_bitcmp1_b64 s[18:19], 47
    s_cbranch_scc1 L_w255
    s_waitcnt vmcnt(6)
    s_bitcmp1_b64 s[18:19], 31
    s_cbranch_scc1 L_w255
    s_waitcnt vmcnt(5)
    s_bitcmp1_b64 s[18:19], 15
    s_cbranch_scc1 L_w255
    s_waitcnt vmcnt(4)
L_w255:
    buffer_load_dwordx4 v[236:239], v2, s[40:43], s73 offen offset:3072 nt
    v_dot2c_f32_bf16_dpp v12, v44, v200 row_newbcast:6 row_mask:0xf bank_mask:0xf
    v_dot2c_f32_bf16_dpp v13, v26, v200 row_newbcast:6 row_mask:0xf bank_mask:0xf
    v_dot2c_f32_bf16_dpp v14, v44, v201 row_newbcast:6 row_mask:0xf bank_mask:0xf
    v_dot2c_f32_bf16_dpp v15, v26, v201 row_newbcast:6 row_mask:0xf bank_mask:0xf
    v_dot2c_f32_bf16_dpp v16, v44, v202 row_newbcast:6 row_mask:0xf bank_mask:0xf
    v_dot2c_f32_bf16_dpp v17, v26, v202 row_newbcast:6 row_mask:0xf bank_mask:0xf
    v_dot2c_f32_bf16_dpp v18, v44, v203 row_newbcast:6 row_mask:0xf bank_mask:0xf
    v_dot2c_f32_bf16_dpp v19, v26, v203 row_newbcast:6 row_mask:0xf bank_mask:0xf
    v_lshlrev_b32 v3, 3, v7
    s_mov_b32 s8, 0x40000
    s_waitcnt vmcnt(8)
    v_dot2c_f32_bf16_dpp v12, v44, v204 row_newbcast:7 row_mask:0xf bank_mask:0xf
    v_dot2c_f32_bf16_dpp v13, v26, v204 row_newbcast:7 row_mask:0xf bank_mask:0xf
    v_dot2c_f32_bf16_dpp v14, v44, v205 row_newbcast:7 row_mask:0xf bank_mask:0xf
    v_dot2c_f32_bf16_dpp v15, v26, v205 row_newbcast:7 row_mask:0xf bank_mask:0xf
    v_dot2c_f32_bf16_dpp v16, v44, v206 row_newbcast:7 row_mask:0xf bank_mask:0xf
    v_dot2c_f32_bf16_dpp v17, v26, v206 row_newbcast:7 row_mask:0xf bank_mask:0xf
    v_dot2c_f32_bf16_dpp v18, v44, v207 row_newbcast:7 row_mask:0xf bank_mask:0xf
    v_dot2c_f32_bf16_dpp v19, v26, v207 row_newbcast:7 row_mask:0xf bank_mask:0xf
    s_waitcnt vmcnt(7)
    v_dot2c_f32_bf16_dpp v12, v44, v208 row_newbcast:8 row_mask:0xf bank_mask:0xf
    v_dot2c_f32_bf16_dpp v13, v26, v208 row_newbcast:8 row_mask:0xf bank_mask:0xf
    v_dot2c_f32_bf16_dpp v14, v44, v209 row_newbcast:8 row_mask:0xf bank_mask:0xf
    v_dot2c_f32_bf16_dpp v15, v26, v209 row_newbcast:8 row_mask:0xf bank_mask:0xf
    v_dot2c_f32_bf16_dpp v16, v44, v210 row_newbcast:8 row_mask:0xf bank_mask:0xf
    v_dot2c_f32_bf16_dpp v17, v26, v210 row_newbcast:8 row_mask:0xf bank_mask:0xf
    v_dot2c_f32_bf16_dpp v18, v44, v211 row_newbcast:8 row_mask:0xf bank_mask:0xf
    v_dot2c_f32_bf16_dpp v19, v26, v211 row_newbcast:8 row_mask:0xf bank_mask:0xf
    s_waitcnt vmcnt(6)
    v_dot2c_f32_bf16_dpp v12, v44, v212 row_newbcast:9 row_mask:0xf bank_mask:0xf
    v_dot2c_f32_bf16_dpp v13, v26, v212 row_newbcast:9 row_mask:0xf bank_mask:0xf
    v_dot2c_f32_bf16_dpp v14, v44, v213 row_newbcast:9 row_mask:0xf bank_mask:0xf
    v_dot2c_f32_bf16_dpp v15, v26, v213 row_newbcast:9 row_mask:0xf bank_mask:0xf
    v_dot2c_f32_bf16_dpp v16, v44, v214 row_newbcast:9 row_mask:0xf bank_mask:0xf
    v_dot2c_f32_bf16_dpp v17, v26, v214 row_newbcast:9 row_mask:0xf bank_mask:0xf
    v_dot2c_f32_bf16_dpp v18, v44, v215 row_newbcast:9 row_mask:0xf bank_mask:0xf
    v_dot2c_f32_bf16_dpp v19, v26, v215 row_newbcast:9 row_mask:0xf bank_mask:0xf
    s_waitcnt vmcnt(5)
    v_dot2c_f32_bf16_dpp v12, v44, v216 row_newbcast:10 row_mask:0xf bank_mask:0xf
    v_dot2c_f32_bf16_dpp v13, v26, v216 row_newbcast:10 row_mask:0xf bank_mask:0xf
    v_dot2c_f32_bf16_dpp v14, v44, v217 row_newbcast:10 row_mask:0xf bank_mask:0xf
    v_dot2c_f32_bf16_dpp v15, v26, v217 row_newbcast:10 row_mask:0xf bank_mask:0xf
    v_dot2c_f32_bf16_dpp v16, v44, v218 row_newbcast:10 row_mask:0xf bank_mask:0xf
    v_dot2c_f32_bf16_dpp v17, v26, v218 row_newbcast:10 row_mask:0xf bank_mask:0xf
    v_dot2c_f32_bf16_dpp v18, v44, v219 row_newbcast:10 row_mask:0xf bank_mask:0xf
    v_dot2c_f32_bf16_dpp v19, v26, v219 row_newbcast:10 row_mask:0xf bank_mask:0xf
    s_waitcnt vmcnt(4)
    v_dot2c_f32_bf16_dpp v12, v44, v220 row_newbcast:11 row_mask:0xf bank_mask:0xf
    v_dot2c_f32_bf16_dpp v13, v26, v220 row_newbcast:11 row_mask:0xf bank_mask:0xf
    v_dot2c_f32_bf16_dpp v14, v44, v221 row_newbcast:11 row_mask:0xf bank_mask:0xf
    v_dot2c_f32_bf16_dpp v15, v26, v221 row_newbcast:11 row_mask:0xf bank_mask:0xf
    v_dot2c_f32_bf16_dpp v16, v44, v222 row_newbcast:11 row_mask:0xf bank_mask:0xf
    v_dot2c_f32_bf16_dpp v17, v26, v222 row_newbcast:11 row_mask:0xf bank_mask:0xf
    v_dot2c_f32_bf16_dpp v18, v44, v223 row_newbcast:11 row_mask:0xf bank_mask:0xf
    v_dot2c_f32_bf16_dpp v19, v26, v223 row_newbcast:11 row_mask:0xf bank_mask:0xf
    s_waitcnt vmcnt(3)
    v_dot2c_f32_bf16_dpp v12, v44, v224 row_newbcast:12 row_mask:0xf bank_mask:0xf
    v_dot2c_f32_bf16_dpp v13, v26, v224 row_newbcast:12 row_mask:0xf bank_mask:0xf
    v_dot2c_f32_bf16_dpp v14, v44, v225 row_newbcast:12 row_mask:0xf bank_mask:0xf
    v_dot2c_f32_bf16_dpp v15, v26, v225 row_newbcast:12 row_mask:0xf bank_mask:0xf
    v_dot2c_f32_bf16_dpp v16, v44, v226 row_newbcast:12 row_mask:0xf bank_mask:0xf
    v_dot2c_f32_bf16_dpp v17, v26, v226 row_newbcast:12 row_mask:0xf bank_mask:0xf
    v_dot2c_f32_bf16_dpp v18, v44, v227 row_newbcast:12 row_mask:0xf bank_mask:0xf
    v_dot2c_f32_bf16_dpp v19, v26, v227 row_newbcast:12 row_mask:0xf bank_mask:0xf
    s_waitcnt vmcnt(2)
    v_dot2c_f32_bf16_dpp v12, v44, v228 row_newbcast:13 row_mask:0xf bank_mask:0xf
    v_dot2c_f32_bf16_dpp v13, v26, v228 row_newbcast:13 row_mask:0xf bank_mask:0xf
    v_dot2c_f32_bf16_dpp v14, v44, v229 row_newbcast:13 row_mask:0xf bank_mask:0xf
    v_dot2c_f32_bf16_dpp v15, v26, v229 row_newbcast:13 row_mask:0xf bank_mask:0xf
    v_dot2c_f32_bf16_dpp v16, v44, v230 row_newbcast:13 row_mask:0xf bank_mask:0xf
    v_dot2c_f32_bf16_dpp v17, v26, v230 row_newbcast:13 row_mask:0xf bank_mask:0xf
    v_dot2c_f32_bf16_dpp v18, v44, v231 row_newbcast:13 row_mask:0xf bank_mask:0xf
    v_dot2c_f32_bf16_dpp v19, v26, v231 row_newbcast:13 row_mask:0xf bank_mask:0xf
    s_waitcnt vmcnt(1)
    ds_read_b32 v32, v31 offset:672
    ds_read_b32 v33, v21 offset:640
    ds_read_b64 v[34:35], v3 offset:2048
    v_dot2c_f32_bf16_dpp v12, v44, v232 row_newbcast:14 row_mask:0xf bank_mask:0xf
    v_dot2c_f32_bf16_dpp v13, v26, v232 row_newbcast:14 row_mask:0xf bank_mask:0xf
    v_dot2c_f32_bf16_dpp v14, v44, v233 row_newbcast:14 row_mask:0xf bank_mask:0xf
    v_dot2c_f32_bf16_dpp v15, v26, v233 row_newbcast:14 row_mask:0xf bank_mask:0xf
    v_dot2c_f32_bf16_dpp v16, v44, v234 row_newbcast:14 row_mask:0xf bank_mask:0xf
    v_dot2c_f32_bf16_dpp v17, v26, v234 row_newbcast:14 row_mask:0xf bank_mask:0xf
    v_dot2c_f32_bf16_dpp v18, v44, v235 row_newbcast:14 row_mask:0xf bank_mask:0xf
    v_dot2c_f32_bf16_dpp v19, v26, v235 row_newbcast:14 row_mask:0xf bank_mask:0xf
    s_waitcnt vmcnt(0)
    v_dot2c_f32_bf16_dpp v12, v44, v236 row_newbcast:15 row_mask:0xf bank_mask:0xf
    v_dot2c_f32_bf16_dpp v13, v26, v236 row_newbcast:15 row_mask:0xf bank_mask:0xf
    v_dot2c_f32_bf16_dpp v14, v44, v237 row_newbcast:15 row_mask:0xf bank_mask:0xf
    v_dot2c_f32_bf16_dpp v15, v26, v237 row_newbcast:15 row_mask:0xf bank_mask:0xf
    v_dot2c_f32_bf16_dpp v16, v44, v238 row_newbcast:15 row_mask:0xf bank_mask:0xf
    v_dot2c_f32_bf16_dpp v17, v26, v238 row_newbcast:15 row_mask:0xf bank_mask:0xf
    v_dot2c_f32_bf16_dpp v18, v44, v239 row_newbcast:15 row_mask:0xf bank_mask:0xf
    v_dot2c_f32_bf16_dpp v19, v26, v239 row_newbcast:15 row_mask:0xf bank_mask:0xf
    s_waitcnt lgkmcnt(0)
    v_cmp_ne_u32 vcc, 0, v32
    v_permlane32_swap_b32 v12, v16
    v_permlane32_swap_b32 v13, v17
    v_permlane32_swap_b32 v14, v18
    v_permlane32_swap_b32 v15, v19
    v_add_f32 v12, v12, v16
    v_add_f32 v13, v13, v17
    v_add_f32 v14, v14, v18
    v_add_f32 v15, v15, v19
    s_nop 0
    v_permlane16_swap_b32 v12, v14
    v_permlane16_swap_b32 v13, v15
    v_add_f32 v12, v12, v14
    v_add_f32 v13, v13, v15
    s_cbranch_vccz L_ud
L_up:
    ds_read_b32 v32, v31 offset:672
    ds_read_b32 v33, v21 offset:640
    ds_read_b64 v[34:35], v3 offset:2048
    s_sub_u32 s8, s8, 1
    s_waitcnt lgkmcnt(0)
    s_cbranch_scc1 L_ud
    v_cmp_ne_u32 vcc, 0, v32
    s_nop 4
    s_cbranch_vccnz L_up
L_ud:
    v_fma_f32 v12, v12, v33, v34
    v_fma_f32 v13, v13, v33, v35
    v_cvt_pk_bf16_f32 v12, v12, v13
    ds_write_b32 v5, v12 offset:768
    s_cmp_eq_u32 s34, 0
    s_cbranch_scc1 L_cons
    s_waitcnt lgkmcnt(0)
    s_endpgm
L_cons:
    s_mov_b32 s8, 0x8000
    v_not_b32 v51, s62
    v_not_b32 v55, s62
    v_not_b32 v59, s62
    v_not_b32 v63, s62
    s_waitcnt lgkmcnt(0)
    s_barrier
L_cp:
    s_waitcnt vmcnt(0)
    v_cmp_ne_u32 s[10:11], s62, v51
    v_cmp_ne_u32 s[12:13], s62, v55
    v_cmp_ne_u32 s[14:15], s62, v59
    v_cmp_ne_u32 s[16:17], s62, v63
    s_or_b64 s[4:5], s[10:11], s[12:13]
    s_or_b64 s[6:7], s[14:15], s[16:17]
    s_or_b64 s[4:5], s[4:5], s[6:7]
    s_cbranch_scc0 L_cdone
    s_bcnt1_i32_b64 s4, s[10:11]
    s_bcnt1_i32_b64 s5, s[12:13]
    s_add_u32 s4, s4, s5
    s_bcnt1_i32_b64 s5, s[14:15]
    s_add_u32 s4, s4, s5
    s_bcnt1_i32_b64 s5, s[16:17]
    s_add_u32 s4, s4, s5
    s_cmp_le_u32 s4, 8
    s_cbranch_scc1 L_asl
    s_sleep 4
    s_cmp_le_u32 s4, 32
    s_cbranch_scc1 L_asl
    s_sleep 6
    s_cmp_le_u32 s4, 96
    s_cbranch_scc1 L_asl
    s_sleep 10
    s_cmp_le_u32 s4, 0xe0
    s_cbranch_scc1 L_asl
    s_sleep 16
L_asl:
    s_mov_b64 exec, s[10:11]
    s_cbranch_execz L_cs0
    buffer_load_dwordx4 v[48:51], v0, s[56:59], s20 offen sc1
L_cs0:
    s_mov_b64 exec, s[12:13]
    s_cbranch_execz L_cs1
    buffer_load_dwordx4 v[52:55], v0, s[56:59], s21 offen sc1
L_cs1:
    s_mov_b64 exec, s[14:15]
    s_cbranch_execz L_cs2
    buffer_load_dwordx4 v[56:59], v0, s[56:59], s22 offen sc1
L_cs2:
    s_mov_b64 exec, s[16:17]
    s_cbranch_execz L_cs3
    buffer_load_dwordx4 v[60:63], v0, s[56:59], s23 offen sc1
L_cs3:
    s_mov_b64 exec, -1
    s_sub_u32 s8, s8, 1
    s_cbranch_scc0 L_cp
    s_waitcnt vmcnt(0)
L_cdone:
    v_add_f32 v32, v48, v52
    v_add_f32 v33, v49, v53
    v_add_f32 v34, v50, v54
    v_add_f32 v40, v56, v60
    v_add_f32 v41, v57, v61
    v_add_f32 v42, v58, v62
    v_add_f32 v32, v32, v40
    v_add_f32 v33, v33, v41
    v_add_f32 v34, v34, v42
    v_mov_b32 v35, v34
    v_permlane32_swap_b32 v32, v33
    s_nop 0
    v_permlane32_swap_b32 v34, v35
    v_add_f32 v32, v32, v33
    v_add_f32 v34, v34, v35
    s_nop 1
    v_permlane16_swap_b32 v32, v34
    v_add_f32 v32, v32, v34
    s_nop 1
    v_add_f32_dpp v32, v32, v32 row_ror:2 row_mask:0xf bank_mask:0xf
    s_nop 1
    v_add_f32_dpp v32, v32, v32 row_ror:4 row_mask:0xf bank_mask:0xf
    s_nop 1
    v_add_f32_dpp v32, v32, v32 row_ror:8 row_mask:0xf bank_mask:0xf
    v_cvt_pk_bf16_f32 v32, v32, v32
    s_mov_b32 exec_lo, s9
    s_mov_b32 exec_hi, 3
    buffer_store_short v32, v6, s[44:47], 0 offen
    s_cmp_lg_u32 s2, 0
    s_cbranch_scc1 L_cend
    s_mov_b64 exec, 1
    v_mov_b32 v36, s62
    buffer_store_dword v36, v1, s[56:59], 0 offen sc1
L_cend:
    s_endpgm
L_help:
    s_nop 4
    s_sub_u32 s64, s34, 4
    v_lshrrev_b32 v1, 4, v7
    v_and_b32 v2, 15, v7
    v_lshlrev_b32 v4, 4, v2
    v_lshl_add_u32 v3, v1, 13, v4
    v_lshl_add_u32 v11, v2, 2, v1
    v_lshlrev_b32 v11, 1, v11
    s_and_b32 s75, s61, 3
    s_lshl_b32 s63, s75, 1
    s_add_u32 s63, s63, s64
    s_mul_i32 s65, s63, 655360
    s_lshl_b32 s3, s60, 8
    s_add_u32 s65, s65, s3
    s_mul_i32 s100, s63, 160
    s_mov_b32 s54, 1280
    s_mov_b32 s55, 0x20000
    s_mov_b32 s46, 5242880
    s_mov_b32 s47, 0x20000
    s_cmp_eq_u32 s35, 0
    s_waitcnt lgkmcnt(0)
    s_cselect_b64 s[44:45], s[14:15], s[24:25]
    s_cselect_b64 s[52:53], s[8:9], s[18:19]
    s_cselect_b64 s[48:49], s[16:17], s[26:27]
    s_cmp_ge_u32 s64, 2
    s_cbranch_scc1 L_hq_skip
    buffer_load_dwordx4 v[92:95], v3, s[44:47], s65 offen nt
    s_add_u32 s65, s65, 32768
    buffer_load_ushort v8, v11, s[52:55], s100 offen offset:0
    buffer_load_ushort v9, v11, s[52:55], s100 offen offset:128
    buffer_load_dwordx4 v[96:99], v3, s[44:47], s65 offen nt
    s_add_u32 s65, s65, 32768
    buffer_load_dwordx4 v[100:103], v3, s[44:47], s65 offen nt
    s_add_u32 s65, s65, 32768
    buffer_load_dwordx4 v[104:107], v3, s[44:47], s65 offen nt
    s_add_u32 s65, s65, 32768
    buffer_load_dwordx4 v[108:111], v3, s[44:47], s65 offen nt
    s_add_u32 s65, s65, 32768
    buffer_load_dwordx4 v[112:115], v3, s[44:47], s65 offen nt
    s_add_u32 s65, s65, 32768
    buffer_load_dwordx4 v[116:119], v3, s[44:47], s65 offen nt
    s_add_u32 s65, s65, 32768
    buffer_load_dwordx4 v[120:123], v3, s[44:47], s65 offen nt
    s_add_u32 s65, s65, 32768
    buffer_load_dwordx4 v[124:127], v3, s[44:47], s65 offen nt
    s_add_u32 s65, s65, 32768
    buffer_load_dwordx4 v[128:131], v3, s[44:47], s65 offen nt
    s_add_u32 s65, s65, 32768
    buffer_load_dwordx4 v[132:135], v3, s[44:47], s65 offen nt
    s_add_u32 s65, s65, 32768
    buffer_load_dwordx4 v[136:139], v3, s[44:47], s65 offen nt
    s_add_u32 s65, s65, 32768
    buffer_load_dwordx4 v[140:143], v3, s[44:47], s65 offen nt
    s_add_u32 s65, s65, 32768
    buffer_load_dwordx4 v[144:147], v3, s[44:47], s65 offen nt
    s_add_u32 s65, s65, 32768
    buffer_load_dwordx4 v[148:151], v3, s[44:47], s65 offen nt
    s_add_u32 s65, s65, 32768
    buffer_load_dwordx4 v[152:155], v3, s[44:47], s65 offen nt
    s_add_u32 s65, s65, 32768
    buffer_load_dwordx4 v[156:159], v3, s[44:47], s65 offen nt
    s_add_u32 s65, s65, 32768
    buffer_load_dwordx4 v[160:163], v3, s[44:47], s65 offen nt
    s_add_u32 s65, s65, 32768
    buffer_load_dwordx4 v[164:167], v3, s[44:47], s65 offen nt
    s_add_u32 s65, s65, 32768
    buffer_load_dwordx4 v[168:171], v3, s[44:47], s65 offen nt
    s_mov_b32 s56, s32
    s_mov_b32 s57, s33
    s_mov_b32 s58, 3670016
    s_mov_b32 s59, 0x20000
    s_load_dword s62, s[32:33], 0
    s_mov_b32 s50, 5242880
    s_mov_b32 s51, 0x20000
    s_mov_b32 s80, 0x3fb8aa3b
    s_mov_b32 s67, 0x05040100
    s_mov_b32 s68, 0x07060302
    v_lshlrev_b32 v6, 4, v7
    v_mul_u32_u24 v5, 10240, v1
    v_add_u32 v4, v4, v5
    v_lshl_add_u32 v5, v2, 2, v5
    v_add_u32 v5, 256, v5
    s_mul_i32 s66, s60, 163840
    s_mul_i32 s3, s64, 320
    s_add_u32 s66, s66, s3
    s_lshl_b32 s82, s35, 7
    s_add_u32 s82, s82, s61
    s_mul_i32 s82, s82, 4224
    s_lshl_b32 s3, s64, 10
    s_add_u32 s82, s82, s3
    s_add_u32 s82, s82, 0x200000
    s_waitcnt lgkmcnt(0)
    s_add_u32 s62, s62, 0x9e3779b9
    s_xor_b32 s63, s35, s64
    s_lshl_b32 s3, s63, 5
    s_add_u32 s3, s3, s60
    s_lshl_b32 s69, s3, 12
    s_add_u32 s69, s69, 0x8000
    s_lshl_b32 s101, s75, 10
    s_add_u32 s101, s101, s69
    s_lshl_b32 s63, s63, 8
    v_lshl_add_u32 v24, v11, 1, s63
    s_lshl_b32 s74, s64, 2
    s_or_b32 s74, s74, s75
    s_mov_b32 s71, 0x8000
    v_mov_b32 v16, 0
    v_mov_b32 v17, 0
    v_mov_b32 v18, 0
    v_mov_b32 v19, 0
    v_mov_b32 v20, 0
    v_mov_b32 v21, 0
    v_mov_b32 v22, 0
    v_mov_b32 v23, 0
    s_waitcnt vmcnt(19)
    v_lshlrev_b32 v11, 16, v8
    v_lshlrev_b32 v12, 16, v9
    v_dot2c_f32_bf16_dpp v16, v8, v92 row_newbcast:0 row_mask:0xf bank_mask:0xf
    v_dot2c_f32_bf16_dpp v17, v11, v92 row_newbcast:0 row_mask:0xf bank_mask:0xf
    v_dot2c_f32_bf16_dpp v18, v8, v93 row_newbcast:0 row_mask:0xf bank_mask:0xf
    v_dot2c_f32_bf16_dpp v19, v11, v93 row_newbcast:0 row_mask:0xf bank_mask:0xf
    v_dot2c_f32_bf16_dpp v20, v8, v94 row_newbcast:0 row_mask:0xf bank_mask:0xf
    v_dot2c_f32_bf16_dpp v21, v11, v94 row_newbcast:0 row_mask:0xf bank_mask:0xf
    v_dot2c_f32_bf16_dpp v22, v8, v95 row_newbcast:0 row_mask:0xf bank_mask:0xf
    v_dot2c_f32_bf16_dpp v23, v11, v95 row_newbcast:0 row_mask:0xf bank_mask:0xf
    s_waitcnt vmcnt(18)
    v_dot2c_f32_bf16_dpp v16, v8, v96 row_newbcast:1 row_mask:0xf bank_mask:0xf
    v_dot2c_f32_bf16_dpp v17, v11, v96 row_newbcast:1 row_mask:0xf bank_mask:0xf
    v_dot2c_f32_bf16_dpp v18, v8, v97 row_newbcast:1 row_mask:0xf bank_mask:0xf
    v_dot2c_f32_bf16_dpp v19, v11, v97 row_newbcast:1 row_mask:0xf bank_mask:0xf
    v_dot2c_f32_bf16_dpp v20, v8, v98 row_newbcast:1 row_mask:0xf bank_mask:0xf
    v_dot2c_f32_bf16_dpp v21, v11, v98 row_newbcast:1 row_mask:0xf bank_mask:0xf
    v_dot2c_f32_bf16_dpp v22, v8, v99 row_newbcast:1 row_mask:0xf bank_mask:0xf
    v_dot2c_f32_bf16_dpp v23, v11, v99 row_newbcast:1 row_mask:0xf bank_mask:0xf
    s_waitcnt vmcnt(17)
    v_dot2c_f32_bf16_dpp v16, v8, v100 row_newbcast:2 row_mask:0xf bank_mask:0xf
    v_dot2c_f32_bf16_dpp v17, v11, v100 row_newbcast:2 row_mask:0xf bank_mask:0xf
    v_dot2c_f32_bf16_dpp v18, v8, v101 row_newbcast:2 row_mask:0xf bank_mask:0xf
    v_dot2c_f32_bf16_dpp v19, v11, v101 row_newbcast:2 row_mask:0xf bank_mask:0xf
    v_dot2c_f32_bf16_dpp v20, v8, v102 row_newbcast:2 row_mask:0xf bank_mask:0xf
    v_dot2c_f32_bf16_dpp v21, v11, v102 row_newbcast:2 row_mask:0xf bank_mask:0xf
    v_dot2c_f32_bf16_dpp v22, v8, v103 row_newbcast:2 row_mask:0xf bank_mask:0xf
    v_dot2c_f32_bf16_dpp v23, v11, v103 row_newbcast:2 row_mask:0xf bank_mask:0xf
    s_waitcnt vmcnt(16)
    v_dot2c_f32_bf16_dpp v16, v8, v104 row_newbcast:3 row_mask:0xf bank_mask:0xf
    v_dot2c_f32_bf16_dpp v17, v11, v104 row_newbcast:3 row_mask:0xf bank_mask:0xf
    v_dot2c_f32_bf16_dpp v18, v8, v105 row_newbcast:3 row_mask:0xf bank_mask:0xf
    v_dot2c_f32_bf16_dpp v19, v11, v105 row_newbcast:3 row_mask:0xf bank_mask:0xf
    v_dot2c_f32_bf16_dpp v20, v8, v106 row_newbcast:3 row_mask:0xf bank_mask:0xf
    v_dot2c_f32_bf16_dpp v21, v11, v106 row_newbcast:3 row_mask:0xf bank_mask:0xf
    v_dot2c_f32_bf16_dpp v22, v8, v107 row_newbcast:3 row_mask:0xf bank_mask:0xf
    v_dot2c_f32_bf16_dpp v23, v11, v107 row_newbcast:3 row_mask:0xf bank_mask:0xf
    s_waitcnt vmcnt(15)
    v_dot2c_f32_bf16_dpp v16, v8, v108 row_newbcast:4 row_mask:0xf bank_mask:0xf
    v_dot2c_f32_bf16_dpp v17, v11, v108 row_newbcast:4 row_mask:0xf bank_mask:0xf
    v_dot2c_f32_bf16_dpp v18, v8, v109 row_newbcast:4 row_mask:0xf bank_mask:0xf
    v_dot2c_f32_bf16_dpp v19, v11, v109 row_newbcast:4 row_mask:0xf bank_mask:0xf
    v_dot2c_f32_bf16_dpp v20, v8, v110 row_newbcast:4 row_mask:0xf bank_mask:0xf
    v_dot2c_f32_bf16_dpp v21, v11, v110 row_newbcast:4 row_mask:0xf bank_mask:0xf
    v_dot2c_f32_bf16_dpp v22, v8, v111 row_newbcast:4 row_mask:0xf bank_mask:0xf
    v_dot2c_f32_bf16_dpp v23, v11, v111 row_newbcast:4 row_mask:0xf bank_mask:0xf
    s_waitcnt vmcnt(14)
    v_dot2c_f32_bf16_dpp v16, v8, v112 row_newbcast:5 row_mask:0xf bank_mask:0xf
    v_dot2c_f32_bf16_dpp v17, v11, v112 row_newbcast:5 row_mask:0xf bank_mask:0xf
    v_dot2c_f32_bf16_dpp v18, v8, v113 row_newbcast:5 row_mask:0xf bank_mask:0xf
    v_dot2c_f32_bf16_dpp v19, v11, v113 row_newbcast:5 row_mask:0xf bank_mask:0xf
    v_dot2c_f32_bf16_dpp v20, v8, v114 row_newbcast:5 row_mask:0xf bank_mask:0xf
    v_dot2c_f32_bf16_dpp v21, v11, v114 row_newbcast:5 row_mask:0xf bank_mask:0xf
    v_dot2c_f32_bf16_dpp v22, v8, v115 row_newbcast:5 row_mask:0xf bank_mask:0xf
    v_dot2c_f32_bf16_dpp v23, v11, v115 row_newbcast:5 row_mask:0xf bank_mask:0xf
    s_waitcnt vmcnt(13)
    v_dot2c_f32_bf16_dpp v16, v8, v116 row_newbcast:6 row_mask:0xf bank_mask:0xf
    v_dot2c_f32_bf16_dpp v17, v11, v116 row_newbcast:6 row_mask:0xf bank_mask:0xf
    v_dot2c_f32_bf16_dpp v18, v8, v117 row_newbcast:6 row_mask:0xf bank_mask:0xf
    v_dot2c_f32_bf16_dpp v19, v11, v117 row_newbcast:6 row_mask:0xf bank_mask:0xf
    v_dot2c_f32_bf16_dpp v20, v8, v118 row_newbcast:6 row_mask:0xf bank_mask:0xf
    v_dot2c_f32_bf16_dpp v21, v11, v118 row_newbcast:6 row_mask:0xf bank_mask:0xf
    v_dot2c_f32_bf16_dpp v22, v8, v119 row_newbcast:6 row_mask:0xf bank_mask:0xf
    v_dot2c_f32_bf16_dpp v23, v11, v119 row_newbcast:6 row_mask:0xf bank_mask:0xf
    s_waitcnt vmcnt(12)
    v_dot2c_f32_bf16_dpp v16, v8, v120 row_newbcast:7 row_mask:0xf bank_mask:0xf
    v_dot2c_f32_bf16_dpp v17, v11, v120 row_newbcast:7 row_mask:0xf bank_mask:0xf
    v_dot2c_f32_bf16_dpp v18, v8, v121 row_newbcast:7 row_mask:0xf bank_mask:0xf
    v_dot2c_f32_bf16_dpp v19, v11, v121 row_newbcast:7 row_mask:0xf bank_mask:0xf
    v_dot2c_f32_bf16_dpp v20, v8, v122 row_newbcast:7 row_mask:0xf bank_mask:0xf
    v_dot2c_f32_bf16_dpp v21, v11, v122 row_newbcast:7 row_mask:0xf bank_mask:0xf
    v_dot2c_f32_bf16_dpp v22, v8, v123 row_newbcast:7 row_mask:0xf bank_mask:0xf
    v_dot2c_f32_bf16_dpp v23, v11, v123 row_newbcast:7 row_mask:0xf bank_mask:0xf
    s_waitcnt vmcnt(11)
    v_dot2c_f32_bf16_dpp v16, v8, v124 row_newbcast:8 row_mask:0xf bank_mask:0xf
    v_dot2c_f32_bf16_dpp v17, v11, v124 row_newbcast:8 row_mask:0xf bank_mask:0xf
    v_dot2c_f32_bf16_dpp v18, v8, v125 row_newbcast:8 row_mask:0xf bank_mask:0xf
    v_dot2c_f32_bf16_dpp v19, v11, v125 row_newbcast:8 row_mask:0xf bank_mask:0xf
    v_dot2c_f32_bf16_dpp v20, v8, v126 row_newbcast:8 row_mask:0xf bank_mask:0xf
    v_dot2c_f32_bf16_dpp v21, v11, v126 row_newbcast:8 row_mask:0xf bank_mask:0xf
    v_dot2c_f32_bf16_dpp v22, v8, v127 row_newbcast:8 row_mask:0xf bank_mask:0xf
    v_dot2c_f32_bf16_dpp v23, v11, v127 row_newbcast:8 row_mask:0xf bank_mask:0xf
    s_waitcnt vmcnt(10)
    v_dot2c_f32_bf16_dpp v16, v8, v128 row_newbcast:9 row_mask:0xf bank_mask:0xf
    v_dot2c_f32_bf16_dpp v17, v11, v128 row_newbcast:9 row_mask:0xf bank_mask:0xf
    v_dot2c_f32_bf16_dpp v18, v8, v129 row_newbcast:9 row_mask:0xf bank_mask:0xf
    v_dot2c_f32_bf16_dpp v19, v11, v129 row_newbcast:9 row_mask:0xf bank_mask:0xf
    v_dot2c_f32_bf16_dpp v20, v8, v130 row_newbcast:9 row_mask:0xf bank_mask:0xf
    v_dot2c_f32_bf16_dpp v21, v11, v130 row_newbcast:9 row_mask:0xf bank_mask:0xf
    v_dot2c_f32_bf16_dpp v22, v8, v131 row_newbcast:9 row_mask:0xf bank_mask:0xf
    v_dot2c_f32_bf16_dpp v23, v11, v131 row_newbcast:9 row_mask:0xf bank_mask:0xf
    s_waitcnt vmcnt(9)
    v_dot2c_f32_bf16_dpp v16, v8, v132 row_newbcast:10 row_mask:0xf bank_mask:0xf
    v_dot2c_f32_bf16_dpp v17, v11, v132 row_newbcast:10 row_mask:0xf bank_mask:0xf
    v_dot2c_f32_bf16_dpp v18, v8, v133 row_newbcast:10 row_mask:0xf bank_mask:0xf
    v_dot2c_f32_bf16_dpp v19, v11, v133 row_newbcast:10 row_mask:0xf bank_mask:0xf
    v_dot2c_f32_bf16_dpp v20, v8, v134 row_newbcast:10 row_mask:0xf bank_mask:0xf
    v_dot2c_f32_bf16_dpp v21, v11, v134 row_newbcast:10 row_mask:0xf bank_mask:0xf
    v_dot2c_f32_bf16_dpp v22, v8, v135 row_newbcast:10 row_mask:0xf bank_mask:0xf
    v_dot2c_f32_bf16_dpp v23, v11, v135 row_newbcast:10 row_mask:0xf bank_mask:0xf
    s_waitcnt vmcnt(8)
    v_dot2c_f32_bf16_dpp v16, v8, v136 row_newbcast:11 row_mask:0xf bank_mask:0xf
    v_dot2c_f32_bf16_dpp v17, v11, v136 row_newbcast:11 row_mask:0xf bank_mask:0xf
    v_dot2c_f32_bf16_dpp v18, v8, v137 row_newbcast:11 row_mask:0xf bank_mask:0xf
    v_dot2c_f32_bf16_dpp v19, v11, v137 row_newbcast:11 row_mask:0xf bank_mask:0xf
    v_dot2c_f32_bf16_dpp v20, v8, v138 row_newbcast:11 row_mask:0xf bank_mask:0xf
    v_dot2c_f32_bf16_dpp v21, v11, v138 row_newbcast:11 row_mask:0xf bank_mask:0xf
    v_dot2c_f32_bf16_dpp v22, v8, v139 row_newbcast:11 row_mask:0xf bank_mask:0xf
    v_dot2c_f32_bf16_dpp v23, v11, v139 row_newbcast:11 row_mask:0xf bank_mask:0xf
    s_waitcnt vmcnt(7)
    v_dot2c_f32_bf16_dpp v16, v8, v140 row_newbcast:12 row_mask:0xf bank_mask:0xf
    v_dot2c_f32_bf16_dpp v17, v11, v140 row_newbcast:12 row_mask:0xf bank_mask:0xf
    v_dot2c_f32_bf16_dpp v18, v8, v141 row_newbcast:12 row_mask:0xf bank_mask:0xf
    v_dot2c_f32_bf16_dpp v19, v11, v141 row_newbcast:12 row_mask:0xf bank_mask:0xf
    v_dot2c_f32_bf16_dpp v20, v8, v142 row_newbcast:12 row_mask:0xf bank_mask:0xf
    v_dot2c_f32_bf16_dpp v21, v11, v142 row_newbcast:12 row_mask:0xf bank_mask:0xf
    v_dot2c_f32_bf16_dpp v22, v8, v143 row_newbcast:12 row_mask:0xf bank_mask:0xf
    v_dot2c_f32_bf16_dpp v23, v11, v143 row_newbcast:12 row_mask:0xf bank_mask:0xf
    s_waitcnt vmcnt(6)
    v_dot2c_f32_bf16_dpp v16, v8, v144 row_newbcast:13 row_mask:0xf bank_mask:0xf
    v_dot2c_f32_bf16_dpp v17, v11, v144 row_newbcast:13 row_mask:0xf bank_mask:0xf
    v_dot2c_f32_bf16_dpp v18, v8, v145 row_newbcast:13 row_mask:0xf bank_mask:0xf
    v_dot2c_f32_bf16_dpp v19, v11, v145 row_newbcast:13 row_mask:0xf bank_mask:0xf
    v_dot2c_f32_bf16_dpp v20, v8, v146 row_newbcast:13 row_mask:0xf bank_mask:0xf
    v_dot2c_f32_bf16_dpp v21, v11, v146 row_newbcast:13 row_mask:0xf bank_mask:0xf
    v_dot2c_f32_bf16_dpp v22, v8, v147 row_newbcast:13 row_mask:0xf bank_mask:0xf
    v_dot2c_f32_bf16_dpp v23, v11, v147 row_newbcast:13 row_mask:0xf bank_mask:0xf
    s_waitcnt vmcnt(5)
    v_dot2c_f32_bf16_dpp v16, v8, v148 row_newbcast:14 row_mask:0xf bank_mask:0xf
    v_dot2c_f32_bf16_dpp v17, v11, v148 row_newbcast:14 row_mask:0xf bank_mask:0xf
    v_dot2c_f32_bf16_dpp v18, v8, v149 row_newbcast:14 row_mask:0xf bank_mask:0xf
    v_dot2c_f32_bf16_dpp v19, v11, v149 row_newbcast:14 row_mask:0xf bank_mask:0xf
    v_dot2c_f32_bf16_dpp v20, v8, v150 row_newbcast:14 row_mask:0xf bank_mask:0xf
    v_dot2c_f32_bf16_dpp v21, v11, v150 row_newbcast:14 row_mask:0xf bank_mask:0xf
    v_dot2c_f32_bf16_dpp v22, v8, v151 row_newbcast:14 row_mask:0xf bank_mask:0xf
    v_dot2c_f32_bf16_dpp v23, v11, v151 row_newbcast:14 row_mask:0xf bank_mask:0xf
    s_waitcnt vmcnt(4)
    v_dot2c_f32_bf16_dpp v16, v8, v152 row_newbcast:15 row_mask:0xf bank_mask:0xf
    v_dot2c_f32_bf16_dpp v17, v11, v152 row_newbcast:15 row_mask:0xf bank_mask:0xf
    v_dot2c_f32_bf16_dpp v18, v8, v153 row_newbcast:15 row_mask:0xf bank_mask:0xf
    v_dot2c_f32_bf16_dpp v19, v11, v153 row_newbcast:15 row_mask:0xf bank_mask:0xf
    v_dot2c_f32_bf16_dpp v20, v8, v154 row_newbcast:15 row_mask:0xf bank_mask:0xf
    v_dot2c_f32_bf16_dpp v21, v11, v154 row_newbcast:15 row_mask:0xf bank_mask:0xf
    v_dot2c_f32_bf16_dpp v22, v8, v155 row_newbcast:15 row_mask:0xf bank_mask:0xf
    v_dot2c_f32_bf16_dpp v23, v11, v155 row_newbcast:15 row_mask:0xf bank_mask:0xf
    s_waitcnt vmcnt(3)
    v_dot2c_f32_bf16_dpp v16, v9, v156 row_newbcast:0 row_mask:0xf bank_mask:0xf
    v_dot2c_f32_bf16_dpp v17, v12, v156 row_newbcast:0 row_mask:0xf bank_mask:0xf
    v_dot2c_f32_bf16_dpp v18, v9, v157 row_newbcast:0 row_mask:0xf bank_mask:0xf
    v_dot2c_f32_bf16_dpp v19, v12, v157 row_newbcast:0 row_mask:0xf bank_mask:0xf
    v_dot2c_f32_bf16_dpp v20, v9, v158 row_newbcast:0 row_mask:0xf bank_mask:0xf
    v_dot2c_f32_bf16_dpp v21, v12, v158 row_newbcast:0 row_mask:0xf bank_mask:0xf
    v_dot2c_f32_bf16_dpp v22, v9, v159 row_newbcast:0 row_mask:0xf bank_mask:0xf
    v_dot2c_f32_bf16_dpp v23, v12, v159 row_newbcast:0 row_mask:0xf bank_mask:0xf
    s_waitcnt vmcnt(2)
    v_dot2c_f32_bf16_dpp v16, v9, v160 row_newbcast:1 row_mask:0xf bank_mask:0xf
    v_dot2c_f32_bf16_dpp v17, v12, v160 row_newbcast:1 row_mask:0xf bank_mask:0xf
    v_dot2c_f32_bf16_dpp v18, v9, v161 row_newbcast:1 row_mask:0xf bank_mask:0xf
    v_dot2c_f32_bf16_dpp v19, v12, v161 row_newbcast:1 row_mask:0xf bank_mask:0xf
    v_dot2c_f32_bf16_dpp v20, v9, v162 row_newbcast:1 row_mask:0xf bank_mask:0xf
    v_dot2c_f32_bf16_dpp v21, v12, v162 row_newbcast:1 row_mask:0xf bank_mask:0xf
    v_dot2c_f32_bf16_dpp v22, v9, v163 row_newbcast:1 row_mask:0xf bank_mask:0xf
    v_dot2c_f32_bf16_dpp v23, v12, v163 row_newbcast:1 row_mask:0xf bank_mask:0xf
    s_waitcnt vmcnt(1)
    v_dot2c_f32_bf16_dpp v16, v9, v164 row_newbcast:2 row_mask:0xf bank_mask:0xf
    v_dot2c_f32_bf16_dpp v17, v12, v164 row_newbcast:2 row_mask:0xf bank_mask:0xf
    v_dot2c_f32_bf16_dpp v18, v9, v165 row_newbcast:2 row_mask:0xf bank_mask:0xf
    v_dot2c_f32_bf16_dpp v19, v12, v165 row_newbcast:2 row_mask:0xf bank_mask:0xf
    v_dot2c_f32_bf16_dpp v20, v9, v166 row_newbcast:2 row_mask:0xf bank_mask:0xf
    v_dot2c_f32_bf16_dpp v21, v12, v166 row_newbcast:2 row_mask:0xf bank_mask:0xf
    v_dot2c_f32_bf16_dpp v22, v9, v167 row_newbcast:2 row_mask:0xf bank_mask:0xf
    v_dot2c_f32_bf16_dpp v23, v12, v167 row_newbcast:2 row_mask:0xf bank_mask:0xf
    s_waitcnt vmcnt(0)
    v_dot2c_f32_bf16_dpp v16, v9, v168 row_newbcast:3 row_mask:0xf bank_mask:0xf
    v_dot2c_f32_bf16_dpp v17, v12, v168 row_newbcast:3 row_mask:0xf bank_mask:0xf
    v_dot2c_f32_bf16_dpp v18, v9, v169 row_newbcast:3 row_mask:0xf bank_mask:0xf
    v_dot2c_f32_bf16_dpp v19, v12, v169 row_newbcast:3 row_mask:0xf bank_mask:0xf
    v_dot2c_f32_bf16_dpp v20, v9, v170 row_newbcast:3 row_mask:0xf bank_mask:0xf
    v_dot2c_f32_bf16_dpp v21, v12, v170 row_newbcast:3 row_mask:0xf bank_mask:0xf
    v_dot2c_f32_bf16_dpp v22, v9, v171 row_newbcast:3 row_mask:0xf bank_mask:0xf
    v_dot2c_f32_bf16_dpp v23, v12, v171 row_newbcast:3 row_mask:0xf bank_mask:0xf
    v_permlane32_swap_b32 v16, v20
    v_permlane32_swap_b32 v17, v21
    v_permlane32_swap_b32 v18, v22
    v_permlane32_swap_b32 v19, v23
    v_add_f32 v16, v16, v20
    v_add_f32 v17, v17, v21
    v_add_f32 v18, v18, v22
    v_add_f32 v19, v19, v23
    s_nop 0
    v_permlane16_swap_b32 v16, v18
    v_permlane16_swap_b32 v17, v19
    v_add_f32 v16, v16, v18
    v_add_f32 v17, v17, v19
    v_mov_b32 v19, s62
    s_cmp_eq_u32 s64, 0
    s_cbranch_scc1 L_qc
    ds_write_b128 v6, v[16:19] offset:768
    s_sleep 50
    s_branch L_qg
L_qc:
    s_mov_b32 s73, 0x40000
L_qcp:
    ds_read_b128 v[20:23], v6 offset:768
    s_sub_u32 s73, s73, 1
    s_waitcnt lgkmcnt(0)
    s_cbranch_scc1 L_qcd
    v_cmp_ne_u32 vcc, s62, v23
    s_nop 4
    s_cbranch_vccnz L_qcp
L_qcd:
    v_add_f32 v16, v16, v20
    v_add_f32 v17, v17, v21
    buffer_store_dwordx4 v[16:19], v6, s[56:59], s101 offen sc1
    v_mov_b32 v92, v16
    v_mov_b32 v93, v17
    v_mov_b32 v95, v19
    v_mov_b32 v96, v16
    v_mov_b32 v97, v17
    v_mov_b32 v99, v19
    v_mov_b32 v100, v16
    v_mov_b32 v101, v17
    v_mov_b32 v103, v19
    v_mov_b32 v104, v16
    v_mov_b32 v105, v17
    v_mov_b32 v107, v19
    s_waitcnt vmcnt(0)
    s_sleep 14
L_qg:
    s_cmp_eq_u32 s74, 0
    s_cbranch_scc1 L_qo0
    buffer_load_dwordx4 v[92:95], v6, s[56:59], s69 offen offset:0 sc1
L_qo0:
    s_cmp_eq_u32 s74, 1
    s_cbranch_scc1 L_qo1
    buffer_load_dwordx4 v[96:99], v6, s[56:59], s69 offen offset:1024 sc1
L_qo1:
    s_cmp_eq_u32 s74, 2
    s_cbranch_scc1 L_qo2
    buffer_load_dwordx4 v[100:103], v6, s[56:59], s69 offen offset:2048 sc1
L_qo2:
    s_cmp_eq_u32 s74, 3
    s_cbranch_scc1 L_qo3
    buffer_load_dwordx4 v[104:107], v6, s[56:59], s69 offen offset:3072 sc1
L_qo3:
L_qp:
    s_waitcnt vmcnt(0)
    v_cmp_ne_u32 s[8:9], s62, v95
    v_cmp_ne_u32 s[10:11], s62, v99
    v_cmp_ne_u32 s[12:13], s62, v103
    v_cmp_ne_u32 s[14:15], s62, v107
    s_or_b64 s[4:5], s[8:9], s[10:11]
    s_or_b64 s[4:5], s[4:5], s[12:13]
    s_or_b64 s[4:5], s[4:5], s[14:15]
    s_cbranch_scc0 L_qdone
    s_sleep 10
    s_mov_b64 exec, s[8:9]
    s_cbranch_execz L_qs0
    buffer_load_dwordx4 v[92:95], v6, s[56:59], s69 offen offset:0 sc1
L_qs0:
    s_mov_b64 exec, s[10:11]
    s_cbranch_execz L_qs1
    buffer_load_dwordx4 v[96:99], v6, s[56:59], s69 offen offset:1024 sc1
L_qs1:
    s_mov_b64 exec, s[12:13]
    s_cbranch_execz L_qs2
    buffer_load_dwordx4 v[100:103], v6, s[56:59], s69 offen offset:2048 sc1
L_qs2:
    s_mov_b64 exec, s[14:15]
    s_cbranch_execz L_qs3
    buffer_load_dwordx4 v[104:107], v6, s[56:59], s69 offen offset:3072 sc1
L_qs3:
    s_mov_b64 exec, -1
    s_sub_u32 s71, s71, 1
    s_cbranch_scc0 L_qp
    s_waitcnt vmcnt(0)
L_qdone:
    v_add_f32 v92, v92, v96
    v_add_f32 v93, v93, v97
    v_add_f32 v100, v100, v104
    v_add_f32 v101, v101, v105
    v_add_f32 v92, v92, v100
    v_add_f32 v93, v93, v101
    v_cvt_pk_bf16_f32 v92, v92, v93
    ds_write_b32 v24, v92 offset:0
    s_waitcnt lgkmcnt(0)
    s_branch L_hq_done
L_hq_skip:
    s_nop 4
    v_mov_b32 v8, -1
    v_lshlrev_b32 v9, 2, v7
    ds_write_b32 v9, v8 offset:512
    s_mov_b32 s56, s32
    s_mov_b32 s57, s33
    s_mov_b32 s58, 3670016
    s_mov_b32 s59, 0x20000
    s_load_dword s62, s[32:33], 0
    s_mov_b32 s50, 5242880
    s_mov_b32 s51, 0x20000
    s_mov_b32 s80, 0x3fb8aa3b
    s_mov_b32 s67, 0x05040100
    s_mov_b32 s68, 0x07060302
    v_lshlrev_b32 v6, 4, v7
    v_mul_u32_u24 v5, 10240, v1
    v_add_u32 v4, v4, v5
    v_lshl_add_u32 v5, v2, 2, v5
    v_add_u32 v5, 256, v5
    s_mul_i32 s66, s60, 163840
    s_mul_i32 s3, s64, 320
    s_add_u32 s66, s66, s3
    s_lshl_b32 s82, s35, 7
    s_add_u32 s82, s82, s61
    s_mul_i32 s82, s82, 4224
    s_lshl_b32 s3, s64, 10
    s_add_u32 s82, s82, s3
    s_add_u32 s82, s82, 0x200000
    s_waitcnt lgkmcnt(0)
    s_add_u32 s62, s62, 0x9e3779b9
L_hq_done:
    s_nop 4
    s_barrier
    buffer_load_dwordx4 v[56:59], v4, s[48:51], s66 offen offset:0
    buffer_load_dwordx4 v[60:63], v4, s[48:51], s66 offen offset:1280
    buffer_load_dword v64, v5, s[48:51], s66 offen offset:0
    buffer_load_dword v65, v5, s[48:51], s66 offen offset:1280
    s_add_u32 s66, s66, 2560
    s_waitcnt vmcnt(0)
    buffer_load_dwordx4 v[68:71], v4, s[48:51], s66 offen offset:0
    buffer_load_dwordx4 v[72:75], v4, s[48:51], s66 offen offset:1280
    buffer_load_dword v76, v5, s[48:51], s66 offen offset:0
    buffer_load_dword v77, v5, s[48:51], s66 offen offset:1280
    s_add_u32 s66, s66, 2560
    v_perm_b32 v92, v60, v56, s67
    v_perm_b32 v108, v60, v56, s68
    v_perm_b32 v124, v61, v57, s67
    v_perm_b32 v140, v61, v57, s68
    v_perm_b32 v156, v62, v58, s67
    v_perm_b32 v172, v62, v58, s68
    v_perm_b32 v188, v63, v59, s67
    v_perm_b32 v204, v63, v59, s68
    v_perm_b32 v220, v65, v64, s67
    v_perm_b32 v236, v65, v64, s68
    s_waitcnt vmcnt(0)
    buffer_load_dwordx4 v[80:83], v4, s[48:51], s66 offen offset:0
    buffer_load_dwordx4 v[84:87], v4, s[48:51], s66 offen offset:1280
    buffer_load_dword v88, v5, s[48:51], s66 offen offset:0
    buffer_load_dword v89, v5, s[48:51], s66 offen offset:1280
    s_add_u32 s66, s66, 2560
    v_perm_b32 v93, v72, v68, s67
    v_perm_b32 v109, v72, v68, s68
    v_perm_b32 v125, v73, v69, s67
    v_perm_b32 v141, v73, v69, s68
    v_perm_b32 v157, v74, v70, s67
    v_perm_b32 v173, v74, v70, s68
    v_perm_b32 v189, v75, v71, s67
    v_perm_b32 v205, v75, v71, s68
    v_perm_b32 v221, v77, v76, s67
    v_perm_b32 v237, v77, v76, s68
    s_waitcnt vmcnt(0)
    buffer_load_dwordx4 v[56:59], v4, s[48:51], s66 offen offset:0
    buffer_load_dwordx4 v[60:63], v4, s[48:51], s66 offen offset:1280
    buffer_load_dword v64, v5, s[48:51], s66 offen offset:0
    buffer_load_dword v65, v5, s[48:51], s66 offen offset:1280
    s_add_u32 s66, s66, 33280
    v_perm_b32 v94, v84, v80, s67
    v_perm_b32 v110, v84, v80, s68
    v_perm_b32 v126, v85, v81, s67
    v_perm_b32 v142, v85, v81, s68
    v_perm_b32 v158, v86, v82, s67
    v_perm_b32 v174, v86, v82, s68
    v_perm_b32 v190, v87, v83, s67
    v_perm_b32 v206, v87, v83, s68
    v_perm_b32 v222, v89, v88, s67
    v_perm_b32 v238, v89, v88, s68
    s_waitcnt vmcnt(0)
    buffer_load_dwordx4 v[68:71], v4, s[48:51], s66 offen offset:0
    buffer_load_dwordx4 v[72:75], v4, s[48:51], s66 offen offset:1280
    buffer_load_dword v76, v5, s[48:51], s66 offen offset:0
    buffer_load_dword v77, v5, s[48:51], s66 offen offset:1280
    s_add_u32 s66, s66, 2560
    v_perm_b32 v95, v60, v56, s67
    v_perm_b32 v111, v60, v56, s68
    v_perm_b32 v127, v61, v57, s67
    v_perm_b32 v143, v61, v57, s68
    v_perm_b32 v159, v62, v58, s67
    v_perm_b32 v175, v62, v58, s68
    v_perm_b32 v191, v63, v59, s67
    v_perm_b32 v207, v63, v59, s68
    v_perm_b32 v223, v65, v64, s67
    v_perm_b32 v239, v65, v64, s68
    s_waitcnt vmcnt(0)
    buffer_load_dwordx4 v[80:83], v4, s[48:51], s66 offen offset:0
    buffer_load_dwordx4 v[84:87], v4, s[48:51], s66 offen offset:1280
    buffer_load_dword v88, v5, s[48:51], s66 offen offset:0
    buffer_load_dword v89, v5, s[48:51], s66 offen offset:1280
    s_add_u32 s66, s66, 2560
    v_perm_b32 v96, v72, v68, s67
    v_perm_b32 v112, v72, v68, s68
    v_perm_b32 v128, v73, v69, s67
    v_perm_b32 v144, v73, v69, s68
    v_perm_b32 v160, v74, v70, s67
    v_perm_b32 v176, v74, v70, s68
    v_perm_b32 v192, v75, v71, s67
    v_perm_b32 v208, v75, v71, s68
    v_perm_b32 v224, v77, v76, s67
    v_perm_b32 v240, v77, v76, s68
    s_waitcnt vmcnt(0)
    buffer_load_dwordx4 v[56:59], v4, s[48:51], s66 offen offset:0
    buffer_load_dwordx4 v[60:63], v4, s[48:51], s66 offen offset:1280
    buffer_load_dword v64, v5, s[48:51], s66 offen offset:0
    buffer_load_dword v65, v5, s[48:51], s66 offen offset:1280
    s_add_u32 s66, s66, 2560
    v_perm_b32 v97, v84, v80, s67
    v_perm_b32 v113, v84, v80, s68
    v_perm_b32 v129, v85, v81, s67
    v_perm_b32 v145, v85, v81, s68
    v_perm_b32 v161, v86, v82, s67
    v_perm_b32 v177, v86, v82, s68
    v_perm_b32 v193, v87, v83, s67
    v_perm_b32 v209, v87, v83, s68
    v_perm_b32 v225, v89, v88, s67
    v_perm_b32 v241, v89, v88, s68
    s_waitcnt vmcnt(0)
    buffer_load_dwordx4 v[68:71], v4, s[48:51], s66 offen offset:0
    buffer_load_dwordx4 v[72:75], v4, s[48:51], s66 offen offset:1280
    buffer_load_dword v76, v5, s[48:51], s66 offen offset:0
    buffer_load_dword v77, v5, s[48:51], s66 offen offset:1280
    s_add_u32 s66, s66, 33280
    v_perm_b32 v98, v60, v56, s67
    v_perm_b32 v114, v60, v56, s68
    v_perm_b32 v130, v61, v57, s67
    v_perm_b32 v146, v61, v57, s68
    v_perm_b32 v162, v62, v58, s67
    v_perm_b32 v178, v62, v58, s68
    v_perm_b32 v194, v63, v59, s67
    v_perm_b32 v210, v63, v59, s68
    v_perm_b32 v226, v65, v64, s67
    v_perm_b32 v242, v65, v64, s68
    s_waitcnt vmcnt(0)
    buffer_load_dwordx4 v[80:83], v4, s[48:51], s66 offen offset:0
    buffer_load_dwordx4 v[84:87], v4, s[48:51], s66 offen offset:1280
    buffer_load_dword v88, v5, s[48:51], s66 offen offset:0
    buffer_load_dword v89, v5, s[48:51], s66 offen offset:1280
    s_add_u32 s66, s66, 2560
    v_perm_b32 v99, v72, v68, s67
    v_perm_b32 v115, v72, v68, s68
    v_perm_b32 v131, v73, v69, s67
    v_perm_b32 v147, v73, v69, s68
    v_perm_b32 v163, v74, v70, s67
    v_perm_b32 v179, v74, v70, s68
    v_perm_b32 v195, v75, v71, s67
    v_perm_b32 v211, v75, v71, s68
    v_perm_b32 v227, v77, v76, s67
    v_perm_b32 v243, v77, v76, s68
    s_waitcnt vmcnt(0)
    buffer_load_dwordx4 v[56:59], v4, s[48:51], s66 offen offset:0
    buffer_load_dwordx4 v[60:63], v4, s[48:51], s66 offen offset:1280
    buffer_load_dword v64, v5, s[48:51], s66 offen offset:0
    buffer_load_dword v65, v5, s[48:51], s66 offen offset:1280
    s_add_u32 s66, s66, 2560
    v_perm_b32 v100, v84, v80, s67
    v_perm_b32 v116, v84, v80, s68
    v_perm_b32 v132, v85, v81, s67
    v_perm_b32 v148, v85, v81, s68
    v_perm_b32 v164, v86, v82, s67
    v_perm_b32 v180, v86, v82, s68
    v_perm_b32 v196, v87, v83, s67
    v_perm_b32 v212, v87, v83, s68
    v_perm_b32 v228, v89, v88, s67
    v_perm_b32 v244, v89, v88, s68
    s_waitcnt vmcnt(0)
    buffer_load_dwordx4 v[68:71], v4, s[48:51], s66 offen offset:0
    buffer_load_dwordx4 v[72:75], v4, s[48:51], s66 offen offset:1280
    buffer_load_dword v76, v5, s[48:51], s66 offen offset:0
    buffer_load_dword v77, v5, s[48:51], s66 offen offset:1280
    s_add_u32 s66, s66, 2560
    v_perm_b32 v101, v60, v56, s67
    v_perm_b32 v117, v60, v56, s68
    v_perm_b32 v133, v61, v57, s67
    v_perm_b32 v149, v61, v57, s68
    v_perm_b32 v165, v62, v58, s67
    v_perm_b32 v181, v62, v58, s68
    v_perm_b32 v197, v63, v59, s67
    v_perm_b32 v213, v63, v59, s68
    v_perm_b32 v229, v65, v64, s67
    v_perm_b32 v245, v65, v64, s68
    s_waitcnt vmcnt(0)
    buffer_load_dwordx4 v[80:83], v4, s[48:51], s66 offen offset:0
    buffer_load_dwordx4 v[84:87], v4, s[48:51], s66 offen offset:1280
    buffer_load_dword v88, v5, s[48:51], s66 offen offset:0
    buffer_load_dword v89, v5, s[48:51], s66 offen offset:1280
    s_add_u32 s66, s66, 33280
    v_perm_b32 v102, v72, v68, s67
    v_perm_b32 v118, v72, v68, s68
    v_perm_b32 v134, v73, v69, s67
    v_perm_b32 v150, v73, v69, s68
    v_perm_b32 v166, v74, v70, s67
    v_perm_b32 v182, v74, v70, s68
    v_perm_b32 v198, v75, v71, s67
    v_perm_b32 v214, v75, v71, s68
    v_perm_b32 v230, v77, v76, s67
    v_perm_b32 v246, v77, v76, s68
    s_waitcnt vmcnt(0)
    buffer_load_dwordx4 v[56:59], v4, s[48:51], s66 offen offset:0
    buffer_load_dwordx4 v[60:63], v4, s[48:51], s66 offen offset:1280
    buffer_load_dword v64, v5, s[48:51], s66 offen offset:0
    buffer_load_dword v65, v5, s[48:51], s66 offen offset:1280
    s_add_u32 s66, s66, 2560
    v_perm_b32 v103, v84, v80, s67
    v_perm_b32 v119, v84, v80, s68
    v_perm_b32 v135, v85, v81, s67
    v_perm_b32 v151, v85, v81, s68
    v_perm_b32 v167, v86, v82, s67
    v_perm_b32 v183, v86, v82, s68
    v_perm_b32 v199, v87, v83, s67
    v_perm_b32 v215, v87, v83, s68
    v_perm_b32 v231, v89, v88, s67
    v_perm_b32 v247, v89, v88, s68
    s_waitcnt vmcnt(0)
    buffer_load_dwordx4 v[68:71], v4, s[48:51], s66 offen offset:0
    buffer_load_dwordx4 v[72:75], v4, s[48:51], s66 offen offset:1280
    buffer_load_dword v76, v5, s[48:51], s66 offen offset:0
    buffer_load_dword v77, v5, s[48:51], s66 offen offset:1280
    s_add_u32 s66, s66, 2560
    v_perm_b32 v104, v60, v56, s67
    v_perm_b32 v120, v60, v56, s68
    v_perm_b32 v136, v61, v57, s67
    v_perm_b32 v152, v61, v57, s68
    v_perm_b32 v168, v62, v58, s67
    v_perm_b32 v184, v62, v58, s68
    v_perm_b32 v200, v63, v59, s67
    v_perm_b32 v216, v63, v59, s68
    v_perm_b32 v232, v65, v64, s67
    v_perm_b32 v248, v65, v64, s68
    s_waitcnt vmcnt(0)
    buffer_load_dwordx4 v[80:83], v4, s[48:51], s66 offen offset:0
    buffer_load_dwordx4 v[84:87], v4, s[48:51], s66 offen offset:1280
    buffer_load_dword v88, v5, s[48:51], s66 offen offset:0
    buffer_load_dword v89, v5, s[48:51], s66 offen offset:1280
    s_add_u32 s66, s66, 2560
    v_perm_b32 v105, v72, v68, s67
    v_perm_b32 v121, v72, v68, s68
    v_perm_b32 v137, v73, v69, s67
    v_perm_b32 v153, v73, v69, s68
    v_perm_b32 v169, v74, v70, s67
    v_perm_b32 v185, v74, v70, s68
    v_perm_b32 v201, v75, v71, s67
    v_perm_b32 v217, v75, v71, s68
    v_perm_b32 v233, v77, v76, s67
    v_perm_b32 v249, v77, v76, s68
    s_waitcnt vmcnt(0)
    buffer_load_dwordx4 v[56:59], v4, s[48:51], s66 offen offset:0
    buffer_load_dwordx4 v[60:63], v4, s[48:51], s66 offen offset:1280
    buffer_load_dword v64, v5, s[48:51], s66 offen offset:0
    buffer_load_dword v65, v5, s[48:51], s66 offen offset:1280
    s_add_u32 s66, s66, 33280
    v_perm_b32 v106, v84, v80, s67
    v_perm_b32 v122, v84, v80, s68
    v_perm_b32 v138, v85, v81, s67
    v_perm_b32 v154, v85, v81, s68
    v_perm_b32 v170, v86, v82, s67
    v_perm_b32 v186, v86, v82, s68
    v_perm_b32 v202, v87, v83, s67
    v_perm_b32 v218, v87, v83, s68
    v_perm_b32 v234, v89, v88, s67
    v_perm_b32 v250, v89, v88, s68
    s_waitcnt vmcnt(0)
    v_perm_b32 v107, v60, v56, s67
    v_perm_b32 v123, v60, v56, s68
    v_perm_b32 v139, v61, v57, s67
    v_perm_b32 v155, v61, v57, s68
    v_perm_b32 v171, v62, v58, s67
    v_perm_b32 v187, v62, v58, s68
    v_perm_b32 v203, v63, v59, s67
    v_perm_b32 v219, v63, v59, s68
    v_perm_b32 v235, v65, v64, s67
    v_perm_b32 v251, v65, v64, s68
    v_mov_b32 v35, s62
    v_mov_b32 v8, 0
    v_and_b32 v14, 3, v2
    v_mul_u32_u24 v14, 320, v14
    v_lshl_add_u32 v14, v1, 5, v14
    v_bfe_u32 v13, v2, 2, 1
    v_lshl_add_u32 v14, v13, 4, v14
    v_sub_u32 v13, 0, v13
    v_and_b32 v13, 0xaaaaaaaa, v13
    v_or_b32 v13, 0x44444444, v13
    v_lshlrev_b32 v9, 2, v7
    v_lshlrev_b32 v10, 3, v7
    s_mov_b32 s72, 0
    s_branch L_hy2
L_hb2:
    s_nop 4
    s_mov_b32 s72, 1
    s_nop 7
    v_mov_b32 v40, 0
    v_mov_b32 v41, 0
    v_mov_b32 v42, 0
    v_mov_b32 v43, 0
    v_mov_b32 v44, 0
    v_mov_b32 v45, 0
    v_mov_b32 v46, 0
    v_mov_b32 v47, 0
    v_mov_b32 v48, 0
    v_mov_b32 v49, 0
    v_mov_b32 v50, 0
    v_mov_b32 v51, 0
    v_mov_b32 v52, 0
    v_mov_b32 v53, 0
    v_mov_b32 v54, 0
    v_mov_b32 v55, 0
    v_mov_b32 v80, 0
    v_mov_b32 v81, 0
    v_mov_b32 v82, 0
    v_mov_b32 v83, 0
    v_mov_b32 v84, 0
    v_mov_b32 v85, 0
    v_mov_b32 v86, 0
    v_mov_b32 v87, 0
    v_mov_b32 v88, 0
    v_mov_b32 v89, 0
    v_mov_b32 v90, 0
    v_mov_b32 v91, 0
    v_mov_b32 v24, 0
    v_mov_b32 v25, 0
    v_mov_b32 v26, 0
    v_mov_b32 v27, 0
    v_mov_b32 v28, 0
    v_mov_b32 v29, 0
    v_mov_b32 v30, 0
    v_mov_b32 v31, 0
    v_mov_b32 v36, 0
    v_mov_b32 v37, 0
    v_mov_b32 v38, 0
    v_mov_b32 v39, 0
    s_xor_b32 s74, s35, 1
    s_cmp_eq_u32 s64, 2
    s_cbranch_scc1 L_cmb
    s_cmp_lg_u32 s64, 1
    s_cbranch_scc1 L_hy
    s_mov_b32 s74, s35
    s_mov_b32 s73, 0x40000
    v_mov_b32 v63, s62
    v_mov_b32 v64, 0xff7fffff
    v_mov_b32 v65, 0
    s_lshl_b32 s3, s60, 8
    s_add_u32 s3, s3, 0x1000
    s_lshl_b32 s63, s35, 13
    s_add_u32 s70, s3, s63
    s_lshl_b32 s100, s75, 4
    s_add_u32 s63, s70, s100
    s_add_u32 s63, s63, 128
    v_mov_b32 v59, s63
    s_add_u32 s3, s3, s100
    s_lshl_b32 s100, s35, 6
    s_add_u32 s3, s3, s100
    v_writelane_b32 v59, s3, 4
    s_add_u32 s3, s3, 0x2000
    v_writelane_b32 v59, s3, 8
    s_mov_b32 s71, 0x8000
    s_mov_b64 exec, 0xfff
L_b2p:
    s_sleep 4
    ds_read_b64 v[56:57], v10 offset:512
    s_sub_u32 s73, s73, 1
    s_waitcnt lgkmcnt(0)
    s_cbranch_scc1 L_b2d
    v_cmp_eq_u32 vcc, -1, v57
    s_nop 4
    s_cbranch_vccnz L_b2p
L_b2d:
    s_memrealtime s[76:77]
    v_max_f32_dpp v60, v56, v56 quad_perm:[1,0,3,2] row_mask:0xf bank_mask:0xf
    s_nop 1
    v_max_f32_dpp v60, v60, v60 quad_perm:[2,3,0,1] row_mask:0xf bank_mask:0xf
    v_sub_f32 v58, v56, v60
    v_mul_f32 v58, s80, v58
    v_exp_f32 v58, v58
    s_nop 0
    v_mul_f32 v61, v58, v57
    s_nop 1
    v_add_f32_dpp v61, v61, v61 quad_perm:[1,0,3,2] row_mask:0xf bank_mask:0xf
    s_nop 1
    v_add_f32_dpp v61, v61, v61 quad_perm:[2,3,0,1] row_mask:0xf bank_mask:0xf
    s_waitcnt lgkmcnt(0)
    v_mov_b32 v62, s76
    s_mov_b64 exec, 0x111
    buffer_store_dwordx4 v[60:63], v59, s[56:59], 0 offen sc1
    s_mov_b64 exec, -1
    v_lshl_add_u32 v11, v1, 3, s60
    v_and_b32 v11, 31, v11
    v_lshlrev_b32 v11, 8, v11
    v_lshl_add_u32 v11, v2, 4, v11
    s_lshl_b32 s70, s35, 13
    s_add_u32 s70, s70, 0x1000
    s_mov_b32 exec_lo, 0x00ff0fff
    s_mov_b32 exec_hi, 0x00ff00ff
    s_waitcnt vmcnt(0)
    s_sleep 40
L_mp:
    s_sleep 20
    buffer_load_dwordx4 v[64:67], v11, s[56:59], s70 offen sc1
    s_sub_u32 s71, s71, 1
    s_waitcnt vmcnt(0)
    s_cbranch_scc1 L_mdone
    v_cmp_ne_u32 vcc, s62, v67
    s_nop 0
    s_and_b64 s[4:5], vcc, 0xfff
    s_mov_b64 exec, vcc
    s_cbranch_scc1 L_mp
L_mdone:
    s_mov_b64 exec, -1
    s_memrealtime s[78:79]
    v_mov_b32 v68, 0
    s_mov_b32 exec_lo, 0x00ff00ff
    s_mov_b32 exec_hi, 0x00ff00ff
    v_cmp_ne_u32 vcc, s62, v67
    s_waitcnt lgkmcnt(0)
    v_mov_b32 v68, s78
    v_cndmask_b32 v68, v66, v68, vcc
    s_add_u32 s78, s84, 2290
    v_subrev_u32 v68, s78, v68
    v_max_i32 v68, -1000, v68
    v_min_i32 v68, 1000, v68
    s_mov_b64 exec, -1
    s_nop 0
    v_add_u32_dpp v68, v68, v68 quad_perm:[1,0,3,2] row_mask:0xf bank_mask:0xf
    s_nop 1
    v_add_u32_dpp v68, v68, v68 quad_perm:[2,3,0,1] row_mask:0xf bank_mask:0xf
    s_nop 1
    v_add_u32_dpp v68, v68, v68 row_half_mirror row_mask:0xf bank_mask:0xf
    v_mov_b32 v69, v68
    s_nop 1
    v_permlane16_swap_b32 v68, v69
    v_add_u32 v68, v68, v69
    v_mov_b32 v69, v68
    s_nop 1
    v_permlane32_swap_b32 v68, v69
    v_add_u32 v68, v68, v69
    v_ashrrev_i32 v68, 5, v68
    s_mov_b64 exec, 1
    ds_write_b32 v8, v68 offset:676
    s_mov_b64 exec, 0xffff
    v_max_f32_dpp v60, v64, v64 quad_perm:[1,0,3,2] row_mask:0xf bank_mask:0xf
    s_nop 1
    v_max_f32_dpp v60, v60, v60 quad_perm:[2,3,0,1] row_mask:0xf bank_mask:0xf
    s_nop 1
    v_max_f32_dpp v60, v60, v60 row_half_mirror row_mask:0xf bank_mask:0xf
    s_nop 1
    v_max_f32_dpp v60, v60, v60 row_mirror row_mask:0xf bank_mask:0xf
    v_sub_f32 v64, v64, v60
    v_sub_f32 v56, v56, v60
    v_mul_f32 v64, s80, v64
    v_mul_f32 v56, s80, v56
    v_exp_f32 v64, v64
    v_exp_f32 v56, v56
    v_mul_f32 v61, v64, v65
    v_mul_f32 v64, 0.25, v64
    s_nop 0
    v_add_f32_dpp v61, v61, v61 quad_perm:[1,0,3,2] row_mask:0xf bank_mask:0xf
    s_nop 1
    v_add_f32_dpp v61, v61, v61 quad_perm:[2,3,0,1] row_mask:0xf bank_mask:0xf
    s_nop 1
    v_add_f32_dpp v61, v61, v61 row_half_mirror row_mask:0xf bank_mask:0xf
    s_nop 1
    v_add_f32_dpp v61, v61, v61 row_mirror row_mask:0xf bank_mask:0xf
    v_rcp_f32 v61, v61
    s_lshl_b32 s63, s35, 2
    s_add_u32 s63, s63, s75
    s_xor_b32 s3, s63, 4
    v_mul_f32 v56, v56, v61
    v_mul_f32 v64, v64, v61
    s_mov_b64 exec, 15
    ds_write_b32 v9, v56 offset:640
    v_readlane_b32 s12, v64, s63
    v_readlane_b32 s13, v64, s3
L_cmb:
    s_nop 4
    s_mov_b64 exec, -1
    s_lshl_b32 s63, s74, 5
    v_add_u32 v11, s63, v10
    s_lshl_b32 s63, s74, 4
    v_add_u32 v9, s63, v9
    s_lshl_b32 s63, s74, 11
    v_add_u32 v12, s63, v10
    s_lshl_b32 s63, s74, 7
    s_add_u32 s63, s63, s61
    s_lshl_b32 s69, s63, 9
    s_add_u32 s69, s69, 0x50000
    v_mov_b32 v77, s62
    s_mov_b32 s71, 0x8000
    s_mov_b32 s73, 0x40000
    s_mov_b64 exec, 15
L_sp:
    s_sleep 16
    ds_read_b64 v[56:57], v11 offset:544
    s_sub_u32 s73, s73, 1
    s_waitcnt lgkmcnt(0)
    s_cbranch_scc1 L_sd
    v_cmp_eq_u32 vcc, -1, v57
    s_nop 4
    s_cbranch_vccnz L_sp
L_sd:
    v_max_f32_dpp v60, v56, v56 quad_perm:[1,0,3,2] row_mask:0xf bank_mask:0xf
    s_nop 1
    v_max_f32_dpp v60, v60, v60 quad_perm:[2,3,0,1] row_mask:0xf bank_mask:0xf
    v_sub_f32 v58, v56, v60
    v_mul_f32 v58, s80, v58
    v_exp_f32 v58, v58
    s_mov_b32 s73, 0x40000
    v_readlane_b32 s8, v58, 0
    v_readlane_b32 s9, v58, 1
    v_readlane_b32 s10, v58, 2
    v_readlane_b32 s11, v58, 3
L_fp:
    s_sleep 4
    ds_read_b32 v68, v9 offset:608
    s_sub_u32 s73, s73, 1
    s_waitcnt lgkmcnt(0)
    s_cbranch_scc1 L_fd
    v_cmp_ne_u32 vcc, 0, v68
    s_nop 4
    s_cbranch_vccnz L_fp
L_fd:
    s_mov_b64 exec, -1
    ds_read_b64 v[68:69], v12 offset:2560
    ds_read_b64 v[70:71], v12 offset:3072
    ds_read_b64 v[72:73], v12 offset:3584
    ds_read_b64 v[74:75], v12 offset:4096
    s_cmp_eq_u32 s64, 1
    s_waitcnt lgkmcnt(0)
    v_mul_f32 v68, s8, v68
    v_mul_f32 v69, s8, v69
    v_fmac_f32 v68, s9, v70
    v_fmac_f32 v69, s9, v71
    v_fmac_f32 v68, s10, v72
    v_fmac_f32 v69, s10, v73
    v_fmac_f32 v68, s11, v74
    v_fmac_f32 v69, s11, v75
    s_cbranch_scc1 L_rcv
    v_cvt_pk_bf16_f32 v76, v68, v69
    buffer_store_dwordx2 v[76:77], v10, s[56:59], s69 offen sc1
    s_branch L_hy
L_rcv:
    v_mul_f32 v68, s12, v68
    v_mul_f32 v69, s12, v69
    s_sleep 30
    s_cmp_eq_u32 s35, 1
    s_cbranch_scc1 L_op
    s_sleep 60
L_op:
    buffer_load_dwordx2 v[76:77], v10, s[56:59], s69 offen sc1
    s_sub_u32 s71, s71, 1
    s_waitcnt vmcnt(0)
    s_cbranch_scc1 L_od
    v_cmp_ne_u32 vcc, s62, v77
    s_nop 4
    s_cbranch_vccz L_od
    s_sleep 8
    s_branch L_op
L_od:
    v_lshlrev_b32 v70, 16, v76
    v_and_b32 v71, 0xffff0000, v76
    v_fmac_f32 v68, s13, v70
    v_fmac_f32 v69, s13, v71
    ds_write_b64 v10, v[68:69] offset:2048
    ds_write_b32 v8, v8 offset:672
    s_waitcnt lgkmcnt(0)
L_hy:
    s_nop 4
    s_barrier
L_hy2:
    ds_read_b128 v[16:19], v14 offset:768
    ds_read_b128 v[20:23], v14 offset:896
    s_cmp_eq_u32 s72, 0
    s_waitcnt lgkmcnt(1)
    v_smfmac_f32_16x16x64_bf16 v[40:43], v[16:19], v[156:163], v13
    s_waitcnt lgkmcnt(0)
    v_smfmac_f32_16x16x64_bf16 v[40:43], v[20:23], v[164:171], v13
    v_smfmac_f32_16x16x64_bf16 v[44:47], v[16:19], v[236:243], v13
    v_smfmac_f32_16x16x64_bf16 v[44:47], v[20:23], v[244:251], v13
    v_smfmac_f32_16x16x64_bf16 v[48:51], v[16:19], v[92:99], v13
    v_smfmac_f32_16x16x64_bf16 v[48:51], v[20:23], v[100:107], v13
    v_smfmac_f32_16x16x64_bf16 v[52:55], v[16:19], v[108:115], v13
    v_smfmac_f32_16x16x64_bf16 v[52:55], v[20:23], v[116:123], v13
    v_smfmac_f32_16x16x64_bf16 v[80:83], v[16:19], v[172:179], v13
    v_smfmac_f32_16x16x64_bf16 v[80:83], v[20:23], v[180:187], v13
    v_pk_add_f32 v[40:41], v[40:41], v[42:43]
    v_smfmac_f32_16x16x64_bf16 v[84:87], v[16:19], v[188:195], v13
    v_pk_add_f32 v[44:45], v[44:45], v[46:47]
    v_add_f32_dpp v60, v40, v41 quad_perm:[0,1,2,3] row_mask:0x3 bank_mask:0xf
    v_smfmac_f32_16x16x64_bf16 v[84:87], v[20:23], v[196:203], v13
    v_add_f32_dpp v61, v40, v41 quad_perm:[0,1,2,3] row_mask:0x3 bank_mask:0xf
    v_add_f32_dpp v60, v44, v45 quad_perm:[0,1,2,3] row_mask:0xc bank_mask:0xf
    v_smfmac_f32_16x16x64_bf16 v[88:91], v[16:19], v[124:131], v13
    v_add_f32_dpp v61, v44, v45 quad_perm:[0,1,2,3] row_mask:0xc bank_mask:0xf
    v_pk_add_f32 v[48:49], v[48:49], v[50:51]
    v_smfmac_f32_16x16x64_bf16 v[88:91], v[20:23], v[132:139], v13
    v_permlane16_swap_b32 v60, v61
    v_add_f32 v34, v60, v61
    v_smfmac_f32_16x16x64_bf16 v[24:27], v[16:19], v[140:147], v13
    v_add_f32_dpp v56, v48, v49 quad_perm:[0,1,2,3] row_mask:0x3 bank_mask:0xf
    v_pk_add_f32 v[52:53], v[52:53], v[54:55]
    v_smfmac_f32_16x16x64_bf16 v[24:27], v[20:23], v[148:155], v13
    v_pk_add_f32 v[80:81], v[80:81], v[82:83]
    v_add_f32_dpp v57, v52, v53 quad_perm:[0,1,2,3] row_mask:0x3 bank_mask:0xf
    v_smfmac_f32_16x16x64_bf16 v[28:31], v[16:19], v[204:211], v13
    v_add_f32_dpp v56, v80, v81 quad_perm:[0,1,2,3] row_mask:0xc bank_mask:0xf
    v_pk_add_f32 v[84:85], v[84:85], v[86:87]
    v_smfmac_f32_16x16x64_bf16 v[28:31], v[20:23], v[212:219], v13
    v_pk_add_f32 v[88:89], v[88:89], v[90:91]
    v_add_f32_dpp v57, v84, v85 quad_perm:[0,1,2,3] row_mask:0xc bank_mask:0xf
    v_smfmac_f32_16x16x64_bf16 v[36:39], v[16:19], v[220:227], v13
    v_add_f32_dpp v58, v88, v89 quad_perm:[0,1,2,3] row_mask:0x3 bank_mask:0xf
    v_permlane16_swap_b32 v56, v57
    v_smfmac_f32_16x16x64_bf16 v[36:39], v[20:23], v[228:235], v13
    v_add_f32 v32, v56, v57
    v_pk_add_f32 v[24:25], v[24:25], v[26:27]
    v_pk_add_f32 v[28:29], v[28:29], v[30:31]
    s_nop 0
    v_add_f32_dpp v59, v24, v25 quad_perm:[0,1,2,3] row_mask:0x3 bank_mask:0xf
    v_add_f32_dpp v58, v28, v29 quad_perm:[0,1,2,3] row_mask:0xc bank_mask:0xf
    s_nop 1
    v_pk_add_f32 v[36:37], v[36:37], v[38:39]
    s_nop 1
    v_add_f32_dpp v59, v36, v37 quad_perm:[0,1,2,3] row_mask:0xc bank_mask:0xf
    s_nop 1
    v_permlane16_swap_b32 v58, v59
    v_add_f32 v33, v58, v59
    s_cbranch_scc1 L_hb2
    buffer_store_dwordx4 v[32:35], v6, s[56:59], s82 offen sc1
L_end:
    s_endpgm
.section .rodata,"a"
.p2align 6
.amdhsa_kernel concat_heads__mha_block_cached__gqa_block_cached__decode_kernel
  .amdhsa_next_free_vgpr 256
  .amdhsa_next_free_sgpr 102
  .amdhsa_accum_offset 256
  .amdhsa_group_segment_fixed_size 0
  .amdhsa_kernarg_size 104
  .amdhsa_user_sgpr_count 2
  .amdhsa_user_sgpr_kernarg_segment_ptr 1
  .amdhsa_system_sgpr_workgroup_id_x 1
.end_amdhsa_kernel
```
